```python
import torch

def _softmax(x, axis=-1):
    return torch.softmax(x, dim=axis)

def _gelu(x):
    return torch.nn.functional.gelu(x, approximate='tanh')

def _silu(x):
    return torch.nn.functional.silu(x)

def _sigmoid(x):
    return torch.sigmoid(x)

def _layernorm(x, axis=-1, eps=1e-05):
    m = x.mean(dim=axis, keepdim=True)
    v = x.var(dim=axis, keepdim=True, unbiased=False)
    return (x - m) / torch.sqrt(v + eps)

def _scatter_add(tgt, idx, src, axis=0):
    return tgt.clone().index_add_(axis, idx, src)

def _segment_sum(src, seg, n):
    out = torch.zeros((n,) + src.shape[1:], dtype=src.dtype)
    return out.index_add_(0, seg, src)

def _pad(x, pw):
    flat = tuple((v for pair in reversed(pw) for v in pair))
    return torch.nn.functional.pad(x, flat)
kernel_name = 'adaLN_cond__mha_block_cached__moe_arch_mod__prompt'

def setup_inputs():

    _w = lambda a: (lambda t: t.to(torch.bfloat16) if t.is_floating_point() else t)(torch.as_tensor(a))

    def _A_setup():
        B, Sq, D = (1, 2048, 512)
        H, Sk, Dh = (32, 2048, 128)
        return {'x': _w((lambda *s: torch.randn(*s, dtype=torch.bfloat16) * 0.1)(B, Sq, D)), 'k_cache': _w((lambda *s: torch.randn(*s, dtype=torch.bfloat16) * 0.8)(B, H, Sk, Dh)), 'v_cache': _w((lambda *s: torch.randn(*s, dtype=torch.bfloat16) * 3.2)(B, H, Sk, Dh)), 'wq': _w((lambda *s: torch.randn(*s, dtype=torch.bfloat16) * 0.8)(D, H * Dh) * D ** (-0.5)), 'wo': _w((lambda *s: torch.randn(*s, dtype=torch.bfloat16) * 3.2)(H * Dh, D) * (H * Dh) ** (-0.5))}
    _A_in = _A_setup()

    def _B_setup():
        B, S, D, F, C = (1, 2048, 512, 1792, 1)
        return {'x': _w((lambda *s: torch.randn(*s, dtype=torch.bfloat16) * 0.1)(B, S, D)), 'w_r': _w((lambda *s: torch.randn(*s, dtype=torch.bfloat16) * 3.2)(D)), 'w_gate': _w((lambda *s: torch.randn(*s, dtype=torch.bfloat16) * 3.2)(D, F)), 'w_up': _w((lambda *s: torch.randn(*s, dtype=torch.bfloat16) * 3.2)(D, F)), 'w_down': _w((lambda *s: torch.randn(*s, dtype=torch.bfloat16) * 3.2)(F, D))}
    _B_in = _B_setup()
    return {'A_x': _A_in['x'], 'A_k_cache': _A_in['k_cache'], 'A_v_cache': _A_in['v_cache'], 'A_wq': _A_in['wq'], 'A_wo': _A_in['wo'], 'B_x': _B_in['x'], 'B_w_r': _B_in['w_r'], 'B_w_gate': _B_in['w_gate'], 'B_w_up': _B_in['w_up'], 'B_w_down': _B_in['w_down'], 'c': _w((lambda *s: torch.randn(*s, dtype=torch.bfloat16) * 0.2)(1, 512) * 8.0), 'w_mod': _w((lambda *s: torch.randn(*s, dtype=torch.bfloat16) * 0.2)(512, 6 * 512) * 512 ** (-0.5) * 8.0)}

def reference(A_x, A_k_cache, A_v_cache, A_wq, A_wo, B_x, B_w_r, B_w_gate, B_w_up, B_w_down, c, w_mod):

    def _A_ref(x, k_cache, v_cache, wq, wo):
        B, Sq, D = x.shape
        H, Dh = (32, 128)
        q = (lambda x, *d: x.permute(*d))((x @ wq).reshape(B, Sq, H, Dh), 0, 2, 1, 3)
        scores = torch.einsum('bhqd,bhkd->bhqk', q, k_cache) * Dh ** (-0.5)
        p = _softmax(scores, axis=-1)
        o = torch.einsum('bhqk,bhkd->bhqd', p, v_cache)
        return (lambda x, *d: x.permute(*d))(o, 0, 2, 1, 3).reshape(B, Sq, H * Dh) @ wo

    def _B_ref(x, w_r, w_gate, w_up, w_down):
        B, S, D = x.shape
        C = 1
        r = x @ w_r
        idx = torch.argsort(-r, axis=-1)[:, :C]
        idx_e = (lambda x, n, axis: torch.repeat_interleave(x, n, dim=axis))(idx.reshape(B, C, 1), D, axis=2)
        x_sel = (lambda x, i, axis: torch.take_along_dim(x, i, dim=axis))(x, idx_e, axis=1)
        g = _silu(x_sel @ w_gate)
        u = x_sel @ w_up
        y = g * u @ w_down
        r_sel = _sigmoid((lambda x, i, axis: torch.take_along_dim(x, i, dim=axis))(r, idx, axis=1))
        y = y * r_sel.reshape(B, C, 1)
        b_off = (torch.arange(B) * S).reshape(B, 1)
        flat_idx = (idx + b_off).reshape(B * C)
        zero = (x * 0.0).reshape(B * S, D)
        upd = _scatter_add(zero, flat_idx, y.reshape(B * C, D), axis=0)
        return x + upd.reshape(B, S, D)
    x = A_x
    mod = (_silu(c) @ w_mod).reshape(c.shape[0], 6, 1, -1)
    sa, ca, ga, sb, cb, gb = (mod[:, 0].clone(), mod[:, 1].clone(), mod[:, 2].clone(), mod[:, 3].clone(), mod[:, 4].clone(), mod[:, 5].clone())
    h = _layernorm(x, axis=-1) * (1 + ca) + sa
    x = x + ga * _A_ref(h, A_k_cache, A_v_cache, A_wq, A_wo)
    h = _layernorm(x, axis=-1) * (1 + cb) + sb
    x = x + gb * _B_ref(h, B_w_r, B_w_gate, B_w_up, B_w_down)
    return x
```

```asm
; @launch grid=(256,1,1) block=(256,1,1) lds=163840
.amdgcn_target "amdgcn-amd-amdhsa--gfx950"
.text
.globl adaLN_cond__mha_block_cached__moe_arch_mod__prompt_kernel
.p2align 8
.type adaLN_cond__mha_block_cached__moe_arch_mod__prompt_kernel,@function
adaLN_cond__mha_block_cached__moe_arch_mod__prompt_kernel:
    s_cmp_ge_u32 s2, 256
    s_cbranch_scc1 L2_end
    s_load_dwordx4 s[44:47], s[0:1], 80
    s_load_dwordx2 s[58:59], s[0:1], 0
    s_load_dwordx2 s[10:11], s[0:1], 112
    s_load_dwordx2 s[60:61], s[0:1], 48
    s_load_dwordx4 s[4:7], s[0:1], 8
    s_load_dwordx2 s[8:9], s[0:1], 24
    s_load_dwordx2 s[56:57], s[0:1], 32
    s_load_dwordx2 s[54:55], s[0:1], 104
    s_load_dwordx2 s[62:63], s[0:1], 96
    s_load_dwordx4 s[64:67], s[0:1], 56
    s_load_dwordx2 s[68:69], s[0:1], 72
    v_lshrrev_b32 v1, 6, v0
    s_nop 0
    v_readfirstlane_b32 s36, v1
    s_waitcnt lgkmcnt(0)
    s_mov_b32 s32, s10
    s_mov_b32 s33, s11
    s_mov_b32 s34, 131072
    s_mov_b32 s35, 0x20000
    s_and_b32 s53, s2, 7
    s_lshl_b32 s53, s53, 7
    s_add_u32 s53, s53, 126976
    v_mov_b32 v101, 0
    s_cmp_ge_u32 s2, 224
    s_cbranch_scc0 L0_role
    buffer_load_dword v100, v101, s[32:35], s53 offen sc1
    s_branch L0_done
L0_role:
    s_cmp_ge_u32 s2, 96
    s_cbranch_scc1 L0_ln
    v_and_b32 v1, 3, v0
    v_lshrrev_b32 v2, 2, v0
    s_and_b32 s50, s2, 7
    s_lshl_b32 s50, s50, 1
    s_bfe_u32 s42, s2, 0x10003
    s_add_u32 s50, s50, s42
    s_and_b32 s42, s2, 0x70
    s_add_u32 s50, s50, s42
    s_lshl_b32 s42, s50, 6
    s_movk_i32 s43, 6144
    v_mul_lo_u32 v3, v2, s43
    v_lshl_add_u32 v3, v1, 4, v3
    v_add_u32 v3, s42, v3
    v_lshlrev_b32 v4, 1, v2
    v_and_b32 v5, 31, v0
    v_lshlrev_b32 v6, 1, v5
    v_lshrrev_b32 v48, 4, v0
    v_lshlrev_b32 v48, 7, v48
    v_lshl_add_u32 v48, v1, 5, v48
    v_add_u32 v48, 147456, v48
    s_waitcnt lgkmcnt(0)
    s_mov_b32 s16, s46
    s_mov_b32 s17, s47
    s_mov_b32 s18, 3145728
    s_mov_b32 s19, 0x20000
    s_mov_b32 s20, s44
    s_mov_b32 s21, s45
    s_mov_b32 s22, 1024
    s_mov_b32 s23, 0x20000
    s_mov_b32 s24, s60
    s_mov_b32 s25, s61
    s_mov_b32 s26, 1024
    s_mov_b32 s27, 0x20000
    buffer_load_ushort v8, v4, s[20:23], 0 offen offset:0
    buffer_load_ushort v9, v4, s[20:23], 0 offen offset:128
    buffer_load_ushort v10, v4, s[20:23], 0 offen offset:256
    buffer_load_ushort v11, v4, s[20:23], 0 offen offset:384
    buffer_load_ushort v12, v4, s[20:23], 0 offen offset:512
    buffer_load_ushort v13, v4, s[20:23], 0 offen offset:640
    buffer_load_ushort v14, v4, s[20:23], 0 offen offset:768
    buffer_load_ushort v15, v4, s[20:23], 0 offen offset:896
    s_mov_b32 s43, 0
    buffer_load_dwordx4 v[16:19], v3, s[16:19], s43 offen
    s_mov_b32 s43, 393216
    buffer_load_dwordx4 v[20:23], v3, s[16:19], s43 offen
    s_mov_b32 s43, 786432
    buffer_load_dwordx4 v[24:27], v3, s[16:19], s43 offen
    s_mov_b32 s43, 1179648
    buffer_load_dwordx4 v[28:31], v3, s[16:19], s43 offen
    s_mov_b32 s43, 1572864
    buffer_load_dwordx4 v[32:35], v3, s[16:19], s43 offen
    s_mov_b32 s43, 1966080
    buffer_load_dwordx4 v[36:39], v3, s[16:19], s43 offen
    s_mov_b32 s43, 2359296
    buffer_load_dwordx4 v[40:43], v3, s[16:19], s43 offen
    s_mov_b32 s43, 2752512
    buffer_load_dwordx4 v[44:47], v3, s[16:19], s43 offen
    s_and_b32 s43, s50, 15
    s_lshl_b32 s43, s43, 6
    buffer_load_ushort v7, v6, s[24:27], s43 offen
    buffer_load_dword v100, v101, s[32:35], s53 offen sc1
    s_mov_b32 s15, 0xbfb8aa3b
    s_waitcnt vmcnt(17)
    v_lshlrev_b32 v8, 16, v8
    s_waitcnt vmcnt(16)
    v_lshlrev_b32 v9, 16, v9
    s_waitcnt vmcnt(15)
    v_lshlrev_b32 v10, 16, v10
    s_waitcnt vmcnt(14)
    v_lshlrev_b32 v11, 16, v11
    s_waitcnt vmcnt(13)
    v_lshlrev_b32 v12, 16, v12
    s_waitcnt vmcnt(12)
    v_lshlrev_b32 v13, 16, v13
    s_waitcnt vmcnt(11)
    v_lshlrev_b32 v14, 16, v14
    s_waitcnt vmcnt(10)
    v_lshlrev_b32 v15, 16, v15
    v_mul_f32 v112, s15, v8
    v_mul_f32 v113, s15, v9
    v_mul_f32 v114, s15, v10
    v_mul_f32 v115, s15, v11
    v_mul_f32 v116, s15, v12
    v_mul_f32 v117, s15, v13
    v_mul_f32 v118, s15, v14
    v_mul_f32 v119, s15, v15
    v_exp_f32 v112, v112
    v_exp_f32 v113, v113
    v_exp_f32 v114, v114
    v_exp_f32 v115, v115
    v_exp_f32 v116, v116
    v_exp_f32 v117, v117
    v_exp_f32 v118, v118
    v_exp_f32 v119, v119
    v_add_f32 v112, 1.0, v112
    v_add_f32 v113, 1.0, v113
    v_add_f32 v114, 1.0, v114
    v_add_f32 v115, 1.0, v115
    v_add_f32 v116, 1.0, v116
    v_add_f32 v117, 1.0, v117
    v_add_f32 v118, 1.0, v118
    v_add_f32 v119, 1.0, v119
    v_rcp_f32 v112, v112
    v_rcp_f32 v113, v113
    v_rcp_f32 v114, v114
    v_rcp_f32 v115, v115
    v_rcp_f32 v116, v116
    v_rcp_f32 v117, v117
    v_rcp_f32 v118, v118
    v_rcp_f32 v119, v119
    v_mul_f32 v8, v8, v112
    v_mul_f32 v9, v9, v113
    v_mul_f32 v10, v10, v114
    v_mul_f32 v11, v11, v115
    v_mul_f32 v12, v12, v116
    v_mul_f32 v13, v13, v117
    v_mul_f32 v14, v14, v118
    v_mul_f32 v15, v15, v119
    v_cvt_pk_bf16_f32 v8, v8, v8
    v_and_b32 v8, 0xffff0000, v8
    v_cvt_pk_bf16_f32 v9, v9, v9
    v_and_b32 v9, 0xffff0000, v9
    v_cvt_pk_bf16_f32 v10, v10, v10
    v_and_b32 v10, 0xffff0000, v10
    v_cvt_pk_bf16_f32 v11, v11, v11
    v_and_b32 v11, 0xffff0000, v11
    v_cvt_pk_bf16_f32 v12, v12, v12
    v_and_b32 v12, 0xffff0000, v12
    v_cvt_pk_bf16_f32 v13, v13, v13
    v_and_b32 v13, 0xffff0000, v13
    v_cvt_pk_bf16_f32 v14, v14, v14
    v_and_b32 v14, 0xffff0000, v14
    v_cvt_pk_bf16_f32 v15, v15, v15
    v_and_b32 v15, 0xffff0000, v15
    s_waitcnt vmcnt(9)
    v_lshlrev_b32 v112, 16, v16
    v_and_b32 v113, 0xffff0000, v16
    v_mul_f32 v50, v8, v112
    v_mul_f32 v51, v8, v113
    v_lshlrev_b32 v112, 16, v17
    v_and_b32 v113, 0xffff0000, v17
    v_mul_f32 v52, v8, v112
    v_mul_f32 v53, v8, v113
    v_lshlrev_b32 v112, 16, v18
    v_and_b32 v113, 0xffff0000, v18
    v_mul_f32 v54, v8, v112
    v_mul_f32 v55, v8, v113
    v_lshlrev_b32 v112, 16, v19
    v_and_b32 v113, 0xffff0000, v19
    v_mul_f32 v56, v8, v112
    v_mul_f32 v57, v8, v113
    s_waitcnt vmcnt(8)
    v_lshlrev_b32 v112, 16, v20
    v_and_b32 v113, 0xffff0000, v20
    v_fmac_f32 v50, v9, v112
    v_fmac_f32 v51, v9, v113
    v_lshlrev_b32 v112, 16, v21
    v_and_b32 v113, 0xffff0000, v21
    v_fmac_f32 v52, v9, v112
    v_fmac_f32 v53, v9, v113
    v_lshlrev_b32 v112, 16, v22
    v_and_b32 v113, 0xffff0000, v22
    v_fmac_f32 v54, v9, v112
    v_fmac_f32 v55, v9, v113
    v_lshlrev_b32 v112, 16, v23
    v_and_b32 v113, 0xffff0000, v23
    v_fmac_f32 v56, v9, v112
    v_fmac_f32 v57, v9, v113
    s_waitcnt vmcnt(7)
    v_lshlrev_b32 v112, 16, v24
    v_and_b32 v113, 0xffff0000, v24
    v_fmac_f32 v50, v10, v112
    v_fmac_f32 v51, v10, v113
    v_lshlrev_b32 v112, 16, v25
    v_and_b32 v113, 0xffff0000, v25
    v_fmac_f32 v52, v10, v112
    v_fmac_f32 v53, v10, v113
    v_lshlrev_b32 v112, 16, v26
    v_and_b32 v113, 0xffff0000, v26
    v_fmac_f32 v54, v10, v112
    v_fmac_f32 v55, v10, v113
    v_lshlrev_b32 v112, 16, v27
    v_and_b32 v113, 0xffff0000, v27
    v_fmac_f32 v56, v10, v112
    v_fmac_f32 v57, v10, v113
    s_waitcnt vmcnt(6)
    v_lshlrev_b32 v112, 16, v28
    v_and_b32 v113, 0xffff0000, v28
    v_fmac_f32 v50, v11, v112
    v_fmac_f32 v51, v11, v113
    v_lshlrev_b32 v112, 16, v29
    v_and_b32 v113, 0xffff0000, v29
    v_fmac_f32 v52, v11, v112
    v_fmac_f32 v53, v11, v113
    v_lshlrev_b32 v112, 16, v30
    v_and_b32 v113, 0xffff0000, v30
    v_fmac_f32 v54, v11, v112
    v_fmac_f32 v55, v11, v113
    v_lshlrev_b32 v112, 16, v31
    v_and_b32 v113, 0xffff0000, v31
    v_fmac_f32 v56, v11, v112
    v_fmac_f32 v57, v11, v113
    s_waitcnt vmcnt(5)
    v_lshlrev_b32 v112, 16, v32
    v_and_b32 v113, 0xffff0000, v32
    v_fmac_f32 v50, v12, v112
    v_fmac_f32 v51, v12, v113
    v_lshlrev_b32 v112, 16, v33
    v_and_b32 v113, 0xffff0000, v33
    v_fmac_f32 v52, v12, v112
    v_fmac_f32 v53, v12, v113
    v_lshlrev_b32 v112, 16, v34
    v_and_b32 v113, 0xffff0000, v34
    v_fmac_f32 v54, v12, v112
    v_fmac_f32 v55, v12, v113
    v_lshlrev_b32 v112, 16, v35
    v_and_b32 v113, 0xffff0000, v35
    v_fmac_f32 v56, v12, v112
    v_fmac_f32 v57, v12, v113
    s_waitcnt vmcnt(4)
    v_lshlrev_b32 v112, 16, v36
    v_and_b32 v113, 0xffff0000, v36
    v_fmac_f32 v50, v13, v112
    v_fmac_f32 v51, v13, v113
    v_lshlrev_b32 v112, 16, v37
    v_and_b32 v113, 0xffff0000, v37
    v_fmac_f32 v52, v13, v112
    v_fmac_f32 v53, v13, v113
    v_lshlrev_b32 v112, 16, v38
    v_and_b32 v113, 0xffff0000, v38
    v_fmac_f32 v54, v13, v112
    v_fmac_f32 v55, v13, v113
    v_lshlrev_b32 v112, 16, v39
    v_and_b32 v113, 0xffff0000, v39
    v_fmac_f32 v56, v13, v112
    v_fmac_f32 v57, v13, v113
    s_waitcnt vmcnt(3)
    v_lshlrev_b32 v112, 16, v40
    v_and_b32 v113, 0xffff0000, v40
    v_fmac_f32 v50, v14, v112
    v_fmac_f32 v51, v14, v113
    v_lshlrev_b32 v112, 16, v41
    v_and_b32 v113, 0xffff0000, v41
    v_fmac_f32 v52, v14, v112
    v_fmac_f32 v53, v14, v113
    v_lshlrev_b32 v112, 16, v42
    v_and_b32 v113, 0xffff0000, v42
    v_fmac_f32 v54, v14, v112
    v_fmac_f32 v55, v14, v113
    v_lshlrev_b32 v112, 16, v43
    v_and_b32 v113, 0xffff0000, v43
    v_fmac_f32 v56, v14, v112
    v_fmac_f32 v57, v14, v113
    s_waitcnt vmcnt(2)
    v_lshlrev_b32 v112, 16, v44
    v_and_b32 v113, 0xffff0000, v44
    v_fmac_f32 v50, v15, v112
    v_fmac_f32 v51, v15, v113
    v_lshlrev_b32 v112, 16, v45
    v_and_b32 v113, 0xffff0000, v45
    v_fmac_f32 v52, v15, v112
    v_fmac_f32 v53, v15, v113
    v_lshlrev_b32 v112, 16, v46
    v_and_b32 v113, 0xffff0000, v46
    v_fmac_f32 v54, v15, v112
    v_fmac_f32 v55, v15, v113
    v_lshlrev_b32 v112, 16, v47
    v_and_b32 v113, 0xffff0000, v47
    v_fmac_f32 v56, v15, v112
    v_fmac_f32 v57, v15, v113
    v_add_f32_dpp v50, v50, v50 row_ror:4 row_mask:0xf bank_mask:0xf
    v_add_f32_dpp v51, v51, v51 row_ror:4 row_mask:0xf bank_mask:0xf
    v_add_f32_dpp v52, v52, v52 row_ror:4 row_mask:0xf bank_mask:0xf
    v_add_f32_dpp v53, v53, v53 row_ror:4 row_mask:0xf bank_mask:0xf
    v_add_f32_dpp v54, v54, v54 row_ror:4 row_mask:0xf bank_mask:0xf
    v_add_f32_dpp v55, v55, v55 row_ror:4 row_mask:0xf bank_mask:0xf
    v_add_f32_dpp v56, v56, v56 row_ror:4 row_mask:0xf bank_mask:0xf
    v_add_f32_dpp v57, v57, v57 row_ror:4 row_mask:0xf bank_mask:0xf
    v_add_f32_dpp v50, v50, v50 row_ror:8 row_mask:0xf bank_mask:0xf
    v_add_f32_dpp v51, v51, v51 row_ror:8 row_mask:0xf bank_mask:0xf
    v_add_f32_dpp v52, v52, v52 row_ror:8 row_mask:0xf bank_mask:0xf
    v_add_f32_dpp v53, v53, v53 row_ror:8 row_mask:0xf bank_mask:0xf
    v_add_f32_dpp v54, v54, v54 row_ror:8 row_mask:0xf bank_mask:0xf
    v_add_f32_dpp v55, v55, v55 row_ror:8 row_mask:0xf bank_mask:0xf
    v_add_f32_dpp v56, v56, v56 row_ror:8 row_mask:0xf bank_mask:0xf
    v_add_f32_dpp v57, v57, v57 row_ror:8 row_mask:0xf bank_mask:0xf
    v_and_b32 v49, 12, v0
    v_cmp_eq_u32 vcc, 0, v49
    s_and_saveexec_b64 s[48:49], vcc
    ds_write_b128 v48, v[50:53]
    ds_write_b128 v48, v[54:57] offset:16
    s_mov_b64 exec, s[48:49]
    s_waitcnt lgkmcnt(0)
    s_barrier
    s_cmp_lg_u32 s36, 0
    s_cbranch_scc1 L0_done
    v_lshrrev_b32 v48, 5, v0
    v_lshlrev_b32 v48, 10, v48
    v_lshl_add_u32 v48, v5, 2, v48
    v_add_u32 v48, 147456, v48
    ds_read_b32 v16, v48 offset:0
    ds_read_b32 v17, v48 offset:128
    ds_read_b32 v18, v48 offset:256
    ds_read_b32 v19, v48 offset:384
    ds_read_b32 v20, v48 offset:512
    ds_read_b32 v21, v48 offset:640
    ds_read_b32 v22, v48 offset:768
    ds_read_b32 v23, v48 offset:896
    s_waitcnt lgkmcnt(6)
    v_add_f32 v16, v16, v17
    s_waitcnt lgkmcnt(4)
    v_add_f32 v18, v18, v19
    s_waitcnt lgkmcnt(2)
    v_add_f32 v20, v20, v21
    s_waitcnt lgkmcnt(0)
    v_add_f32 v22, v22, v23
    v_add_f32 v16, v16, v18
    v_add_f32 v20, v20, v22
    v_add_f32 v16, v16, v20
    v_mov_b32 v17, v16
    s_nop 1
    v_permlane32_swap_b32 v17, v16
    v_add_f32 v16, v17, v16
    v_cvt_pk_bf16_f32 v16, v16, v16
    v_and_b32 v16, 0xffff0000, v16
    s_lshr_b32 s42, s2, 4
    v_add_f32 v17, 1.0, v16
    v_cvt_pk_bf16_f32 v17, v17, v17
    v_and_b32 v17, 0xffff0000, v17
    s_cmp_eq_u32 s42, 1
    s_cselect_b64 vcc, -1, 0
    s_cmp_eq_u32 s42, 4
    s_cselect_b64 vcc, -1, vcc
    v_cndmask_b32 v16, v16, v17, vcc
    s_cmp_lt_u32 s42, 2
    s_cselect_b32 s43, 0x3e0293ee, 1.0
    v_mul_f32 v17, s43, v16
    s_lshl_b32 s43, s50, 7
    v_lshlrev_b32 v18, 2, v5
    s_mov_b32 exec_hi, 0
    buffer_store_dword v17, v18, s[32:35], s43 offen sc1
    s_mov_b64 exec, -1
    s_cmp_lt_u32 s42, 2
    s_cbranch_scc1 L0_sig
    s_sub_u32 s43, s42, 3
    s_cmp_gt_u32 s43, 1
    s_cbranch_scc1 L0_done
    s_waitcnt vmcnt(2)
    v_lshlrev_b32 v7, 16, v7
    v_mul_f32 v16, v16, v7
    s_nop 1
    v_add_f32_dpp v16, v16, v16 row_ror:8 row_mask:0xf bank_mask:0xf
    s_nop 1
    v_add_f32_dpp v16, v16, v16 row_ror:4 row_mask:0xf bank_mask:0xf
    s_nop 1
    v_add_f32_dpp v16, v16, v16 row_ror:2 row_mask:0xf bank_mask:0xf
    s_nop 1
    v_add_f32_dpp v16, v16, v16 row_ror:1 row_mask:0xf bank_mask:0xf
    v_mov_b32 v17, v16
    s_nop 1
    v_permlane16_swap_b32 v17, v16
    v_add_f32 v16, v17, v16
    s_sub_u32 s43, s50, 48
    s_lshl_b32 s43, s43, 2
    s_add_u32 s43, s43, 12288
    v_mov_b32 v18, 0
    s_mov_b64 exec, 1
    buffer_store_dword v16, v18, s[32:35], s43 offen sc1
    s_mov_b64 exec, -1
    s_branch L0_done
L0_ln:
    s_sub_u32 s42, s2, 96
    v_lshrrev_b32 v1, 4, v0
    v_and_b32 v2, 15, v0
    s_lshl_b32 s43, s42, 14
    v_lshlrev_b32 v3, 10, v1
    v_lshl_add_u32 v3, v2, 4, v3
    v_lshrrev_b32 v4, 2, v2
    v_lshlrev_b32 v4, 10, v4
    v_and_b32 v5, 3, v2
    v_lshl_add_u32 v4, v5, 8, v4
    v_lshl_add_u32 v4, v1, 4, v4
    s_waitcnt lgkmcnt(0)
    s_mov_b32 s16, s58
    s_mov_b32 s17, s59
    s_mov_b32 s18, 2097152
    s_mov_b32 s19, 0x20000
    s_add_u32 s20, s10, 1048576
    s_addc_u32 s21, s11, 0
    s_mov_b32 s22, 2097152
    s_mov_b32 s23, 0x20000
    buffer_load_dwordx4 v[8:11], v3, s[16:19], s43 offen offset:0
    buffer_load_dwordx4 v[12:15], v3, s[16:19], s43 offen offset:256
    buffer_load_dwordx4 v[16:19], v3, s[16:19], s43 offen offset:512
    buffer_load_dwordx4 v[20:23], v3, s[16:19], s43 offen offset:768
    buffer_load_dword v100, v101, s[32:35], s53 offen sc1
    v_and_b32 v6, 63, v0
    v_lshlrev_b32 v6, 2, v6
    v_mov_b32 v7, 0
    s_mul_i32 s48, s42, 656
    s_mul_i32 s49, s36, 164
    s_add_u32 s48, s48, s49
    s_add_u32 s48, s48, 16384
    s_movk_i32 exec_hi, 0x1ff
    buffer_store_dword v7, v6, s[32:35], s48 offen sc1
    s_mov_b64 exec, -1
    s_waitcnt vmcnt(5)
    v_lshlrev_b32 v32, 16, v8
    v_and_b32 v33, 0xffff0000, v8
    v_lshlrev_b32 v34, 16, v9
    v_and_b32 v35, 0xffff0000, v9
    v_lshlrev_b32 v36, 16, v10
    v_and_b32 v37, 0xffff0000, v10
    v_lshlrev_b32 v38, 16, v11
    v_and_b32 v39, 0xffff0000, v11
    s_waitcnt vmcnt(4)
    v_lshlrev_b32 v40, 16, v12
    v_and_b32 v41, 0xffff0000, v12
    v_lshlrev_b32 v42, 16, v13
    v_and_b32 v43, 0xffff0000, v13
    v_lshlrev_b32 v44, 16, v14
    v_and_b32 v45, 0xffff0000, v14
    v_lshlrev_b32 v46, 16, v15
    v_and_b32 v47, 0xffff0000, v15
    s_waitcnt vmcnt(3)
    v_lshlrev_b32 v48, 16, v16
    v_and_b32 v49, 0xffff0000, v16
    v_lshlrev_b32 v50, 16, v17
    v_and_b32 v51, 0xffff0000, v17
    v_lshlrev_b32 v52, 16, v18
    v_and_b32 v53, 0xffff0000, v18
    v_lshlrev_b32 v54, 16, v19
    v_and_b32 v55, 0xffff0000, v19
    s_waitcnt vmcnt(2)
    v_lshlrev_b32 v56, 16, v20
    v_and_b32 v57, 0xffff0000, v20
    v_lshlrev_b32 v58, 16, v21
    v_and_b32 v59, 0xffff0000, v21
    v_lshlrev_b32 v60, 16, v22
    v_and_b32 v61, 0xffff0000, v22
    v_lshlrev_b32 v62, 16, v23
    v_and_b32 v63, 0xffff0000, v23
    v_add_f32 v24, v32, v33
    v_add_f32 v25, v34, v35
    v_add_f32 v24, v24, v36
    v_add_f32 v25, v25, v37
    v_add_f32 v24, v24, v38
    v_add_f32 v25, v25, v39
    v_add_f32 v24, v24, v40
    v_add_f32 v25, v25, v41
    v_add_f32 v24, v24, v42
    v_add_f32 v25, v25, v43
    v_add_f32 v24, v24, v44
    v_add_f32 v25, v25, v45
    v_add_f32 v24, v24, v46
    v_add_f32 v25, v25, v47
    v_add_f32 v24, v24, v48
    v_add_f32 v25, v25, v49
    v_add_f32 v24, v24, v50
    v_add_f32 v25, v25, v51
    v_add_f32 v24, v24, v52
    v_add_f32 v25, v25, v53
    v_add_f32 v24, v24, v54
    v_add_f32 v25, v25, v55
    v_add_f32 v24, v24, v56
    v_add_f32 v25, v25, v57
    v_add_f32 v24, v24, v58
    v_add_f32 v25, v25, v59
    v_add_f32 v24, v24, v60
    v_add_f32 v25, v25, v61
    v_add_f32 v24, v24, v62
    v_add_f32 v25, v25, v63
    v_add_f32 v24, v24, v25
    s_nop 1
    v_add_f32_dpp v24, v24, v24 row_ror:8 row_mask:0xf bank_mask:0xf
    s_nop 1
    v_add_f32_dpp v24, v24, v24 row_ror:4 row_mask:0xf bank_mask:0xf
    s_nop 1
    v_add_f32_dpp v24, v24, v24 row_ror:2 row_mask:0xf bank_mask:0xf
    s_nop 1
    v_add_f32_dpp v24, v24, v24 row_ror:1 row_mask:0xf bank_mask:0xf
    v_mul_f32 v24, 0x3b000000, v24
    v_mov_b32 v26, 0
    v_mov_b32 v27, 0
    v_sub_f32 v8, v32, v24
    v_sub_f32 v9, v33, v24
    v_fmac_f32 v26, v8, v8
    v_fmac_f32 v27, v9, v9
    v_sub_f32 v8, v34, v24
    v_sub_f32 v9, v35, v24
    v_fmac_f32 v26, v8, v8
    v_fmac_f32 v27, v9, v9
    v_sub_f32 v8, v36, v24
    v_sub_f32 v9, v37, v24
    v_fmac_f32 v26, v8, v8
    v_fmac_f32 v27, v9, v9
    v_sub_f32 v8, v38, v24
    v_sub_f32 v9, v39, v24
    v_fmac_f32 v26, v8, v8
    v_fmac_f32 v27, v9, v9
    v_sub_f32 v8, v40, v24
    v_sub_f32 v9, v41, v24
    v_fmac_f32 v26, v8, v8
    v_fmac_f32 v27, v9, v9
    v_sub_f32 v8, v42, v24
    v_sub_f32 v9, v43, v24
    v_fmac_f32 v26, v8, v8
    v_fmac_f32 v27, v9, v9
    v_sub_f32 v8, v44, v24
    v_sub_f32 v9, v45, v24
    v_fmac_f32 v26, v8, v8
    v_fmac_f32 v27, v9, v9
    v_sub_f32 v8, v46, v24
    v_sub_f32 v9, v47, v24
    v_fmac_f32 v26, v8, v8
    v_fmac_f32 v27, v9, v9
    v_sub_f32 v8, v48, v24
    v_sub_f32 v9, v49, v24
    v_fmac_f32 v26, v8, v8
    v_fmac_f32 v27, v9, v9
    v_sub_f32 v8, v50, v24
    v_sub_f32 v9, v51, v24
    v_fmac_f32 v26, v8, v8
    v_fmac_f32 v27, v9, v9
    v_sub_f32 v8, v52, v24
    v_sub_f32 v9, v53, v24
    v_fmac_f32 v26, v8, v8
    v_fmac_f32 v27, v9, v9
    v_sub_f32 v8, v54, v24
    v_sub_f32 v9, v55, v24
    v_fmac_f32 v26, v8, v8
    v_fmac_f32 v27, v9, v9
    v_sub_f32 v8, v56, v24
    v_sub_f32 v9, v57, v24
    v_fmac_f32 v26, v8, v8
    v_fmac_f32 v27, v9, v9
    v_sub_f32 v8, v58, v24
    v_sub_f32 v9, v59, v24
    v_fmac_f32 v26, v8, v8
    v_fmac_f32 v27, v9, v9
    v_sub_f32 v8, v60, v24
    v_sub_f32 v9, v61, v24
    v_fmac_f32 v26, v8, v8
    v_fmac_f32 v27, v9, v9
    v_sub_f32 v8, v62, v24
    v_sub_f32 v9, v63, v24
    v_fmac_f32 v26, v8, v8
    v_fmac_f32 v27, v9, v9
    v_add_f32 v26, v26, v27
    s_nop 1
    v_add_f32_dpp v26, v26, v26 row_ror:8 row_mask:0xf bank_mask:0xf
    s_nop 1
    v_add_f32_dpp v26, v26, v26 row_ror:4 row_mask:0xf bank_mask:0xf
    s_nop 1
    v_add_f32_dpp v26, v26, v26 row_ror:2 row_mask:0xf bank_mask:0xf
    s_nop 1
    v_add_f32_dpp v26, v26, v26 row_ror:1 row_mask:0xf bank_mask:0xf
    v_mul_f32 v26, 0x3b000000, v26
    v_cvt_pk_bf16_f32 v26, v26, v26
    v_and_b32 v26, 0xffff0000, v26
    v_add_f32 v26, 0x3727c5ac, v26
    v_cvt_pk_bf16_f32 v26, v26, v26
    v_and_b32 v26, 0xffff0000, v26
    v_sqrt_f32 v26, v26
    s_nop 0
    v_cvt_pk_bf16_f32 v26, v26, v26
    v_and_b32 v26, 0xffff0000, v26
    v_rcp_f32 v26, v26
    v_cvt_pk_bf16_f32 v24, v24, v24
    v_and_b32 v24, 0xffff0000, v24
    s_mov_b32 s48, 0x7fffffff
    s_mov_b32 s49, 0xffff0000
    v_sub_f32 v32, v32, v24
    v_sub_f32 v33, v33, v24
    v_cvt_pk_bf16_f32 v32, v32, v33
    v_and_b32 v33, s49, v32
    v_lshlrev_b32 v32, 16, v32
    v_mul_f32 v32, v32, v26
    v_mul_f32 v33, v33, v26
    v_cvt_pk_bf16_f32 v32, v32, v33
    v_and_b32 v33, s49, v32
    v_lshlrev_b32 v32, 16, v32
    v_cvt_pkrtz_f16_f32 v8, v32, v33
    v_sub_f32 v34, v34, v24
    v_sub_f32 v35, v35, v24
    v_cvt_pk_bf16_f32 v34, v34, v35
    v_and_b32 v35, s49, v34
    v_lshlrev_b32 v34, 16, v34
    v_mul_f32 v34, v34, v26
    v_mul_f32 v35, v35, v26
    v_cvt_pk_bf16_f32 v34, v34, v35
    v_and_b32 v35, s49, v34
    v_lshlrev_b32 v34, 16, v34
    v_cvt_pkrtz_f16_f32 v9, v34, v35
    v_sub_f32 v36, v36, v24
    v_sub_f32 v37, v37, v24
    v_cvt_pk_bf16_f32 v36, v36, v37
    v_and_b32 v37, s49, v36
    v_lshlrev_b32 v36, 16, v36
    v_mul_f32 v36, v36, v26
    v_mul_f32 v37, v37, v26
    v_cvt_pk_bf16_f32 v36, v36, v37
    v_and_b32 v37, s49, v36
    v_lshlrev_b32 v36, 16, v36
    v_cvt_pkrtz_f16_f32 v10, v36, v37
    v_sub_f32 v38, v38, v24
    v_sub_f32 v39, v39, v24
    v_cvt_pk_bf16_f32 v38, v38, v39
    v_and_b32 v39, s49, v38
    v_lshlrev_b32 v38, 16, v38
    v_mul_f32 v38, v38, v26
    v_mul_f32 v39, v39, v26
    v_cvt_pk_bf16_f32 v38, v38, v39
    v_and_b32 v39, s49, v38
    v_lshlrev_b32 v38, 16, v38
    v_cvt_pkrtz_f16_f32 v11, v38, v39
    s_add_u32 s42, s43, 0
    buffer_store_dwordx4 v[8:11], v4, s[20:23], s42 offen sc1
    v_sub_f32 v40, v40, v24
    v_sub_f32 v41, v41, v24
    v_cvt_pk_bf16_f32 v40, v40, v41
    v_and_b32 v41, s49, v40
    v_lshlrev_b32 v40, 16, v40
    v_mul_f32 v40, v40, v26
    v_mul_f32 v41, v41, v26
    v_cvt_pk_bf16_f32 v40, v40, v41
    v_and_b32 v41, s49, v40
    v_lshlrev_b32 v40, 16, v40
    v_cvt_pkrtz_f16_f32 v12, v40, v41
    v_sub_f32 v42, v42, v24
    v_sub_f32 v43, v43, v24
    v_cvt_pk_bf16_f32 v42, v42, v43
    v_and_b32 v43, s49, v42
    v_lshlrev_b32 v42, 16, v42
    v_mul_f32 v42, v42, v26
    v_mul_f32 v43, v43, v26
    v_cvt_pk_bf16_f32 v42, v42, v43
    v_and_b32 v43, s49, v42
    v_lshlrev_b32 v42, 16, v42
    v_cvt_pkrtz_f16_f32 v13, v42, v43
    v_sub_f32 v44, v44, v24
    v_sub_f32 v45, v45, v24
    v_cvt_pk_bf16_f32 v44, v44, v45
    v_and_b32 v45, s49, v44
    v_lshlrev_b32 v44, 16, v44
    v_mul_f32 v44, v44, v26
    v_mul_f32 v45, v45, v26
    v_cvt_pk_bf16_f32 v44, v44, v45
    v_and_b32 v45, s49, v44
    v_lshlrev_b32 v44, 16, v44
    v_cvt_pkrtz_f16_f32 v14, v44, v45
    v_sub_f32 v46, v46, v24
    v_sub_f32 v47, v47, v24
    v_cvt_pk_bf16_f32 v46, v46, v47
    v_and_b32 v47, s49, v46
    v_lshlrev_b32 v46, 16, v46
    v_mul_f32 v46, v46, v26
    v_mul_f32 v47, v47, v26
    v_cvt_pk_bf16_f32 v46, v46, v47
    v_and_b32 v47, s49, v46
    v_lshlrev_b32 v46, 16, v46
    v_cvt_pkrtz_f16_f32 v15, v46, v47
    s_add_u32 s42, s43, 4096
    buffer_store_dwordx4 v[12:15], v4, s[20:23], s42 offen sc1
    v_sub_f32 v48, v48, v24
    v_sub_f32 v49, v49, v24
    v_cvt_pk_bf16_f32 v48, v48, v49
    v_and_b32 v49, s49, v48
    v_lshlrev_b32 v48, 16, v48
    v_mul_f32 v48, v48, v26
    v_mul_f32 v49, v49, v26
    v_cvt_pk_bf16_f32 v48, v48, v49
    v_and_b32 v49, s49, v48
    v_lshlrev_b32 v48, 16, v48
    v_cvt_pkrtz_f16_f32 v16, v48, v49
    v_sub_f32 v50, v50, v24
    v_sub_f32 v51, v51, v24
    v_cvt_pk_bf16_f32 v50, v50, v51
    v_and_b32 v51, s49, v50
    v_lshlrev_b32 v50, 16, v50
    v_mul_f32 v50, v50, v26
    v_mul_f32 v51, v51, v26
    v_cvt_pk_bf16_f32 v50, v50, v51
    v_and_b32 v51, s49, v50
    v_lshlrev_b32 v50, 16, v50
    v_cvt_pkrtz_f16_f32 v17, v50, v51
    v_sub_f32 v52, v52, v24
    v_sub_f32 v53, v53, v24
    v_cvt_pk_bf16_f32 v52, v52, v53
    v_and_b32 v53, s49, v52
    v_lshlrev_b32 v52, 16, v52
    v_mul_f32 v52, v52, v26
    v_mul_f32 v53, v53, v26
    v_cvt_pk_bf16_f32 v52, v52, v53
    v_and_b32 v53, s49, v52
    v_lshlrev_b32 v52, 16, v52
    v_cvt_pkrtz_f16_f32 v18, v52, v53
    v_sub_f32 v54, v54, v24
    v_sub_f32 v55, v55, v24
    v_cvt_pk_bf16_f32 v54, v54, v55
    v_and_b32 v55, s49, v54
    v_lshlrev_b32 v54, 16, v54
    v_mul_f32 v54, v54, v26
    v_mul_f32 v55, v55, v26
    v_cvt_pk_bf16_f32 v54, v54, v55
    v_and_b32 v55, s49, v54
    v_lshlrev_b32 v54, 16, v54
    v_cvt_pkrtz_f16_f32 v19, v54, v55
    s_add_u32 s42, s43, 8192
    buffer_store_dwordx4 v[16:19], v4, s[20:23], s42 offen sc1
    v_sub_f32 v56, v56, v24
    v_sub_f32 v57, v57, v24
    v_cvt_pk_bf16_f32 v56, v56, v57
    v_and_b32 v57, s49, v56
    v_lshlrev_b32 v56, 16, v56
    v_mul_f32 v56, v56, v26
    v_mul_f32 v57, v57, v26
    v_cvt_pk_bf16_f32 v56, v56, v57
    v_and_b32 v57, s49, v56
    v_lshlrev_b32 v56, 16, v56
    v_cvt_pkrtz_f16_f32 v20, v56, v57
    v_sub_f32 v58, v58, v24
    v_sub_f32 v59, v59, v24
    v_cvt_pk_bf16_f32 v58, v58, v59
    v_and_b32 v59, s49, v58
    v_lshlrev_b32 v58, 16, v58
    v_mul_f32 v58, v58, v26
    v_mul_f32 v59, v59, v26
    v_cvt_pk_bf16_f32 v58, v58, v59
    v_and_b32 v59, s49, v58
    v_lshlrev_b32 v58, 16, v58
    v_cvt_pkrtz_f16_f32 v21, v58, v59
    v_sub_f32 v60, v60, v24
    v_sub_f32 v61, v61, v24
    v_cvt_pk_bf16_f32 v60, v60, v61
    v_and_b32 v61, s49, v60
    v_lshlrev_b32 v60, 16, v60
    v_mul_f32 v60, v60, v26
    v_mul_f32 v61, v61, v26
    v_cvt_pk_bf16_f32 v60, v60, v61
    v_and_b32 v61, s49, v60
    v_lshlrev_b32 v60, 16, v60
    v_cvt_pkrtz_f16_f32 v22, v60, v61
    v_sub_f32 v62, v62, v24
    v_sub_f32 v63, v63, v24
    v_cvt_pk_bf16_f32 v62, v62, v63
    v_and_b32 v63, s49, v62
    v_lshlrev_b32 v62, 16, v62
    v_mul_f32 v62, v62, v26
    v_mul_f32 v63, v63, v26
    v_cvt_pk_bf16_f32 v62, v62, v63
    v_and_b32 v63, s49, v62
    v_lshlrev_b32 v62, 16, v62
    v_cvt_pkrtz_f16_f32 v23, v62, v63
    s_add_u32 s42, s43, 12288
    buffer_store_dwordx4 v[20:23], v4, s[20:23], s42 offen sc1
    s_waitcnt vmcnt(0)
    s_barrier
    s_cmp_lg_u32 s36, 0
    s_cbranch_scc1 L0_done
L0_sig:
    s_mov_b32 s16, s54
    s_mov_b32 s17, s55
    s_mov_b32 s18, 256
    s_mov_b32 s19, 0x20000
    s_cmp_ge_u32 s2, 118
    s_cselect_b32 s42, 64, 0
    s_cselect_b32 s43, 52, 53
    s_cmp_ge_u32 s2, 171
    s_cselect_b32 s42, 128, s42
    v_mov_b32 v16, 1
    v_mov_b32 v17, 0
    s_mov_b64 exec, 1
    s_waitcnt vmcnt(0)
    buffer_atomic_add v16, v17, s[16:19], s42 offen sc0
    s_waitcnt vmcnt(0)
    v_readfirstlane_b32 s42, v16
    s_cmp_lg_u32 s42, s43
    s_cbranch_scc1 L0_nl
    s_mov_b64 exec, 0xff
    v_mov_b32 v16, 1
    v_lshlrev_b32 v18, 7, v0
    s_mov_b32 s42, 126976
    buffer_atomic_add v16, v18, s[32:35], s42 offen
    s_mov_b64 exec, 1
    buffer_atomic_add v16, v17, s[16:19], 0 offen offset:192
L0_nl:
    s_mov_b64 exec, -1
L0_done:
    v_and_b32 v0, 63, v0
    s_and_b32 s38, s2, 7
    s_lshl_b32 s38, s38, 2
    s_bfe_u32 s39, s2, 0x20003
    s_add_u32 s38, s38, s39
    s_lshr_b32 s39, s2, 5
    s_lshl_b32 s37, s36, 12
    v_and_b32 v2, 15, v0
    v_lshrrev_b32 v3, 4, v0
    v_bfe_u32 v4, v0, 2, 2
    v_and_b32 v5, 3, v0
    v_lshlrev_b32 v6, 2, v3
    v_xor_b32 v6, v2, v6
    v_lshlrev_b32 v6, 4, v6
    v_lshl_add_u32 v46, v3, 13, v6
    s_waitcnt lgkmcnt(0)
    s_lshl_b32 s42, s38, 8
    s_sub_u32 s43, 4194304, s42
    s_add_u32 s20, s8, s42
    s_addc_u32 s21, s9, 0
    s_mov_b32 s22, s43
    s_mov_b32 s23, 0x20000
    s_lshl_b32 s44, s36, 17
    s_add_u32 m0, s37, 65536
    s_add_u32 s43, s44, 0
    buffer_load_dwordx4 v46, s[20:23], s43 offen lds
    s_add_u32 m0, s37, 66560
    s_add_u32 s43, s44, 32768
    buffer_load_dwordx4 v46, s[20:23], s43 offen lds
    s_add_u32 m0, s37, 67584
    s_add_u32 s43, s44, 65536
    buffer_load_dwordx4 v46, s[20:23], s43 offen lds
    s_add_u32 m0, s37, 68608
    s_add_u32 s43, s44, 98304
    buffer_load_dwordx4 v46, s[20:23], s43 offen lds
    s_add_u32 m0, s37, 16384
    s_add_u32 s43, s44, 524288
    buffer_load_dwordx4 v46, s[20:23], s43 offen lds
    s_add_u32 m0, s37, 17408
    s_add_u32 s43, s44, 557056
    buffer_load_dwordx4 v46, s[20:23], s43 offen lds
    s_add_u32 m0, s37, 18432
    s_add_u32 s43, s44, 589824
    buffer_load_dwordx4 v46, s[20:23], s43 offen lds
    s_add_u32 m0, s37, 19456
    s_add_u32 s43, s44, 622592
    buffer_load_dwordx4 v46, s[20:23], s43 offen lds
    s_add_u32 m0, s37, 81920
    s_add_u32 s43, s44, 1048576
    buffer_load_dwordx4 v46, s[20:23], s43 offen lds
    s_add_u32 m0, s37, 82944
    s_add_u32 s43, s44, 1081344
    buffer_load_dwordx4 v46, s[20:23], s43 offen lds
    s_add_u32 m0, s37, 83968
    s_add_u32 s43, s44, 1114112
    buffer_load_dwordx4 v46, s[20:23], s43 offen lds
    s_add_u32 m0, s37, 84992
    s_add_u32 s43, s44, 1146880
    buffer_load_dwordx4 v46, s[20:23], s43 offen lds
    s_add_u32 m0, s37, 32768
    s_add_u32 s43, s44, 1572864
    buffer_load_dwordx4 v46, s[20:23], s43 offen lds
    s_add_u32 m0, s37, 33792
    s_add_u32 s43, s44, 1605632
    buffer_load_dwordx4 v46, s[20:23], s43 offen lds
    s_add_u32 m0, s37, 34816
    s_add_u32 s43, s44, 1638400
    buffer_load_dwordx4 v46, s[20:23], s43 offen lds
    s_add_u32 m0, s37, 35840
    s_add_u32 s43, s44, 1671168
    buffer_load_dwordx4 v46, s[20:23], s43 offen lds
    s_add_u32 m0, s37, 98304
    s_add_u32 s43, s44, 2097152
    buffer_load_dwordx4 v46, s[20:23], s43 offen lds
    s_add_u32 m0, s37, 99328
    s_add_u32 s43, s44, 2129920
    buffer_load_dwordx4 v46, s[20:23], s43 offen lds
    s_add_u32 m0, s37, 100352
    s_add_u32 s43, s44, 2162688
    buffer_load_dwordx4 v46, s[20:23], s43 offen lds
    s_add_u32 m0, s37, 101376
    s_add_u32 s43, s44, 2195456
    buffer_load_dwordx4 v46, s[20:23], s43 offen lds
    s_add_u32 m0, s37, 49152
    s_add_u32 s43, s44, 2621440
    buffer_load_dwordx4 v46, s[20:23], s43 offen lds
    s_add_u32 m0, s37, 50176
    s_add_u32 s43, s44, 2654208
    buffer_load_dwordx4 v46, s[20:23], s43 offen lds
    s_add_u32 m0, s37, 51200
    s_add_u32 s43, s44, 2686976
    buffer_load_dwordx4 v46, s[20:23], s43 offen lds
    s_add_u32 m0, s37, 52224
    s_add_u32 s43, s44, 2719744
    buffer_load_dwordx4 v46, s[20:23], s43 offen lds
    s_add_u32 m0, s37, 114688
    s_add_u32 s43, s44, 3145728
    buffer_load_dwordx4 v46, s[20:23], s43 offen lds
    s_add_u32 m0, s37, 115712
    s_add_u32 s43, s44, 3178496
    buffer_load_dwordx4 v46, s[20:23], s43 offen lds
    s_add_u32 m0, s37, 116736
    s_add_u32 s43, s44, 3211264
    buffer_load_dwordx4 v46, s[20:23], s43 offen lds
    s_add_u32 m0, s37, 117760
    s_add_u32 s43, s44, 3244032
    buffer_load_dwordx4 v46, s[20:23], s43 offen lds
    s_add_u32 m0, s37, 131072
    s_add_u32 s43, s44, 3670016
    buffer_load_dwordx4 v46, s[20:23], s43 offen lds
    s_add_u32 m0, s37, 132096
    s_add_u32 s43, s44, 3702784
    buffer_load_dwordx4 v46, s[20:23], s43 offen lds
    s_add_u32 m0, s37, 133120
    s_add_u32 s43, s44, 3735552
    buffer_load_dwordx4 v46, s[20:23], s43 offen lds
    s_add_u32 m0, s37, 134144
    s_add_u32 s43, s44, 3768320
    buffer_load_dwordx4 v46, s[20:23], s43 offen lds
    v_lshlrev_b32 v47, 4, v0
    v_mov_b32 v8, v47
    v_add_u32 v9, 16384, v47
    v_add_u32 v10, 32768, v47
    v_add_u32 v11, 49152, v47
    s_lshl_b32 s42, s39, 18
    s_lshl_b32 s43, s36, 16
    s_add_u32 s42, s42, s43
    s_add_u32 s42, s42, 1048576
    s_add_u32 s24, s10, s42
    s_addc_u32 s25, s11, 0
    s_mov_b32 s26, 65536
    s_mov_b32 s27, 0x20000
    s_mov_b32 s28, s54
    s_mov_b32 s29, s55
    s_mov_b32 s30, 256
    s_mov_b32 s31, 0x20000
    s_lshl_b32 s42, s38, 19
    s_add_u32 s12, s4, s42
    s_addc_u32 s13, s5, 0
    s_mov_b32 s14, 524288
    s_mov_b32 s15, 0x20000
    s_add_u32 s16, s6, s42
    s_addc_u32 s17, s7, 0
    s_mov_b32 s18, 524288
    s_mov_b32 s19, 0x20000
    s_cmp_eq_u32 s36, 0
    s_cbranch_scc1 L0_nopf
    s_and_b32 s42, s39, 3
    s_mul_i32 s42, s42, 12288
    s_add_u32 s42, s42, s37
    s_sub_u32 s42, s42, 4096
    s_cmp_lt_u32 s39, 4
    s_cselect_b32 s48, s12, s16
    s_cselect_b32 s49, s13, s17
    s_mov_b32 s50, 524288
    s_mov_b32 s51, 0x20000
    buffer_load_dwordx4 a[216:219], v47, s[48:51], s42 offen offset:0
    buffer_load_dwordx4 a[220:223], v47, s[48:51], s42 offen offset:1024
    buffer_load_dwordx4 a[224:227], v47, s[48:51], s42 offen offset:2048
    buffer_load_dwordx4 a[228:231], v47, s[48:51], s42 offen offset:3072
    s_getpc_b64 s[48:49]
L0_pc:
    s_sub_u32 s48, s48, L0_pc-adaLN_cond__mha_block_cached__moe_arch_mod__prompt_kernel
    s_subb_u32 s49, s49, 0
    s_mov_b32 s50, L2_last-adaLN_cond__mha_block_cached__moe_arch_mod__prompt_kernel
    s_lshr_b32 s42, s2, 3
    s_lshl_b32 s42, s42, 1
    s_add_u32 s42, s42, s36
    s_sub_u32 s42, s42, 1
    s_lshl_b32 s42, s42, 10
    buffer_load_dwordx4 a[232:235], v47, s[48:51], s42 offen
L0_nopf:
    v_add_u32 v6, 0, v3
    v_lshlrev_b32 v6, 1, v6
    v_xor_b32 v6, v2, v6
    v_lshlrev_b32 v6, 4, v6
    v_lshl_add_u32 v44, v3, 8, v6
    v_add_u32 v6, 4, v3
    v_lshlrev_b32 v6, 1, v6
    v_xor_b32 v6, v2, v6
    v_lshlrev_b32 v6, 4, v6
    v_lshl_add_u32 v45, v3, 8, v6
    v_and_b32 v6, 7, v2
    v_lshlrev_b32 v6, 1, v6
    s_waitcnt vmcnt(33)
    v_add_u32 v7, 0, v3
    v_xor_b32 v7, v7, v6
    v_lshlrev_b32 v7, 4, v7
    v_lshl_add_u32 v32, v2, 8, v7
    v_add_u32 v7, 4, v3
    v_xor_b32 v7, v7, v6
    v_lshlrev_b32 v7, 4, v7
    v_lshl_add_u32 v33, v2, 8, v7
    v_add_u32 v7, 8, v3
    v_xor_b32 v7, v7, v6
    v_lshlrev_b32 v7, 4, v7
    v_lshl_add_u32 v34, v2, 8, v7
    v_add_u32 v7, 12, v3
    v_xor_b32 v7, v7, v6
    v_lshlrev_b32 v7, 4, v7
    v_lshl_add_u32 v35, v2, 8, v7
    v_lshl_add_u32 v6, v3, 2, v4
    v_and_b32 v7, 7, v6
    v_lshlrev_b32 v6, 8, v6
    v_lshl_add_u32 v6, v5, 3, v6
    v_add_u32 v6, 65536, v6
    v_xor_b32 v12, 0, v7
    v_lshl_add_u32 v36, v12, 5, v6
    v_xor_b32 v12, 1, v7
    v_lshl_add_u32 v37, v12, 5, v6
    v_xor_b32 v12, 2, v7
    v_lshl_add_u32 v38, v12, 5, v6
    v_xor_b32 v12, 3, v7
    v_lshl_add_u32 v39, v12, 5, v6
    v_xor_b32 v12, 4, v7
    v_lshl_add_u32 v40, v12, 5, v6
    v_xor_b32 v12, 5, v7
    v_lshl_add_u32 v41, v12, 5, v6
    v_xor_b32 v12, 6, v7
    v_lshl_add_u32 v42, v12, 5, v6
    v_xor_b32 v12, 7, v7
    v_lshl_add_u32 v43, v12, 5, v6
    v_lshl_add_u32 v6, v3, 3, v4
    v_lshlrev_b32 v6, 8, v6
    v_lshl_add_u32 v6, v5, 4, v6
    v_xor_b32 v7, 0, v4
    v_lshl_add_u32 v12, v7, 6, v6
    v_xor_b32 v7, 1, v4
    v_lshl_add_u32 v13, v7, 6, v6
    v_xor_b32 v7, 2, v4
    v_lshl_add_u32 v14, v7, 6, v6
    v_xor_b32 v7, 3, v4
    v_lshl_add_u32 v15, v7, 6, v6
    v_lshlrev_b32 v1, 5, v3
    v_add_u32 v1, 147456, v1
    v_mov_b32 v2, 0x3f803f80
    v_mov_b32 v16, 0
    v_accvgpr_write_b32 a208, v2
    v_accvgpr_write_b32 a212, 0
    v_accvgpr_write_b32 a209, v2
    v_accvgpr_write_b32 a213, 0
    v_accvgpr_write_b32 a210, v2
    v_accvgpr_write_b32 a214, 0
    v_accvgpr_write_b32 a211, v2
    v_accvgpr_write_b32 a215, 0
    v_add_u32 v4, 65536, v12
    v_add_u32 v5, 65536, v13
    v_add_u32 v6, 65536, v14
    v_add_u32 v7, 65536, v15
    v_mfma_f32_32x32x16_bf16 v[128:143], a[212:215], a[212:215], 0
    v_mfma_f32_32x32x16_bf16 v[144:159], a[212:215], a[212:215], 0
    v_mfma_f32_32x32x16_bf16 v[160:175], a[212:215], a[212:215], 0
    v_mfma_f32_32x32x16_bf16 v[176:191], a[212:215], a[212:215], 0
    v_mfma_f32_32x32x16_bf16 v[192:207], a[212:215], a[212:215], 0
    v_mfma_f32_32x32x16_bf16 v[208:223], a[212:215], a[212:215], 0
    v_mfma_f32_32x32x16_bf16 v[224:239], a[212:215], a[212:215], 0
    v_mfma_f32_32x32x16_bf16 v[240:255], a[212:215], a[212:215], 0
    s_cmp_lg_u32 s36, 0
    s_cbranch_scc1 L0_pj
    s_mov_b32 s70, 0
    s_mov_b64 exec, 1
    s_waitcnt vmcnt(32)
    v_readfirstlane_b32 s43, v100
    s_add_u32 s43, s43, 3
L0_poll:
    buffer_load_dword v3, v16, s[32:35], s53 offen sc1
    s_waitcnt vmcnt(0)
    v_readfirstlane_b32 s42, v3
    s_add_u32 s70, s70, 1
    s_cmp_eq_u32 s42, s43
    s_cbranch_scc1 L0_px
    s_and_b32 s42, s70, 15
    s_cbranch_scc1 L0_ps
    buffer_load_dword v3, v16, s[28:31], 0 offen offset:192 sc1
    s_waitcnt vmcnt(0)
    v_readfirstlane_b32 s42, v3
    s_cmp_eq_u32 s42, 3
    s_cbranch_scc1 L0_px
    s_cmp_gt_u32 s70, 0x8000
    s_cbranch_scc1 L0_px
L0_ps:
    s_sleep 1
    s_branch L0_poll
L0_px:
    s_mov_b64 exec, -1
L0_pj:
    s_barrier
    s_lshl_b32 s43, s36, 10
    s_add_u32 m0, s43, 147456
    s_nop 0
    buffer_load_dwordx4 v47, s[32:35], s43 offen sc1 lds
    buffer_load_dwordx4 v[64:67], v8, s[24:27], 0 offen offset:0 sc1
    buffer_load_dwordx4 v[68:71], v9, s[24:27], 0 offen offset:0 sc1
    buffer_load_dwordx4 v[72:75], v10, s[24:27], 0 offen offset:0 sc1
    buffer_load_dwordx4 v[76:79], v11, s[24:27], 0 offen offset:0 sc1
    buffer_load_dwordx4 v[80:83], v8, s[24:27], 0 offen offset:1024 sc1
    buffer_load_dwordx4 v[84:87], v9, s[24:27], 0 offen offset:1024 sc1
    buffer_load_dwordx4 v[88:91], v10, s[24:27], 0 offen offset:1024 sc1
    buffer_load_dwordx4 v[92:95], v11, s[24:27], 0 offen offset:1024 sc1
    buffer_load_dwordx4 v[96:99], v8, s[24:27], 0 offen offset:2048 sc1
    s_waitcnt vmcnt(42)
    buffer_load_dwordx4 v[100:103], v9, s[24:27], 0 offen offset:2048 sc1
    buffer_load_dwordx4 v[104:107], v10, s[24:27], 0 offen offset:2048 sc1
    buffer_load_dwordx4 v[108:111], v11, s[24:27], 0 offen offset:2048 sc1
    s_waitcnt vmcnt(12)
    s_barrier
    ds_read_b128 v[16:19], v1 offset:2048
    ds_read_b128 v[24:27], v1 offset:0
    ds_read_b128 v[20:23], v1 offset:2064
    ds_read_b128 v[28:31], v1 offset:16
    ds_read_b64_tr_b16 a[64:65], v4 offset:0
    ds_read_b64_tr_b16 a[66:67], v4 offset:1024
    ds_read_b64_tr_b16 a[68:69], v4 offset:8
    ds_read_b64_tr_b16 a[70:71], v4 offset:1032
    ds_read_b64_tr_b16 a[72:73], v5 offset:0
    ds_read_b64_tr_b16 a[74:75], v5 offset:1024
    ds_read_b64_tr_b16 a[76:77], v5 offset:8
    ds_read_b64_tr_b16 a[78:79], v5 offset:1032
    ds_read_b64_tr_b16 a[80:81], v6 offset:0
    ds_read_b64_tr_b16 a[82:83], v6 offset:1024
    ds_read_b64_tr_b16 a[84:85], v6 offset:8
    ds_read_b64_tr_b16 a[86:87], v6 offset:1032
    ds_read_b64_tr_b16 a[88:89], v7 offset:0
    ds_read_b64_tr_b16 a[90:91], v7 offset:1024
    ds_read_b64_tr_b16 a[92:93], v7 offset:8
    ds_read_b64_tr_b16 a[94:95], v7 offset:1032
    s_waitcnt vmcnt(11) lgkmcnt(15)
    v_fma_mix_f32 v2, v64, v16, v24 op_sel:[0,0,0] op_sel_hi:[1,0,0]
    v_fma_mix_f32 v3, v64, v17, v25 op_sel:[1,0,0] op_sel_hi:[1,0,0]
    v_cvt_pk_bf16_f32 v64, v2, v3
    v_fma_mix_f32 v2, v65, v18, v26 op_sel:[0,0,0] op_sel_hi:[1,0,0]
    v_fma_mix_f32 v3, v65, v19, v27 op_sel:[1,0,0] op_sel_hi:[1,0,0]
    v_cvt_pk_bf16_f32 v65, v2, v3
    v_fma_mix_f32 v2, v66, v20, v28 op_sel:[0,0,0] op_sel_hi:[1,0,0]
    v_fma_mix_f32 v3, v66, v21, v29 op_sel:[1,0,0] op_sel_hi:[1,0,0]
    v_cvt_pk_bf16_f32 v66, v2, v3
    v_fma_mix_f32 v2, v67, v22, v30 op_sel:[0,0,0] op_sel_hi:[1,0,0]
    v_fma_mix_f32 v3, v67, v23, v31 op_sel:[1,0,0] op_sel_hi:[1,0,0]
    v_cvt_pk_bf16_f32 v67, v2, v3
    s_waitcnt vmcnt(10)
    v_fma_mix_f32 v2, v68, v16, v24 op_sel:[0,0,0] op_sel_hi:[1,0,0]
    v_fma_mix_f32 v3, v68, v17, v25 op_sel:[1,0,0] op_sel_hi:[1,0,0]
    v_cvt_pk_bf16_f32 v68, v2, v3
    s_mov_b32 s46, 0
    s_mov_b32 s47, 0
L2_qloop:
    s_add_u32 s48, s47, 4096
    s_lshl_b32 s49, s46, 14
    s_add_u32 s50, s49, 16384
    s_add_u32 s51, s49, 81920
    s_add_u32 s52, s49, s37
    s_waitcnt lgkmcnt(14)
    v_mfma_f32_16x16x32_bf16 v[128:131], a[64:67], v[64:67], v[128:131]
    v_fma_mix_f32 v2, v69, v18, v26 op_sel:[0,0,0] op_sel_hi:[1,0,0]
    v_fma_mix_f32 v3, v69, v19, v27 op_sel:[1,0,0] op_sel_hi:[1,0,0]
    s_waitcnt lgkmcnt(12)
    v_mfma_f32_16x16x32_bf16 v[144:147], a[68:71], v[64:67], v[144:147]
    ds_read_b64_tr_b16 a[96:97], v4 offset:8192
    buffer_load_dwordx4 v[112:115], v8, s[24:27], s47 offen offset:3072 sc1
    buffer_load_dwordx4 v[116:119], v9, s[24:27], s47 offen offset:3072 sc1
    v_cvt_pk_bf16_f32 v69, v2, v3
    s_waitcnt lgkmcnt(11)
    v_mfma_f32_16x16x32_bf16 v[160:163], a[72:75], v[64:67], v[160:163]
    v_fma_mix_f32 v2, v70, v20, v28 op_sel:[0,0,0] op_sel_hi:[1,0,0]
    v_fma_mix_f32 v3, v70, v21, v29 op_sel:[1,0,0] op_sel_hi:[1,0,0]
    s_waitcnt lgkmcnt(9)
    v_mfma_f32_16x16x32_bf16 v[176:179], a[76:79], v[64:67], v[176:179]
    ds_read_b64_tr_b16 a[98:99], v4 offset:9216
    ds_read_b64_tr_b16 a[100:101], v4 offset:8200
    v_cvt_pk_bf16_f32 v70, v2, v3
    s_waitcnt lgkmcnt(9)
    v_mfma_f32_16x16x32_bf16 v[192:195], a[80:83], v[64:67], v[192:195]
    v_fma_mix_f32 v2, v71, v22, v30 op_sel:[0,0,0] op_sel_hi:[1,0,0]
    v_fma_mix_f32 v3, v71, v23, v31 op_sel:[1,0,0] op_sel_hi:[1,0,0]
    s_waitcnt lgkmcnt(7)
    v_mfma_f32_16x16x32_bf16 v[208:211], a[84:87], v[64:67], v[208:211]
    ds_read_b64_tr_b16 a[102:103], v4 offset:9224
    ds_read_b128 v[48:51], v1 offset:2176
    v_cvt_pk_bf16_f32 v71, v2, v3
    s_waitcnt lgkmcnt(7)
    v_mfma_f32_16x16x32_bf16 v[224:227], a[88:91], v[64:67], v[224:227]
    s_waitcnt vmcnt(11)
    v_fma_mix_f32 v2, v72, v16, v24 op_sel:[0,0,0] op_sel_hi:[1,0,0]
    v_fma_mix_f32 v3, v72, v17, v25 op_sel:[1,0,0] op_sel_hi:[1,0,0]
    s_waitcnt lgkmcnt(5)
    v_mfma_f32_16x16x32_bf16 v[240:243], a[92:95], v[64:67], v[240:243]
    ds_read_b64_tr_b16 a[104:105], v5 offset:8192
    ds_read_b64_tr_b16 a[106:107], v5 offset:9216
    v_cvt_pk_bf16_f32 v72, v2, v3
    v_mfma_f32_16x16x32_bf16 v[132:135], a[64:67], v[68:71], v[132:135]
    v_fma_mix_f32 v2, v73, v18, v26 op_sel:[0,0,0] op_sel_hi:[1,0,0]
    v_fma_mix_f32 v3, v73, v19, v27 op_sel:[1,0,0] op_sel_hi:[1,0,0]
    v_mfma_f32_16x16x32_bf16 v[148:151], a[68:71], v[68:71], v[148:151]
    ds_read_b64_tr_b16 a[108:109], v5 offset:8200
    v_cvt_pk_bf16_f32 v73, v2, v3
    v_mfma_f32_16x16x32_bf16 v[164:167], a[72:75], v[68:71], v[164:167]
    v_fma_mix_f32 v2, v74, v20, v28 op_sel:[0,0,0] op_sel_hi:[1,0,0]
    v_fma_mix_f32 v3, v74, v21, v29 op_sel:[1,0,0] op_sel_hi:[1,0,0]
    v_mfma_f32_16x16x32_bf16 v[180:183], a[76:79], v[68:71], v[180:183]
    ds_read_b64_tr_b16 a[110:111], v5 offset:9224
    ds_read_b128 v[56:59], v1 offset:128
    v_cvt_pk_bf16_f32 v74, v2, v3
    v_mfma_f32_16x16x32_bf16 v[196:199], a[80:83], v[68:71], v[196:199]
    v_fma_mix_f32 v2, v75, v22, v30 op_sel:[0,0,0] op_sel_hi:[1,0,0]
    v_fma_mix_f32 v3, v75, v23, v31 op_sel:[1,0,0] op_sel_hi:[1,0,0]
    v_mfma_f32_16x16x32_bf16 v[212:215], a[84:87], v[68:71], v[212:215]
    ds_read_b64_tr_b16 a[112:113], v6 offset:8192
    v_cvt_pk_bf16_f32 v75, v2, v3
    v_mfma_f32_16x16x32_bf16 v[228:231], a[88:91], v[68:71], v[228:231]
    s_waitcnt vmcnt(10)
    v_fma_mix_f32 v2, v76, v16, v24 op_sel:[0,0,0] op_sel_hi:[1,0,0]
    v_fma_mix_f32 v3, v76, v17, v25 op_sel:[1,0,0] op_sel_hi:[1,0,0]
    v_mfma_f32_16x16x32_bf16 v[244:247], a[92:95], v[68:71], v[244:247]
    ds_read_b64_tr_b16 a[114:115], v6 offset:9216
    ds_read_b128 v[52:55], v1 offset:2192
    v_cvt_pk_bf16_f32 v76, v2, v3
    v_mfma_f32_16x16x32_bf16 v[136:139], a[64:67], v[72:75], v[136:139]
    v_fma_mix_f32 v2, v77, v18, v26 op_sel:[0,0,0] op_sel_hi:[1,0,0]
    v_fma_mix_f32 v3, v77, v19, v27 op_sel:[1,0,0] op_sel_hi:[1,0,0]
    v_mfma_f32_16x16x32_bf16 v[152:155], a[68:71], v[72:75], v[152:155]
    ds_read_b64_tr_b16 a[116:117], v6 offset:8200
    buffer_load_dwordx4 v[120:123], v10, s[24:27], s47 offen offset:3072 sc1
    buffer_load_dwordx4 v[124:127], v11, s[24:27], s47 offen offset:3072 sc1
    ds_read_b128 v[60:63], v1 offset:144
    v_cvt_pk_bf16_f32 v77, v2, v3
    v_mfma_f32_16x16x32_bf16 v[168:171], a[72:75], v[72:75], v[168:171]
    v_fma_mix_f32 v2, v78, v20, v28 op_sel:[0,0,0] op_sel_hi:[1,0,0]
    v_fma_mix_f32 v3, v78, v21, v29 op_sel:[1,0,0] op_sel_hi:[1,0,0]
    v_mfma_f32_16x16x32_bf16 v[184:187], a[76:79], v[72:75], v[184:187]
    ds_read_b64_tr_b16 a[118:119], v6 offset:9224
    v_cvt_pk_bf16_f32 v78, v2, v3
    v_mfma_f32_16x16x32_bf16 v[200:203], a[80:83], v[72:75], v[200:203]
    s_waitcnt lgkmcnt(2)
    v_fma_mix_f32 v2, v79, v22, v30 op_sel:[0,0,0] op_sel_hi:[1,0,0]
    v_fma_mix_f32 v3, v79, v23, v31 op_sel:[1,0,0] op_sel_hi:[1,0,0]
    v_mfma_f32_16x16x32_bf16 v[216:219], a[84:87], v[72:75], v[216:219]
    ds_read_b64_tr_b16 a[120:121], v7 offset:8192
    v_cvt_pk_bf16_f32 v79, v2, v3
    v_mfma_f32_16x16x32_bf16 v[232:235], a[88:91], v[72:75], v[232:235]
    s_waitcnt vmcnt(11)
    v_fma_mix_f32 v2, v80, v48, v56 op_sel:[0,0,0] op_sel_hi:[1,0,0]
    v_fma_mix_f32 v3, v80, v49, v57 op_sel:[1,0,0] op_sel_hi:[1,0,0]
    v_mfma_f32_16x16x32_bf16 v[248:251], a[92:95], v[72:75], v[248:251]
    ds_read_b64_tr_b16 a[122:123], v7 offset:9216
    v_cvt_pk_bf16_f32 v80, v2, v3
    v_mfma_f32_16x16x32_bf16 v[140:143], a[64:67], v[76:79], v[140:143]
    v_fma_mix_f32 v2, v81, v50, v58 op_sel:[0,0,0] op_sel_hi:[1,0,0]
    v_fma_mix_f32 v3, v81, v51, v59 op_sel:[1,0,0] op_sel_hi:[1,0,0]
    v_mfma_f32_16x16x32_bf16 v[156:159], a[68:71], v[76:79], v[156:159]
    ds_read_b64_tr_b16 a[124:125], v7 offset:8200
    v_cvt_pk_bf16_f32 v81, v2, v3
    v_mfma_f32_16x16x32_bf16 v[172:175], a[72:75], v[76:79], v[172:175]
    s_waitcnt lgkmcnt(4)
    v_fma_mix_f32 v2, v82, v52, v60 op_sel:[0,0,0] op_sel_hi:[1,0,0]
    v_fma_mix_f32 v3, v82, v53, v61 op_sel:[1,0,0] op_sel_hi:[1,0,0]
    v_mfma_f32_16x16x32_bf16 v[188:191], a[76:79], v[76:79], v[188:191]
    ds_read_b64_tr_b16 a[126:127], v7 offset:9224
    v_cvt_pk_bf16_f32 v82, v2, v3
    v_mfma_f32_16x16x32_bf16 v[204:207], a[80:83], v[76:79], v[204:207]
    v_fma_mix_f32 v2, v83, v54, v62 op_sel:[0,0,0] op_sel_hi:[1,0,0]
    v_fma_mix_f32 v3, v83, v55, v63 op_sel:[1,0,0] op_sel_hi:[1,0,0]
    v_mfma_f32_16x16x32_bf16 v[220:223], a[84:87], v[76:79], v[220:223]
    v_cvt_pk_bf16_f32 v83, v2, v3
    v_mfma_f32_16x16x32_bf16 v[236:239], a[88:91], v[76:79], v[236:239]
    s_waitcnt lgkmcnt(0)
    s_waitcnt vmcnt(10)
    v_fma_mix_f32 v2, v84, v48, v56 op_sel:[0,0,0] op_sel_hi:[1,0,0]
    v_fma_mix_f32 v3, v84, v49, v57 op_sel:[1,0,0] op_sel_hi:[1,0,0]
    v_mfma_f32_16x16x32_bf16 v[252:255], a[92:95], v[76:79], v[252:255]
    v_cvt_pk_bf16_f32 v84, v2, v3
    v_add_u32 v4, s50, v12
    v_add_u32 v5, s50, v13
    v_add_u32 v6, s50, v14
    v_add_u32 v7, s50, v15
    v_mfma_f32_16x16x32_bf16 v[128:131], a[96:99], v[80:83], v[128:131]
    v_fma_mix_f32 v2, v85, v50, v58 op_sel:[0,0,0] op_sel_hi:[1,0,0]
    v_fma_mix_f32 v3, v85, v51, v59 op_sel:[1,0,0] op_sel_hi:[1,0,0]
    v_mfma_f32_16x16x32_bf16 v[144:147], a[100:103], v[80:83], v[144:147]
    ds_read_b64_tr_b16 a[64:65], v4 offset:0
    buffer_load_dwordx4 v[64:67], v8, s[24:27], s48 offen offset:0 sc1
    buffer_load_dwordx4 v[68:71], v9, s[24:27], s48 offen offset:0 sc1
    v_cvt_pk_bf16_f32 v85, v2, v3
    v_mfma_f32_16x16x32_bf16 v[160:163], a[104:107], v[80:83], v[160:163]
    v_fma_mix_f32 v2, v86, v52, v60 op_sel:[0,0,0] op_sel_hi:[1,0,0]
    v_fma_mix_f32 v3, v86, v53, v61 op_sel:[1,0,0] op_sel_hi:[1,0,0]
    v_mfma_f32_16x16x32_bf16 v[176:179], a[108:111], v[80:83], v[176:179]
    ds_read_b64_tr_b16 a[66:67], v4 offset:1024
    ds_read_b64_tr_b16 a[68:69], v4 offset:8
    v_cvt_pk_bf16_f32 v86, v2, v3
    v_mfma_f32_16x16x32_bf16 v[192:195], a[112:115], v[80:83], v[192:195]
    v_fma_mix_f32 v2, v87, v54, v62 op_sel:[0,0,0] op_sel_hi:[1,0,0]
    v_fma_mix_f32 v3, v87, v55, v63 op_sel:[1,0,0] op_sel_hi:[1,0,0]
    v_mfma_f32_16x16x32_bf16 v[208:211], a[116:119], v[80:83], v[208:211]
    ds_read_b64_tr_b16 a[70:71], v4 offset:1032
    ds_read_b128 v[16:19], v1 offset:2304
    v_cvt_pk_bf16_f32 v87, v2, v3
    v_mfma_f32_16x16x32_bf16 v[224:227], a[120:123], v[80:83], v[224:227]
    s_waitcnt vmcnt(11)
    v_fma_mix_f32 v2, v88, v48, v56 op_sel:[0,0,0] op_sel_hi:[1,0,0]
    v_fma_mix_f32 v3, v88, v49, v57 op_sel:[1,0,0] op_sel_hi:[1,0,0]
    v_mfma_f32_16x16x32_bf16 v[240:243], a[124:127], v[80:83], v[240:243]
    ds_read_b64_tr_b16 a[72:73], v5 offset:0
    ds_read_b64_tr_b16 a[74:75], v5 offset:1024
    v_cvt_pk_bf16_f32 v88, v2, v3
    v_mfma_f32_16x16x32_bf16 v[132:135], a[96:99], v[84:87], v[132:135]
    v_fma_mix_f32 v2, v89, v50, v58 op_sel:[0,0,0] op_sel_hi:[1,0,0]
    v_fma_mix_f32 v3, v89, v51, v59 op_sel:[1,0,0] op_sel_hi:[1,0,0]
    v_mfma_f32_16x16x32_bf16 v[148:151], a[100:103], v[84:87], v[148:151]
    ds_read_b64_tr_b16 a[76:77], v5 offset:8
    v_cvt_pk_bf16_f32 v89, v2, v3
    v_mfma_f32_16x16x32_bf16 v[164:167], a[104:107], v[84:87], v[164:167]
    v_fma_mix_f32 v2, v90, v52, v60 op_sel:[0,0,0] op_sel_hi:[1,0,0]
    v_fma_mix_f32 v3, v90, v53, v61 op_sel:[1,0,0] op_sel_hi:[1,0,0]
    v_mfma_f32_16x16x32_bf16 v[180:183], a[108:111], v[84:87], v[180:183]
    ds_read_b64_tr_b16 a[78:79], v5 offset:1032
    ds_read_b128 v[24:27], v1 offset:256
    v_cvt_pk_bf16_f32 v90, v2, v3
    v_mfma_f32_16x16x32_bf16 v[196:199], a[112:115], v[84:87], v[196:199]
    v_fma_mix_f32 v2, v91, v54, v62 op_sel:[0,0,0] op_sel_hi:[1,0,0]
    v_fma_mix_f32 v3, v91, v55, v63 op_sel:[1,0,0] op_sel_hi:[1,0,0]
    v_mfma_f32_16x16x32_bf16 v[212:215], a[116:119], v[84:87], v[212:215]
    ds_read_b64_tr_b16 a[80:81], v6 offset:0
    v_cvt_pk_bf16_f32 v91, v2, v3
    v_mfma_f32_16x16x32_bf16 v[228:231], a[120:123], v[84:87], v[228:231]
    s_waitcnt vmcnt(10)
    v_fma_mix_f32 v2, v92, v48, v56 op_sel:[0,0,0] op_sel_hi:[1,0,0]
    v_fma_mix_f32 v3, v92, v49, v57 op_sel:[1,0,0] op_sel_hi:[1,0,0]
    v_mfma_f32_16x16x32_bf16 v[244:247], a[124:127], v[84:87], v[244:247]
    ds_read_b64_tr_b16 a[82:83], v6 offset:1024
    ds_read_b128 v[20:23], v1 offset:2320
    v_cvt_pk_bf16_f32 v92, v2, v3
    v_mfma_f32_16x16x32_bf16 v[136:139], a[96:99], v[88:91], v[136:139]
    v_fma_mix_f32 v2, v93, v50, v58 op_sel:[0,0,0] op_sel_hi:[1,0,0]
    v_fma_mix_f32 v3, v93, v51, v59 op_sel:[1,0,0] op_sel_hi:[1,0,0]
    v_mfma_f32_16x16x32_bf16 v[152:155], a[100:103], v[88:91], v[152:155]
    ds_read_b64_tr_b16 a[84:85], v6 offset:8
    buffer_load_dwordx4 v[72:75], v10, s[24:27], s48 offen offset:0 sc1
    buffer_load_dwordx4 v[76:79], v11, s[24:27], s48 offen offset:0 sc1
    ds_read_b128 v[28:31], v1 offset:272
    v_cvt_pk_bf16_f32 v93, v2, v3
    v_mfma_f32_16x16x32_bf16 v[168:171], a[104:107], v[88:91], v[168:171]
    v_fma_mix_f32 v2, v94, v52, v60 op_sel:[0,0,0] op_sel_hi:[1,0,0]
    v_fma_mix_f32 v3, v94, v53, v61 op_sel:[1,0,0] op_sel_hi:[1,0,0]
    v_mfma_f32_16x16x32_bf16 v[184:187], a[108:111], v[88:91], v[184:187]
    ds_read_b64_tr_b16 a[86:87], v6 offset:1032
    v_cvt_pk_bf16_f32 v94, v2, v3
    v_mfma_f32_16x16x32_bf16 v[200:203], a[112:115], v[88:91], v[200:203]
    s_waitcnt lgkmcnt(2)
    v_fma_mix_f32 v2, v95, v54, v62 op_sel:[0,0,0] op_sel_hi:[1,0,0]
    v_fma_mix_f32 v3, v95, v55, v63 op_sel:[1,0,0] op_sel_hi:[1,0,0]
    v_mfma_f32_16x16x32_bf16 v[216:219], a[116:119], v[88:91], v[216:219]
    ds_read_b64_tr_b16 a[88:89], v7 offset:0
    v_cvt_pk_bf16_f32 v95, v2, v3
    v_mfma_f32_16x16x32_bf16 v[232:235], a[120:123], v[88:91], v[232:235]
    s_waitcnt vmcnt(11)
    v_fma_mix_f32 v2, v96, v16, v24 op_sel:[0,0,0] op_sel_hi:[1,0,0]
    v_fma_mix_f32 v3, v96, v17, v25 op_sel:[1,0,0] op_sel_hi:[1,0,0]
    v_mfma_f32_16x16x32_bf16 v[248:251], a[124:127], v[88:91], v[248:251]
    ds_read_b64_tr_b16 a[90:91], v7 offset:1024
    v_cvt_pk_bf16_f32 v96, v2, v3
    v_mfma_f32_16x16x32_bf16 v[140:143], a[96:99], v[92:95], v[140:143]
    v_fma_mix_f32 v2, v97, v18, v26 op_sel:[0,0,0] op_sel_hi:[1,0,0]
    v_fma_mix_f32 v3, v97, v19, v27 op_sel:[1,0,0] op_sel_hi:[1,0,0]
    v_mfma_f32_16x16x32_bf16 v[156:159], a[100:103], v[92:95], v[156:159]
    ds_read_b64_tr_b16 a[92:93], v7 offset:8
    v_cvt_pk_bf16_f32 v97, v2, v3
    v_mfma_f32_16x16x32_bf16 v[172:175], a[104:107], v[92:95], v[172:175]
    s_waitcnt lgkmcnt(4)
    v_fma_mix_f32 v2, v98, v20, v28 op_sel:[0,0,0] op_sel_hi:[1,0,0]
    v_fma_mix_f32 v3, v98, v21, v29 op_sel:[1,0,0] op_sel_hi:[1,0,0]
    v_mfma_f32_16x16x32_bf16 v[188:191], a[108:111], v[92:95], v[188:191]
    ds_read_b64_tr_b16 a[94:95], v7 offset:1032
    v_cvt_pk_bf16_f32 v98, v2, v3
    v_mfma_f32_16x16x32_bf16 v[204:207], a[112:115], v[92:95], v[204:207]
    v_fma_mix_f32 v2, v99, v22, v30 op_sel:[0,0,0] op_sel_hi:[1,0,0]
    v_fma_mix_f32 v3, v99, v23, v31 op_sel:[1,0,0] op_sel_hi:[1,0,0]
    v_mfma_f32_16x16x32_bf16 v[220:223], a[116:119], v[92:95], v[220:223]
    v_cvt_pk_bf16_f32 v99, v2, v3
    v_mfma_f32_16x16x32_bf16 v[236:239], a[120:123], v[92:95], v[236:239]
    s_waitcnt lgkmcnt(0)
    s_waitcnt vmcnt(10)
    v_fma_mix_f32 v2, v100, v16, v24 op_sel:[0,0,0] op_sel_hi:[1,0,0]
    v_fma_mix_f32 v3, v100, v17, v25 op_sel:[1,0,0] op_sel_hi:[1,0,0]
    v_mfma_f32_16x16x32_bf16 v[252:255], a[124:127], v[92:95], v[252:255]
    v_cvt_pk_bf16_f32 v100, v2, v3
    v_mfma_f32_16x16x32_bf16 v[128:131], a[64:67], v[96:99], v[128:131]
    v_fma_mix_f32 v2, v101, v18, v26 op_sel:[0,0,0] op_sel_hi:[1,0,0]
    v_fma_mix_f32 v3, v101, v19, v27 op_sel:[1,0,0] op_sel_hi:[1,0,0]
    v_mfma_f32_16x16x32_bf16 v[144:147], a[68:71], v[96:99], v[144:147]
    ds_read_b64_tr_b16 a[96:97], v4 offset:8192
    buffer_load_dwordx4 v[80:83], v8, s[24:27], s48 offen offset:1024 sc1
    buffer_load_dwordx4 v[84:87], v9, s[24:27], s48 offen offset:1024 sc1
    v_cvt_pk_bf16_f32 v101, v2, v3
    v_mfma_f32_16x16x32_bf16 v[160:163], a[72:75], v[96:99], v[160:163]
    v_fma_mix_f32 v2, v102, v20, v28 op_sel:[0,0,0] op_sel_hi:[1,0,0]
    v_fma_mix_f32 v3, v102, v21, v29 op_sel:[1,0,0] op_sel_hi:[1,0,0]
    v_mfma_f32_16x16x32_bf16 v[176:179], a[76:79], v[96:99], v[176:179]
    ds_read_b64_tr_b16 a[98:99], v4 offset:9216
    ds_read_b64_tr_b16 a[100:101], v4 offset:8200
    v_cvt_pk_bf16_f32 v102, v2, v3
    v_mfma_f32_16x16x32_bf16 v[192:195], a[80:83], v[96:99], v[192:195]
    v_fma_mix_f32 v2, v103, v22, v30 op_sel:[0,0,0] op_sel_hi:[1,0,0]
    v_fma_mix_f32 v3, v103, v23, v31 op_sel:[1,0,0] op_sel_hi:[1,0,0]
    v_mfma_f32_16x16x32_bf16 v[208:211], a[84:87], v[96:99], v[208:211]
    ds_read_b64_tr_b16 a[102:103], v4 offset:9224
    ds_read_b128 v[48:51], v1 offset:2432
    v_cvt_pk_bf16_f32 v103, v2, v3
    v_mfma_f32_16x16x32_bf16 v[224:227], a[88:91], v[96:99], v[224:227]
    s_waitcnt vmcnt(11)
    v_fma_mix_f32 v2, v104, v16, v24 op_sel:[0,0,0] op_sel_hi:[1,0,0]
    v_fma_mix_f32 v3, v104, v17, v25 op_sel:[1,0,0] op_sel_hi:[1,0,0]
    v_mfma_f32_16x16x32_bf16 v[240:243], a[92:95], v[96:99], v[240:243]
    ds_read_b64_tr_b16 a[104:105], v5 offset:8192
    ds_read_b64_tr_b16 a[106:107], v5 offset:9216
    v_cvt_pk_bf16_f32 v104, v2, v3
    s_add_u32 m0, s52, 0
    s_mov_b32 s40, s52
    v_mfma_f32_16x16x32_bf16 v[132:135], a[64:67], v[100:103], v[132:135]
    v_fma_mix_f32 v2, v105, v18, v26 op_sel:[0,0,0] op_sel_hi:[1,0,0]
    v_fma_mix_f32 v3, v105, v19, v27 op_sel:[1,0,0] op_sel_hi:[1,0,0]
    v_mfma_f32_16x16x32_bf16 v[148:151], a[68:71], v[100:103], v[148:151]
    ds_read_b64_tr_b16 a[108:109], v5 offset:8200
    buffer_load_dwordx4 v44, s[12:15], s40 offen offset:0 sc1 lds
    buffer_load_dwordx4 v45, s[12:15], s40 offen offset:1024 sc1 lds
    v_cvt_pk_bf16_f32 v105, v2, v3
    v_mfma_f32_16x16x32_bf16 v[164:167], a[72:75], v[100:103], v[164:167]
    v_fma_mix_f32 v2, v106, v20, v28 op_sel:[0,0,0] op_sel_hi:[1,0,0]
    v_fma_mix_f32 v3, v106, v21, v29 op_sel:[1,0,0] op_sel_hi:[1,0,0]
    v_mfma_f32_16x16x32_bf16 v[180:183], a[76:79], v[100:103], v[180:183]
    ds_read_b64_tr_b16 a[110:111], v5 offset:9224
    ds_read_b128 v[56:59], v1 offset:384
    v_cvt_pk_bf16_f32 v106, v2, v3
    v_mfma_f32_16x16x32_bf16 v[196:199], a[80:83], v[100:103], v[196:199]
    v_fma_mix_f32 v2, v107, v22, v30 op_sel:[0,0,0] op_sel_hi:[1,0,0]
    v_fma_mix_f32 v3, v107, v23, v31 op_sel:[1,0,0] op_sel_hi:[1,0,0]
    v_mfma_f32_16x16x32_bf16 v[212:215], a[84:87], v[100:103], v[212:215]
    ds_read_b64_tr_b16 a[112:113], v6 offset:8192
    v_cvt_pk_bf16_f32 v107, v2, v3
    v_mfma_f32_16x16x32_bf16 v[228:231], a[88:91], v[100:103], v[228:231]
    s_waitcnt vmcnt(12)
    v_fma_mix_f32 v2, v108, v16, v24 op_sel:[0,0,0] op_sel_hi:[1,0,0]
    v_fma_mix_f32 v3, v108, v17, v25 op_sel:[1,0,0] op_sel_hi:[1,0,0]
    v_mfma_f32_16x16x32_bf16 v[244:247], a[92:95], v[100:103], v[244:247]
    ds_read_b64_tr_b16 a[114:115], v6 offset:9216
    ds_read_b128 v[52:55], v1 offset:2448
    v_cvt_pk_bf16_f32 v108, v2, v3
    v_mfma_f32_16x16x32_bf16 v[136:139], a[64:67], v[104:107], v[136:139]
    v_fma_mix_f32 v2, v109, v18, v26 op_sel:[0,0,0] op_sel_hi:[1,0,0]
    v_fma_mix_f32 v3, v109, v19, v27 op_sel:[1,0,0] op_sel_hi:[1,0,0]
    v_mfma_f32_16x16x32_bf16 v[152:155], a[68:71], v[104:107], v[152:155]
    ds_read_b64_tr_b16 a[116:117], v6 offset:8200
    buffer_load_dwordx4 v[88:91], v10, s[24:27], s48 offen offset:1024 sc1
    buffer_load_dwordx4 v[92:95], v11, s[24:27], s48 offen offset:1024 sc1
    ds_read_b128 v[60:63], v1 offset:400
    v_cvt_pk_bf16_f32 v109, v2, v3
    v_mfma_f32_16x16x32_bf16 v[168:171], a[72:75], v[104:107], v[168:171]
    v_fma_mix_f32 v2, v110, v20, v28 op_sel:[0,0,0] op_sel_hi:[1,0,0]
    v_fma_mix_f32 v3, v110, v21, v29 op_sel:[1,0,0] op_sel_hi:[1,0,0]
    v_mfma_f32_16x16x32_bf16 v[184:187], a[76:79], v[104:107], v[184:187]
    ds_read_b64_tr_b16 a[118:119], v6 offset:9224
    v_cvt_pk_bf16_f32 v110, v2, v3
    v_mfma_f32_16x16x32_bf16 v[200:203], a[80:83], v[104:107], v[200:203]
    s_waitcnt lgkmcnt(2)
    v_fma_mix_f32 v2, v111, v22, v30 op_sel:[0,0,0] op_sel_hi:[1,0,0]
    v_fma_mix_f32 v3, v111, v23, v31 op_sel:[1,0,0] op_sel_hi:[1,0,0]
    v_mfma_f32_16x16x32_bf16 v[216:219], a[84:87], v[104:107], v[216:219]
    ds_read_b64_tr_b16 a[120:121], v7 offset:8192
    v_cvt_pk_bf16_f32 v111, v2, v3
    v_mfma_f32_16x16x32_bf16 v[232:235], a[88:91], v[104:107], v[232:235]
    s_waitcnt vmcnt(13)
    v_fma_mix_f32 v2, v112, v48, v56 op_sel:[0,0,0] op_sel_hi:[1,0,0]
    v_fma_mix_f32 v3, v112, v49, v57 op_sel:[1,0,0] op_sel_hi:[1,0,0]
    v_mfma_f32_16x16x32_bf16 v[248:251], a[92:95], v[104:107], v[248:251]
    ds_read_b64_tr_b16 a[122:123], v7 offset:9216
    v_cvt_pk_bf16_f32 v112, v2, v3
    v_mfma_f32_16x16x32_bf16 v[140:143], a[64:67], v[108:111], v[140:143]
    v_fma_mix_f32 v2, v113, v50, v58 op_sel:[0,0,0] op_sel_hi:[1,0,0]
    v_fma_mix_f32 v3, v113, v51, v59 op_sel:[1,0,0] op_sel_hi:[1,0,0]
    v_mfma_f32_16x16x32_bf16 v[156:159], a[68:71], v[108:111], v[156:159]
    ds_read_b64_tr_b16 a[124:125], v7 offset:8200
    buffer_load_dwordx4 v44, s[12:15], s40 offen offset:2048 sc1 lds
    buffer_load_dwordx4 v45, s[12:15], s40 offen offset:3072 sc1 lds
    v_cvt_pk_bf16_f32 v113, v2, v3
    v_mfma_f32_16x16x32_bf16 v[172:175], a[72:75], v[108:111], v[172:175]
    s_waitcnt lgkmcnt(4)
    v_fma_mix_f32 v2, v114, v52, v60 op_sel:[0,0,0] op_sel_hi:[1,0,0]
    v_fma_mix_f32 v3, v114, v53, v61 op_sel:[1,0,0] op_sel_hi:[1,0,0]
    v_mfma_f32_16x16x32_bf16 v[188:191], a[76:79], v[108:111], v[188:191]
    ds_read_b64_tr_b16 a[126:127], v7 offset:9224
    v_cvt_pk_bf16_f32 v114, v2, v3
    v_mfma_f32_16x16x32_bf16 v[204:207], a[80:83], v[108:111], v[204:207]
    v_fma_mix_f32 v2, v115, v54, v62 op_sel:[0,0,0] op_sel_hi:[1,0,0]
    v_fma_mix_f32 v3, v115, v55, v63 op_sel:[1,0,0] op_sel_hi:[1,0,0]
    v_mfma_f32_16x16x32_bf16 v[220:223], a[84:87], v[108:111], v[220:223]
    v_cvt_pk_bf16_f32 v115, v2, v3
    v_mfma_f32_16x16x32_bf16 v[236:239], a[88:91], v[108:111], v[236:239]
    s_waitcnt lgkmcnt(0)
    s_waitcnt vmcnt(14)
    v_fma_mix_f32 v2, v116, v48, v56 op_sel:[0,0,0] op_sel_hi:[1,0,0]
    v_fma_mix_f32 v3, v116, v49, v57 op_sel:[1,0,0] op_sel_hi:[1,0,0]
    v_mfma_f32_16x16x32_bf16 v[252:255], a[92:95], v[108:111], v[252:255]
    v_cvt_pk_bf16_f32 v116, v2, v3
    v_add_u32 v4, s51, v12
    v_add_u32 v5, s51, v13
    v_add_u32 v6, s51, v14
    v_add_u32 v7, s51, v15
    v_mfma_f32_16x16x32_bf16 v[128:131], a[96:99], v[112:115], v[128:131]
    v_fma_mix_f32 v2, v117, v50, v58 op_sel:[0,0,0] op_sel_hi:[1,0,0]
    v_fma_mix_f32 v3, v117, v51, v59 op_sel:[1,0,0] op_sel_hi:[1,0,0]
    v_mfma_f32_16x16x32_bf16 v[144:147], a[100:103], v[112:115], v[144:147]
    ds_read_b64_tr_b16 a[64:65], v4 offset:0
    buffer_load_dwordx4 v[96:99], v8, s[24:27], s48 offen offset:2048 sc1
    buffer_load_dwordx4 v[100:103], v9, s[24:27], s48 offen offset:2048 sc1
    v_cvt_pk_bf16_f32 v117, v2, v3
    v_mfma_f32_16x16x32_bf16 v[160:163], a[104:107], v[112:115], v[160:163]
    v_fma_mix_f32 v2, v118, v52, v60 op_sel:[0,0,0] op_sel_hi:[1,0,0]
    v_fma_mix_f32 v3, v118, v53, v61 op_sel:[1,0,0] op_sel_hi:[1,0,0]
    v_mfma_f32_16x16x32_bf16 v[176:179], a[108:111], v[112:115], v[176:179]
    ds_read_b64_tr_b16 a[66:67], v4 offset:1024
    ds_read_b64_tr_b16 a[68:69], v4 offset:8
    v_cvt_pk_bf16_f32 v118, v2, v3
    s_waitcnt lgkmcnt(0)
    s_barrier
    v_mfma_f32_16x16x32_bf16 v[192:195], a[112:115], v[112:115], v[192:195]
    v_fma_mix_f32 v2, v119, v54, v62 op_sel:[0,0,0] op_sel_hi:[1,0,0]
    v_fma_mix_f32 v3, v119, v55, v63 op_sel:[1,0,0] op_sel_hi:[1,0,0]
    v_mfma_f32_16x16x32_bf16 v[208:211], a[116:119], v[112:115], v[208:211]
    ds_read_b64_tr_b16 a[70:71], v4 offset:1032
    ds_read_b128 v[16:19], v1 offset:2560
    v_cvt_pk_bf16_f32 v119, v2, v3
    v_mfma_f32_16x16x32_bf16 v[224:227], a[120:123], v[112:115], v[224:227]
    s_waitcnt vmcnt(15)
    v_fma_mix_f32 v2, v120, v48, v56 op_sel:[0,0,0] op_sel_hi:[1,0,0]
    v_fma_mix_f32 v3, v120, v49, v57 op_sel:[1,0,0] op_sel_hi:[1,0,0]
    v_mfma_f32_16x16x32_bf16 v[240:243], a[124:127], v[112:115], v[240:243]
    ds_read_b64_tr_b16 a[72:73], v5 offset:0
    ds_read_b64_tr_b16 a[74:75], v5 offset:1024
    v_cvt_pk_bf16_f32 v120, v2, v3
    v_mfma_f32_16x16x32_bf16 v[132:135], a[96:99], v[116:119], v[132:135]
    v_fma_mix_f32 v2, v121, v50, v58 op_sel:[0,0,0] op_sel_hi:[1,0,0]
    v_fma_mix_f32 v3, v121, v51, v59 op_sel:[1,0,0] op_sel_hi:[1,0,0]
    v_mfma_f32_16x16x32_bf16 v[148:151], a[100:103], v[116:119], v[148:151]
    ds_read_b64_tr_b16 a[76:77], v5 offset:8
    v_cvt_pk_bf16_f32 v121, v2, v3
    v_mfma_f32_16x16x32_bf16 v[164:167], a[104:107], v[116:119], v[164:167]
    v_fma_mix_f32 v2, v122, v52, v60 op_sel:[0,0,0] op_sel_hi:[1,0,0]
    v_fma_mix_f32 v3, v122, v53, v61 op_sel:[1,0,0] op_sel_hi:[1,0,0]
    v_mfma_f32_16x16x32_bf16 v[180:183], a[108:111], v[116:119], v[180:183]
    ds_read_b64_tr_b16 a[78:79], v5 offset:1032
    ds_read_b128 v[24:27], v1 offset:512
    v_cvt_pk_bf16_f32 v122, v2, v3
    v_mfma_f32_16x16x32_bf16 v[196:199], a[112:115], v[116:119], v[196:199]
    v_fma_mix_f32 v2, v123, v54, v62 op_sel:[0,0,0] op_sel_hi:[1,0,0]
    v_fma_mix_f32 v3, v123, v55, v63 op_sel:[1,0,0] op_sel_hi:[1,0,0]
    v_mfma_f32_16x16x32_bf16 v[212:215], a[116:119], v[116:119], v[212:215]
    ds_read_b64_tr_b16 a[80:81], v6 offset:0
    v_cvt_pk_bf16_f32 v123, v2, v3
    v_mfma_f32_16x16x32_bf16 v[228:231], a[120:123], v[116:119], v[228:231]
    s_waitcnt vmcnt(14)
    v_fma_mix_f32 v2, v124, v48, v56 op_sel:[0,0,0] op_sel_hi:[1,0,0]
    v_fma_mix_f32 v3, v124, v49, v57 op_sel:[1,0,0] op_sel_hi:[1,0,0]
    v_mfma_f32_16x16x32_bf16 v[244:247], a[124:127], v[116:119], v[244:247]
    ds_read_b64_tr_b16 a[82:83], v6 offset:1024
    ds_read_b128 v[20:23], v1 offset:2576
    v_cvt_pk_bf16_f32 v124, v2, v3
    v_mfma_f32_16x16x32_bf16 v[136:139], a[96:99], v[120:123], v[136:139]
    v_fma_mix_f32 v2, v125, v50, v58 op_sel:[0,0,0] op_sel_hi:[1,0,0]
    v_fma_mix_f32 v3, v125, v51, v59 op_sel:[1,0,0] op_sel_hi:[1,0,0]
    v_mfma_f32_16x16x32_bf16 v[152:155], a[100:103], v[120:123], v[152:155]
    ds_read_b64_tr_b16 a[84:85], v6 offset:8
    buffer_load_dwordx4 v[104:107], v10, s[24:27], s48 offen offset:2048 sc1
    buffer_load_dwordx4 v[108:111], v11, s[24:27], s48 offen offset:2048 sc1
    ds_read_b128 v[28:31], v1 offset:528
    v_cvt_pk_bf16_f32 v125, v2, v3
    v_mfma_f32_16x16x32_bf16 v[168:171], a[104:107], v[120:123], v[168:171]
    v_fma_mix_f32 v2, v126, v52, v60 op_sel:[0,0,0] op_sel_hi:[1,0,0]
    v_fma_mix_f32 v3, v126, v53, v61 op_sel:[1,0,0] op_sel_hi:[1,0,0]
    v_mfma_f32_16x16x32_bf16 v[184:187], a[108:111], v[120:123], v[184:187]
    ds_read_b64_tr_b16 a[86:87], v6 offset:1032
    v_cvt_pk_bf16_f32 v126, v2, v3
    v_mfma_f32_16x16x32_bf16 v[200:203], a[112:115], v[120:123], v[200:203]
    s_waitcnt lgkmcnt(2)
    v_fma_mix_f32 v2, v127, v54, v62 op_sel:[0,0,0] op_sel_hi:[1,0,0]
    v_fma_mix_f32 v3, v127, v55, v63 op_sel:[1,0,0] op_sel_hi:[1,0,0]
    v_mfma_f32_16x16x32_bf16 v[216:219], a[116:119], v[120:123], v[216:219]
    ds_read_b64_tr_b16 a[88:89], v7 offset:0
    v_cvt_pk_bf16_f32 v127, v2, v3
    v_mfma_f32_16x16x32_bf16 v[232:235], a[120:123], v[120:123], v[232:235]
    s_waitcnt vmcnt(15)
    v_fma_mix_f32 v2, v64, v16, v24 op_sel:[0,0,0] op_sel_hi:[1,0,0]
    v_fma_mix_f32 v3, v64, v17, v25 op_sel:[1,0,0] op_sel_hi:[1,0,0]
    v_mfma_f32_16x16x32_bf16 v[248:251], a[124:127], v[120:123], v[248:251]
    ds_read_b64_tr_b16 a[90:91], v7 offset:1024
    v_cvt_pk_bf16_f32 v64, v2, v3
    v_mfma_f32_16x16x32_bf16 v[140:143], a[96:99], v[124:127], v[140:143]
    v_fma_mix_f32 v2, v65, v18, v26 op_sel:[0,0,0] op_sel_hi:[1,0,0]
    v_fma_mix_f32 v3, v65, v19, v27 op_sel:[1,0,0] op_sel_hi:[1,0,0]
    v_mfma_f32_16x16x32_bf16 v[156:159], a[100:103], v[124:127], v[156:159]
    ds_read_b64_tr_b16 a[92:93], v7 offset:8
    v_cvt_pk_bf16_f32 v65, v2, v3
    v_mfma_f32_16x16x32_bf16 v[172:175], a[104:107], v[124:127], v[172:175]
    s_waitcnt lgkmcnt(4)
    v_fma_mix_f32 v2, v66, v20, v28 op_sel:[0,0,0] op_sel_hi:[1,0,0]
    v_fma_mix_f32 v3, v66, v21, v29 op_sel:[1,0,0] op_sel_hi:[1,0,0]
    v_mfma_f32_16x16x32_bf16 v[188:191], a[108:111], v[124:127], v[188:191]
    ds_read_b64_tr_b16 a[94:95], v7 offset:1032
    v_cvt_pk_bf16_f32 v66, v2, v3
    v_mfma_f32_16x16x32_bf16 v[204:207], a[112:115], v[124:127], v[204:207]
    v_fma_mix_f32 v2, v67, v22, v30 op_sel:[0,0,0] op_sel_hi:[1,0,0]
    v_fma_mix_f32 v3, v67, v23, v31 op_sel:[1,0,0] op_sel_hi:[1,0,0]
    v_mfma_f32_16x16x32_bf16 v[220:223], a[116:119], v[124:127], v[220:223]
    v_cvt_pk_bf16_f32 v67, v2, v3
    v_mfma_f32_16x16x32_bf16 v[236:239], a[120:123], v[124:127], v[236:239]
    s_waitcnt lgkmcnt(0)
    s_waitcnt vmcnt(14)
    v_fma_mix_f32 v2, v68, v16, v24 op_sel:[0,0,0] op_sel_hi:[1,0,0]
    v_fma_mix_f32 v3, v68, v17, v25 op_sel:[1,0,0] op_sel_hi:[1,0,0]
    v_mfma_f32_16x16x32_bf16 v[252:255], a[124:127], v[124:127], v[252:255]
    v_cvt_pk_bf16_f32 v68, v2, v3
    v_add_u32 v1, 512, v1
    s_add_u32 s47, s47, 4096
    s_add_u32 s46, s46, 1
    s_cmp_lt_u32 s46, 3
    s_cbranch_scc1 L2_qloop
    v_mfma_f32_16x16x32_bf16 v[128:131], a[64:67], v[64:67], v[128:131]
    v_fma_mix_f32 v2, v69, v18, v26 op_sel:[0,0,0] op_sel_hi:[1,0,0]
    v_fma_mix_f32 v3, v69, v19, v27 op_sel:[1,0,0] op_sel_hi:[1,0,0]
    v_mfma_f32_16x16x32_bf16 v[144:147], a[68:71], v[64:67], v[144:147]
    ds_read_b64_tr_b16 a[96:97], v4 offset:8192
    buffer_load_dwordx4 v[112:115], v8, s[24:27], s47 offen offset:3072 sc1
    buffer_load_dwordx4 v[116:119], v9, s[24:27], s47 offen offset:3072 sc1
    v_cvt_pk_bf16_f32 v69, v2, v3
    v_mfma_f32_16x16x32_bf16 v[160:163], a[72:75], v[64:67], v[160:163]
    v_fma_mix_f32 v2, v70, v20, v28 op_sel:[0,0,0] op_sel_hi:[1,0,0]
    v_fma_mix_f32 v3, v70, v21, v29 op_sel:[1,0,0] op_sel_hi:[1,0,0]
    v_mfma_f32_16x16x32_bf16 v[176:179], a[76:79], v[64:67], v[176:179]
    ds_read_b64_tr_b16 a[98:99], v4 offset:9216
    ds_read_b64_tr_b16 a[100:101], v4 offset:8200
    v_cvt_pk_bf16_f32 v70, v2, v3
    v_mfma_f32_16x16x32_bf16 v[192:195], a[80:83], v[64:67], v[192:195]
    v_fma_mix_f32 v2, v71, v22, v30 op_sel:[0,0,0] op_sel_hi:[1,0,0]
    v_fma_mix_f32 v3, v71, v23, v31 op_sel:[1,0,0] op_sel_hi:[1,0,0]
    v_mfma_f32_16x16x32_bf16 v[208:211], a[84:87], v[64:67], v[208:211]
    ds_read_b64_tr_b16 a[102:103], v4 offset:9224
    ds_read_b128 v[48:51], v1 offset:2176
    v_cvt_pk_bf16_f32 v71, v2, v3
    v_mfma_f32_16x16x32_bf16 v[224:227], a[88:91], v[64:67], v[224:227]
    s_waitcnt vmcnt(15)
    v_fma_mix_f32 v2, v72, v16, v24 op_sel:[0,0,0] op_sel_hi:[1,0,0]
    v_fma_mix_f32 v3, v72, v17, v25 op_sel:[1,0,0] op_sel_hi:[1,0,0]
    v_mfma_f32_16x16x32_bf16 v[240:243], a[92:95], v[64:67], v[240:243]
    ds_read_b64_tr_b16 a[104:105], v5 offset:8192
    ds_read_b64_tr_b16 a[106:107], v5 offset:9216
    v_cvt_pk_bf16_f32 v72, v2, v3
    s_add_u32 m0, s37, 65536
    s_add_u32 s40, s37, 0
    v_mfma_f32_16x16x32_bf16 v[132:135], a[64:67], v[68:71], v[132:135]
    v_fma_mix_f32 v2, v73, v18, v26 op_sel:[0,0,0] op_sel_hi:[1,0,0]
    v_fma_mix_f32 v3, v73, v19, v27 op_sel:[1,0,0] op_sel_hi:[1,0,0]
    v_mfma_f32_16x16x32_bf16 v[148:151], a[68:71], v[68:71], v[148:151]
    ds_read_b64_tr_b16 a[108:109], v5 offset:8200
    buffer_load_dwordx4 v44, s[16:19], s40 offen offset:0 sc1 lds
    buffer_load_dwordx4 v45, s[16:19], s40 offen offset:1024 sc1 lds
    v_cvt_pk_bf16_f32 v73, v2, v3
    v_mfma_f32_16x16x32_bf16 v[164:167], a[72:75], v[68:71], v[164:167]
    v_fma_mix_f32 v2, v74, v20, v28 op_sel:[0,0,0] op_sel_hi:[1,0,0]
    v_fma_mix_f32 v3, v74, v21, v29 op_sel:[1,0,0] op_sel_hi:[1,0,0]
    v_mfma_f32_16x16x32_bf16 v[180:183], a[76:79], v[68:71], v[180:183]
    ds_read_b64_tr_b16 a[110:111], v5 offset:9224
    ds_read_b128 v[56:59], v1 offset:128
    v_cvt_pk_bf16_f32 v74, v2, v3
    v_mfma_f32_16x16x32_bf16 v[196:199], a[80:83], v[68:71], v[196:199]
    v_fma_mix_f32 v2, v75, v22, v30 op_sel:[0,0,0] op_sel_hi:[1,0,0]
    v_fma_mix_f32 v3, v75, v23, v31 op_sel:[1,0,0] op_sel_hi:[1,0,0]
    v_mfma_f32_16x16x32_bf16 v[212:215], a[84:87], v[68:71], v[212:215]
    ds_read_b64_tr_b16 a[112:113], v6 offset:8192
    v_cvt_pk_bf16_f32 v75, v2, v3
    v_mfma_f32_16x16x32_bf16 v[228:231], a[88:91], v[68:71], v[228:231]
    s_waitcnt vmcnt(16)
    v_fma_mix_f32 v2, v76, v16, v24 op_sel:[0,0,0] op_sel_hi:[1,0,0]
    v_fma_mix_f32 v3, v76, v17, v25 op_sel:[1,0,0] op_sel_hi:[1,0,0]
    v_mfma_f32_16x16x32_bf16 v[244:247], a[92:95], v[68:71], v[244:247]
    ds_read_b64_tr_b16 a[114:115], v6 offset:9216
    ds_read_b128 v[52:55], v1 offset:2192
    v_cvt_pk_bf16_f32 v76, v2, v3
    v_mfma_f32_16x16x32_bf16 v[136:139], a[64:67], v[72:75], v[136:139]
    v_fma_mix_f32 v2, v77, v18, v26 op_sel:[0,0,0] op_sel_hi:[1,0,0]
    v_fma_mix_f32 v3, v77, v19, v27 op_sel:[1,0,0] op_sel_hi:[1,0,0]
    v_mfma_f32_16x16x32_bf16 v[152:155], a[68:71], v[72:75], v[152:155]
    ds_read_b64_tr_b16 a[116:117], v6 offset:8200
    buffer_load_dwordx4 v[120:123], v10, s[24:27], s47 offen offset:3072 sc1
    buffer_load_dwordx4 v[124:127], v11, s[24:27], s47 offen offset:3072 sc1
    ds_read_b128 v[60:63], v1 offset:144
    v_cvt_pk_bf16_f32 v77, v2, v3
    v_mfma_f32_16x16x32_bf16 v[168:171], a[72:75], v[72:75], v[168:171]
    v_fma_mix_f32 v2, v78, v20, v28 op_sel:[0,0,0] op_sel_hi:[1,0,0]
    v_fma_mix_f32 v3, v78, v21, v29 op_sel:[1,0,0] op_sel_hi:[1,0,0]
    v_mfma_f32_16x16x32_bf16 v[184:187], a[76:79], v[72:75], v[184:187]
    ds_read_b64_tr_b16 a[118:119], v6 offset:9224
    v_cvt_pk_bf16_f32 v78, v2, v3
    v_mfma_f32_16x16x32_bf16 v[200:203], a[80:83], v[72:75], v[200:203]
    s_waitcnt lgkmcnt(2)
    v_fma_mix_f32 v2, v79, v22, v30 op_sel:[0,0,0] op_sel_hi:[1,0,0]
    v_fma_mix_f32 v3, v79, v23, v31 op_sel:[1,0,0] op_sel_hi:[1,0,0]
    v_mfma_f32_16x16x32_bf16 v[216:219], a[84:87], v[72:75], v[216:219]
    ds_read_b64_tr_b16 a[120:121], v7 offset:8192
    v_cvt_pk_bf16_f32 v79, v2, v3
    v_mfma_f32_16x16x32_bf16 v[232:235], a[88:91], v[72:75], v[232:235]
    s_waitcnt vmcnt(17)
    v_fma_mix_f32 v2, v80, v48, v56 op_sel:[0,0,0] op_sel_hi:[1,0,0]
    v_fma_mix_f32 v3, v80, v49, v57 op_sel:[1,0,0] op_sel_hi:[1,0,0]
    v_mfma_f32_16x16x32_bf16 v[248:251], a[92:95], v[72:75], v[248:251]
    ds_read_b64_tr_b16 a[122:123], v7 offset:9216
    v_cvt_pk_bf16_f32 v80, v2, v3
    v_mfma_f32_16x16x32_bf16 v[140:143], a[64:67], v[76:79], v[140:143]
    v_fma_mix_f32 v2, v81, v50, v58 op_sel:[0,0,0] op_sel_hi:[1,0,0]
    v_fma_mix_f32 v3, v81, v51, v59 op_sel:[1,0,0] op_sel_hi:[1,0,0]
    v_mfma_f32_16x16x32_bf16 v[156:159], a[68:71], v[76:79], v[156:159]
    ds_read_b64_tr_b16 a[124:125], v7 offset:8200
    buffer_load_dwordx4 v44, s[16:19], s40 offen offset:2048 sc1 lds
    buffer_load_dwordx4 v45, s[16:19], s40 offen offset:3072 sc1 lds
    v_cvt_pk_bf16_f32 v81, v2, v3
    v_mfma_f32_16x16x32_bf16 v[172:175], a[72:75], v[76:79], v[172:175]
    s_waitcnt lgkmcnt(4)
    v_fma_mix_f32 v2, v82, v52, v60 op_sel:[0,0,0] op_sel_hi:[1,0,0]
    v_fma_mix_f32 v3, v82, v53, v61 op_sel:[1,0,0] op_sel_hi:[1,0,0]
    v_mfma_f32_16x16x32_bf16 v[188:191], a[76:79], v[76:79], v[188:191]
    ds_read_b64_tr_b16 a[126:127], v7 offset:9224
    v_cvt_pk_bf16_f32 v82, v2, v3
    v_mfma_f32_16x16x32_bf16 v[204:207], a[80:83], v[76:79], v[204:207]
    v_fma_mix_f32 v2, v83, v54, v62 op_sel:[0,0,0] op_sel_hi:[1,0,0]
    v_fma_mix_f32 v3, v83, v55, v63 op_sel:[1,0,0] op_sel_hi:[1,0,0]
    v_mfma_f32_16x16x32_bf16 v[220:223], a[84:87], v[76:79], v[220:223]
    v_cvt_pk_bf16_f32 v83, v2, v3
    v_mfma_f32_16x16x32_bf16 v[236:239], a[88:91], v[76:79], v[236:239]
    s_waitcnt lgkmcnt(0)
    s_waitcnt vmcnt(18)
    v_fma_mix_f32 v2, v84, v48, v56 op_sel:[0,0,0] op_sel_hi:[1,0,0]
    v_fma_mix_f32 v3, v84, v49, v57 op_sel:[1,0,0] op_sel_hi:[1,0,0]
    v_mfma_f32_16x16x32_bf16 v[252:255], a[92:95], v[76:79], v[252:255]
    v_cvt_pk_bf16_f32 v84, v2, v3
    v_add_u32 v4, 131072, v12
    v_add_u32 v5, 131072, v13
    v_add_u32 v6, 131072, v14
    v_add_u32 v7, 131072, v15
    v_mfma_f32_16x16x32_bf16 v[128:131], a[96:99], v[80:83], v[128:131]
    v_fma_mix_f32 v2, v85, v50, v58 op_sel:[0,0,0] op_sel_hi:[1,0,0]
    v_fma_mix_f32 v3, v85, v51, v59 op_sel:[1,0,0] op_sel_hi:[1,0,0]
    v_mfma_f32_16x16x32_bf16 v[144:147], a[100:103], v[80:83], v[144:147]
    ds_read_b64_tr_b16 a[64:65], v4 offset:0
    v_cvt_pk_bf16_f32 v85, v2, v3
    v_mfma_f32_16x16x32_bf16 v[160:163], a[104:107], v[80:83], v[160:163]
    v_fma_mix_f32 v2, v86, v52, v60 op_sel:[0,0,0] op_sel_hi:[1,0,0]
    v_fma_mix_f32 v3, v86, v53, v61 op_sel:[1,0,0] op_sel_hi:[1,0,0]
    v_mfma_f32_16x16x32_bf16 v[176:179], a[108:111], v[80:83], v[176:179]
    ds_read_b64_tr_b16 a[66:67], v4 offset:1024
    ds_read_b64_tr_b16 a[68:69], v4 offset:8
    v_cvt_pk_bf16_f32 v86, v2, v3
    v_mfma_f32_16x16x32_bf16 v[192:195], a[112:115], v[80:83], v[192:195]
    v_fma_mix_f32 v2, v87, v54, v62 op_sel:[0,0,0] op_sel_hi:[1,0,0]
    v_fma_mix_f32 v3, v87, v55, v63 op_sel:[1,0,0] op_sel_hi:[1,0,0]
    v_mfma_f32_16x16x32_bf16 v[208:211], a[116:119], v[80:83], v[208:211]
    ds_read_b64_tr_b16 a[70:71], v4 offset:1032
    ds_read_b128 v[16:19], v1 offset:2304
    v_cvt_pk_bf16_f32 v87, v2, v3
    v_mfma_f32_16x16x32_bf16 v[224:227], a[120:123], v[80:83], v[224:227]
    s_waitcnt vmcnt(15)
    v_fma_mix_f32 v2, v88, v48, v56 op_sel:[0,0,0] op_sel_hi:[1,0,0]
    v_fma_mix_f32 v3, v88, v49, v57 op_sel:[1,0,0] op_sel_hi:[1,0,0]
    v_mfma_f32_16x16x32_bf16 v[240:243], a[124:127], v[80:83], v[240:243]
    ds_read_b64_tr_b16 a[72:73], v5 offset:0
    ds_read_b64_tr_b16 a[74:75], v5 offset:1024
    v_cvt_pk_bf16_f32 v88, v2, v3
    s_add_u32 m0, s37, 81920
    s_add_u32 s40, s37, 16384
    v_mfma_f32_16x16x32_bf16 v[132:135], a[96:99], v[84:87], v[132:135]
    v_fma_mix_f32 v2, v89, v50, v58 op_sel:[0,0,0] op_sel_hi:[1,0,0]
    v_fma_mix_f32 v3, v89, v51, v59 op_sel:[1,0,0] op_sel_hi:[1,0,0]
    v_mfma_f32_16x16x32_bf16 v[148:151], a[100:103], v[84:87], v[148:151]
    ds_read_b64_tr_b16 a[76:77], v5 offset:8
    buffer_load_dwordx4 v44, s[16:19], s40 offen offset:0 sc1 lds
    buffer_load_dwordx4 v45, s[16:19], s40 offen offset:1024 sc1 lds
    v_cvt_pk_bf16_f32 v89, v2, v3
    v_mfma_f32_16x16x32_bf16 v[164:167], a[104:107], v[84:87], v[164:167]
    v_fma_mix_f32 v2, v90, v52, v60 op_sel:[0,0,0] op_sel_hi:[1,0,0]
    v_fma_mix_f32 v3, v90, v53, v61 op_sel:[1,0,0] op_sel_hi:[1,0,0]
    v_mfma_f32_16x16x32_bf16 v[180:183], a[108:111], v[84:87], v[180:183]
    ds_read_b64_tr_b16 a[78:79], v5 offset:1032
    ds_read_b128 v[24:27], v1 offset:256
    v_cvt_pk_bf16_f32 v90, v2, v3
    v_mfma_f32_16x16x32_bf16 v[196:199], a[112:115], v[84:87], v[196:199]
    v_fma_mix_f32 v2, v91, v54, v62 op_sel:[0,0,0] op_sel_hi:[1,0,0]
    v_fma_mix_f32 v3, v91, v55, v63 op_sel:[1,0,0] op_sel_hi:[1,0,0]
    v_mfma_f32_16x16x32_bf16 v[212:215], a[116:119], v[84:87], v[212:215]
    ds_read_b64_tr_b16 a[80:81], v6 offset:0
    v_cvt_pk_bf16_f32 v91, v2, v3
    v_mfma_f32_16x16x32_bf16 v[228:231], a[120:123], v[84:87], v[228:231]
    s_waitcnt vmcnt(16)
    v_fma_mix_f32 v2, v92, v48, v56 op_sel:[0,0,0] op_sel_hi:[1,0,0]
    v_fma_mix_f32 v3, v92, v49, v57 op_sel:[1,0,0] op_sel_hi:[1,0,0]
    v_mfma_f32_16x16x32_bf16 v[244:247], a[124:127], v[84:87], v[244:247]
    ds_read_b64_tr_b16 a[82:83], v6 offset:1024
    ds_read_b128 v[20:23], v1 offset:2320
    v_cvt_pk_bf16_f32 v92, v2, v3
    v_mfma_f32_16x16x32_bf16 v[136:139], a[96:99], v[88:91], v[136:139]
    v_fma_mix_f32 v2, v93, v50, v58 op_sel:[0,0,0] op_sel_hi:[1,0,0]
    v_fma_mix_f32 v3, v93, v51, v59 op_sel:[1,0,0] op_sel_hi:[1,0,0]
    v_mfma_f32_16x16x32_bf16 v[152:155], a[100:103], v[88:91], v[152:155]
    ds_read_b64_tr_b16 a[84:85], v6 offset:8
    ds_read_b128 v[28:31], v1 offset:272
    v_cvt_pk_bf16_f32 v93, v2, v3
    v_mfma_f32_16x16x32_bf16 v[168:171], a[104:107], v[88:91], v[168:171]
    v_fma_mix_f32 v2, v94, v52, v60 op_sel:[0,0,0] op_sel_hi:[1,0,0]
    v_fma_mix_f32 v3, v94, v53, v61 op_sel:[1,0,0] op_sel_hi:[1,0,0]
    v_mfma_f32_16x16x32_bf16 v[184:187], a[108:111], v[88:91], v[184:187]
    ds_read_b64_tr_b16 a[86:87], v6 offset:1032
    v_cvt_pk_bf16_f32 v94, v2, v3
    v_mfma_f32_16x16x32_bf16 v[200:203], a[112:115], v[88:91], v[200:203]
    s_waitcnt lgkmcnt(2)
    v_fma_mix_f32 v2, v95, v54, v62 op_sel:[0,0,0] op_sel_hi:[1,0,0]
    v_fma_mix_f32 v3, v95, v55, v63 op_sel:[1,0,0] op_sel_hi:[1,0,0]
    v_mfma_f32_16x16x32_bf16 v[216:219], a[116:119], v[88:91], v[216:219]
    ds_read_b64_tr_b16 a[88:89], v7 offset:0
    v_cvt_pk_bf16_f32 v95, v2, v3
    v_mfma_f32_16x16x32_bf16 v[232:235], a[120:123], v[88:91], v[232:235]
    s_waitcnt vmcnt(13)
    v_fma_mix_f32 v2, v96, v16, v24 op_sel:[0,0,0] op_sel_hi:[1,0,0]
    v_fma_mix_f32 v3, v96, v17, v25 op_sel:[1,0,0] op_sel_hi:[1,0,0]
    v_mfma_f32_16x16x32_bf16 v[248:251], a[124:127], v[88:91], v[248:251]
    ds_read_b64_tr_b16 a[90:91], v7 offset:1024
    v_cvt_pk_bf16_f32 v96, v2, v3
    v_mfma_f32_16x16x32_bf16 v[140:143], a[96:99], v[92:95], v[140:143]
    v_fma_mix_f32 v2, v97, v18, v26 op_sel:[0,0,0] op_sel_hi:[1,0,0]
    v_fma_mix_f32 v3, v97, v19, v27 op_sel:[1,0,0] op_sel_hi:[1,0,0]
    v_mfma_f32_16x16x32_bf16 v[156:159], a[100:103], v[92:95], v[156:159]
    ds_read_b64_tr_b16 a[92:93], v7 offset:8
    buffer_load_dwordx4 v44, s[16:19], s40 offen offset:2048 sc1 lds
    buffer_load_dwordx4 v45, s[16:19], s40 offen offset:3072 sc1 lds
    v_cvt_pk_bf16_f32 v97, v2, v3
    v_mfma_f32_16x16x32_bf16 v[172:175], a[104:107], v[92:95], v[172:175]
    s_waitcnt lgkmcnt(4)
    v_fma_mix_f32 v2, v98, v20, v28 op_sel:[0,0,0] op_sel_hi:[1,0,0]
    v_fma_mix_f32 v3, v98, v21, v29 op_sel:[1,0,0] op_sel_hi:[1,0,0]
    v_mfma_f32_16x16x32_bf16 v[188:191], a[108:111], v[92:95], v[188:191]
    ds_read_b64_tr_b16 a[94:95], v7 offset:1032
    v_cvt_pk_bf16_f32 v98, v2, v3
    v_mfma_f32_16x16x32_bf16 v[204:207], a[112:115], v[92:95], v[204:207]
    v_fma_mix_f32 v2, v99, v22, v30 op_sel:[0,0,0] op_sel_hi:[1,0,0]
    v_fma_mix_f32 v3, v99, v23, v31 op_sel:[1,0,0] op_sel_hi:[1,0,0]
    v_mfma_f32_16x16x32_bf16 v[220:223], a[116:119], v[92:95], v[220:223]
    v_cvt_pk_bf16_f32 v99, v2, v3
    v_mfma_f32_16x16x32_bf16 v[236:239], a[120:123], v[92:95], v[236:239]
    s_waitcnt lgkmcnt(0)
    s_waitcnt vmcnt(14)
    v_fma_mix_f32 v2, v100, v16, v24 op_sel:[0,0,0] op_sel_hi:[1,0,0]
    v_fma_mix_f32 v3, v100, v17, v25 op_sel:[1,0,0] op_sel_hi:[1,0,0]
    v_mfma_f32_16x16x32_bf16 v[252:255], a[124:127], v[92:95], v[252:255]
    v_cvt_pk_bf16_f32 v100, v2, v3
    v_mfma_f32_16x16x32_bf16 v[128:131], a[64:67], v[96:99], v[128:131]
    v_fma_mix_f32 v2, v101, v18, v26 op_sel:[0,0,0] op_sel_hi:[1,0,0]
    v_fma_mix_f32 v3, v101, v19, v27 op_sel:[1,0,0] op_sel_hi:[1,0,0]
    v_mfma_f32_16x16x32_bf16 v[144:147], a[68:71], v[96:99], v[144:147]
    ds_read_b64_tr_b16 a[96:97], v4 offset:8192
    v_cvt_pk_bf16_f32 v101, v2, v3
    v_mfma_f32_16x16x32_bf16 v[160:163], a[72:75], v[96:99], v[160:163]
    v_fma_mix_f32 v2, v102, v20, v28 op_sel:[0,0,0] op_sel_hi:[1,0,0]
    v_fma_mix_f32 v3, v102, v21, v29 op_sel:[1,0,0] op_sel_hi:[1,0,0]
    v_mfma_f32_16x16x32_bf16 v[176:179], a[76:79], v[96:99], v[176:179]
    ds_read_b64_tr_b16 a[98:99], v4 offset:9216
    ds_read_b64_tr_b16 a[100:101], v4 offset:8200
    v_cvt_pk_bf16_f32 v102, v2, v3
    v_mfma_f32_16x16x32_bf16 v[192:195], a[80:83], v[96:99], v[192:195]
    v_fma_mix_f32 v2, v103, v22, v30 op_sel:[0,0,0] op_sel_hi:[1,0,0]
    v_fma_mix_f32 v3, v103, v23, v31 op_sel:[1,0,0] op_sel_hi:[1,0,0]
    v_mfma_f32_16x16x32_bf16 v[208:211], a[84:87], v[96:99], v[208:211]
    ds_read_b64_tr_b16 a[102:103], v4 offset:9224
    ds_read_b128 v[48:51], v1 offset:2432
    v_cvt_pk_bf16_f32 v103, v2, v3
    v_mfma_f32_16x16x32_bf16 v[224:227], a[88:91], v[96:99], v[224:227]
    s_waitcnt vmcnt(13)
    v_fma_mix_f32 v2, v104, v16, v24 op_sel:[0,0,0] op_sel_hi:[1,0,0]
    v_fma_mix_f32 v3, v104, v17, v25 op_sel:[1,0,0] op_sel_hi:[1,0,0]
    v_mfma_f32_16x16x32_bf16 v[240:243], a[92:95], v[96:99], v[240:243]
    ds_read_b64_tr_b16 a[104:105], v5 offset:8192
    ds_read_b64_tr_b16 a[106:107], v5 offset:9216
    v_cvt_pk_bf16_f32 v104, v2, v3
    s_add_u32 m0, s37, 98304
    s_add_u32 s40, s37, 32768
    v_mfma_f32_16x16x32_bf16 v[132:135], a[64:67], v[100:103], v[132:135]
    v_fma_mix_f32 v2, v105, v18, v26 op_sel:[0,0,0] op_sel_hi:[1,0,0]
    v_fma_mix_f32 v3, v105, v19, v27 op_sel:[1,0,0] op_sel_hi:[1,0,0]
    v_mfma_f32_16x16x32_bf16 v[148:151], a[68:71], v[100:103], v[148:151]
    ds_read_b64_tr_b16 a[108:109], v5 offset:8200
    buffer_load_dwordx4 v44, s[16:19], s40 offen offset:0 sc1 lds
    buffer_load_dwordx4 v45, s[16:19], s40 offen offset:1024 sc1 lds
    v_cvt_pk_bf16_f32 v105, v2, v3
    v_mfma_f32_16x16x32_bf16 v[164:167], a[72:75], v[100:103], v[164:167]
    v_fma_mix_f32 v2, v106, v20, v28 op_sel:[0,0,0] op_sel_hi:[1,0,0]
    v_fma_mix_f32 v3, v106, v21, v29 op_sel:[1,0,0] op_sel_hi:[1,0,0]
    v_mfma_f32_16x16x32_bf16 v[180:183], a[76:79], v[100:103], v[180:183]
    ds_read_b64_tr_b16 a[110:111], v5 offset:9224
    ds_read_b128 v[56:59], v1 offset:384
    v_cvt_pk_bf16_f32 v106, v2, v3
    v_mfma_f32_16x16x32_bf16 v[196:199], a[80:83], v[100:103], v[196:199]
    v_fma_mix_f32 v2, v107, v22, v30 op_sel:[0,0,0] op_sel_hi:[1,0,0]
    v_fma_mix_f32 v3, v107, v23, v31 op_sel:[1,0,0] op_sel_hi:[1,0,0]
    v_mfma_f32_16x16x32_bf16 v[212:215], a[84:87], v[100:103], v[212:215]
    ds_read_b64_tr_b16 a[112:113], v6 offset:8192
    v_cvt_pk_bf16_f32 v107, v2, v3
    v_mfma_f32_16x16x32_bf16 v[228:231], a[88:91], v[100:103], v[228:231]
    s_waitcnt vmcnt(14)
    v_fma_mix_f32 v2, v108, v16, v24 op_sel:[0,0,0] op_sel_hi:[1,0,0]
    v_fma_mix_f32 v3, v108, v17, v25 op_sel:[1,0,0] op_sel_hi:[1,0,0]
    v_mfma_f32_16x16x32_bf16 v[244:247], a[92:95], v[100:103], v[244:247]
    ds_read_b64_tr_b16 a[114:115], v6 offset:9216
    ds_read_b128 v[52:55], v1 offset:2448
    v_cvt_pk_bf16_f32 v108, v2, v3
    v_mfma_f32_16x16x32_bf16 v[136:139], a[64:67], v[104:107], v[136:139]
    v_fma_mix_f32 v2, v109, v18, v26 op_sel:[0,0,0] op_sel_hi:[1,0,0]
    v_fma_mix_f32 v3, v109, v19, v27 op_sel:[1,0,0] op_sel_hi:[1,0,0]
    v_mfma_f32_16x16x32_bf16 v[152:155], a[68:71], v[104:107], v[152:155]
    ds_read_b64_tr_b16 a[116:117], v6 offset:8200
    ds_read_b128 v[60:63], v1 offset:400
    v_cvt_pk_bf16_f32 v109, v2, v3
    v_mfma_f32_16x16x32_bf16 v[168:171], a[72:75], v[104:107], v[168:171]
    v_fma_mix_f32 v2, v110, v20, v28 op_sel:[0,0,0] op_sel_hi:[1,0,0]
    v_fma_mix_f32 v3, v110, v21, v29 op_sel:[1,0,0] op_sel_hi:[1,0,0]
    v_mfma_f32_16x16x32_bf16 v[184:187], a[76:79], v[104:107], v[184:187]
    ds_read_b64_tr_b16 a[118:119], v6 offset:9224
    v_cvt_pk_bf16_f32 v110, v2, v3
    v_mfma_f32_16x16x32_bf16 v[200:203], a[80:83], v[104:107], v[200:203]
    s_waitcnt lgkmcnt(2)
    v_fma_mix_f32 v2, v111, v22, v30 op_sel:[0,0,0] op_sel_hi:[1,0,0]
    v_fma_mix_f32 v3, v111, v23, v31 op_sel:[1,0,0] op_sel_hi:[1,0,0]
    v_mfma_f32_16x16x32_bf16 v[216:219], a[84:87], v[104:107], v[216:219]
    ds_read_b64_tr_b16 a[120:121], v7 offset:8192
    v_cvt_pk_bf16_f32 v111, v2, v3
    v_mfma_f32_16x16x32_bf16 v[232:235], a[88:91], v[104:107], v[232:235]
    s_waitcnt vmcnt(13)
    v_fma_mix_f32 v2, v112, v48, v56 op_sel:[0,0,0] op_sel_hi:[1,0,0]
    v_fma_mix_f32 v3, v112, v49, v57 op_sel:[1,0,0] op_sel_hi:[1,0,0]
    v_mfma_f32_16x16x32_bf16 v[248:251], a[92:95], v[104:107], v[248:251]
    ds_read_b64_tr_b16 a[122:123], v7 offset:9216
    v_cvt_pk_bf16_f32 v112, v2, v3
    v_mfma_f32_16x16x32_bf16 v[140:143], a[64:67], v[108:111], v[140:143]
    v_fma_mix_f32 v2, v113, v50, v58 op_sel:[0,0,0] op_sel_hi:[1,0,0]
    v_fma_mix_f32 v3, v113, v51, v59 op_sel:[1,0,0] op_sel_hi:[1,0,0]
    v_mfma_f32_16x16x32_bf16 v[156:159], a[68:71], v[108:111], v[156:159]
    ds_read_b64_tr_b16 a[124:125], v7 offset:8200
    buffer_load_dwordx4 v44, s[16:19], s40 offen offset:2048 sc1 lds
    buffer_load_dwordx4 v45, s[16:19], s40 offen offset:3072 sc1 lds
    v_cvt_pk_bf16_f32 v113, v2, v3
    v_mfma_f32_16x16x32_bf16 v[172:175], a[72:75], v[108:111], v[172:175]
    s_waitcnt lgkmcnt(4)
    v_fma_mix_f32 v2, v114, v52, v60 op_sel:[0,0,0] op_sel_hi:[1,0,0]
    v_fma_mix_f32 v3, v114, v53, v61 op_sel:[1,0,0] op_sel_hi:[1,0,0]
    v_mfma_f32_16x16x32_bf16 v[188:191], a[76:79], v[108:111], v[188:191]
    ds_read_b64_tr_b16 a[126:127], v7 offset:9224
    v_cvt_pk_bf16_f32 v114, v2, v3
    v_mfma_f32_16x16x32_bf16 v[204:207], a[80:83], v[108:111], v[204:207]
    v_fma_mix_f32 v2, v115, v54, v62 op_sel:[0,0,0] op_sel_hi:[1,0,0]
    v_fma_mix_f32 v3, v115, v55, v63 op_sel:[1,0,0] op_sel_hi:[1,0,0]
    v_mfma_f32_16x16x32_bf16 v[220:223], a[84:87], v[108:111], v[220:223]
    v_cvt_pk_bf16_f32 v115, v2, v3
    v_mfma_f32_16x16x32_bf16 v[236:239], a[88:91], v[108:111], v[236:239]
    s_waitcnt lgkmcnt(0)
    s_waitcnt vmcnt(14)
    v_fma_mix_f32 v2, v116, v48, v56 op_sel:[0,0,0] op_sel_hi:[1,0,0]
    v_fma_mix_f32 v3, v116, v49, v57 op_sel:[1,0,0] op_sel_hi:[1,0,0]
    v_mfma_f32_16x16x32_bf16 v[252:255], a[92:95], v[108:111], v[252:255]
    v_cvt_pk_bf16_f32 v116, v2, v3
    v_mfma_f32_16x16x32_bf16 v[128:131], a[96:99], v[112:115], v[128:131]
    v_fma_mix_f32 v2, v117, v50, v58 op_sel:[0,0,0] op_sel_hi:[1,0,0]
    v_fma_mix_f32 v3, v117, v51, v59 op_sel:[1,0,0] op_sel_hi:[1,0,0]
    v_mfma_f32_16x16x32_bf16 v[144:147], a[100:103], v[112:115], v[144:147]
    v_cvt_pk_bf16_f32 v117, v2, v3
    v_mfma_f32_16x16x32_bf16 v[160:163], a[104:107], v[112:115], v[160:163]
    v_fma_mix_f32 v2, v118, v52, v60 op_sel:[0,0,0] op_sel_hi:[1,0,0]
    v_fma_mix_f32 v3, v118, v53, v61 op_sel:[1,0,0] op_sel_hi:[1,0,0]
    v_mfma_f32_16x16x32_bf16 v[176:179], a[108:111], v[112:115], v[176:179]
    v_cvt_pk_bf16_f32 v118, v2, v3
    s_waitcnt lgkmcnt(0)
    s_barrier
    v_mfma_f32_16x16x32_bf16 v[192:195], a[112:115], v[112:115], v[192:195]
    v_fma_mix_f32 v2, v119, v54, v62 op_sel:[0,0,0] op_sel_hi:[1,0,0]
    v_fma_mix_f32 v3, v119, v55, v63 op_sel:[1,0,0] op_sel_hi:[1,0,0]
    v_mfma_f32_16x16x32_bf16 v[208:211], a[116:119], v[112:115], v[208:211]
    v_cvt_pk_bf16_f32 v119, v2, v3
    v_mfma_f32_16x16x32_bf16 v[224:227], a[120:123], v[112:115], v[224:227]
    s_waitcnt vmcnt(11)
    v_fma_mix_f32 v2, v120, v48, v56 op_sel:[0,0,0] op_sel_hi:[1,0,0]
    v_fma_mix_f32 v3, v120, v49, v57 op_sel:[1,0,0] op_sel_hi:[1,0,0]
    v_mfma_f32_16x16x32_bf16 v[240:243], a[124:127], v[112:115], v[240:243]
    ds_read_b128 a[64:67], v32 offset:0
    v_cvt_pk_bf16_f32 v120, v2, v3
    v_mfma_f32_16x16x32_bf16 v[132:135], a[96:99], v[116:119], v[132:135]
    v_fma_mix_f32 v2, v121, v50, v58 op_sel:[0,0,0] op_sel_hi:[1,0,0]
    v_fma_mix_f32 v3, v121, v51, v59 op_sel:[1,0,0] op_sel_hi:[1,0,0]
    v_mfma_f32_16x16x32_bf16 v[148:151], a[100:103], v[116:119], v[148:151]
    ds_read_b128 a[68:71], v33 offset:0
    v_cvt_pk_bf16_f32 v121, v2, v3
    v_mfma_f32_16x16x32_bf16 v[164:167], a[104:107], v[116:119], v[164:167]
    v_fma_mix_f32 v2, v122, v52, v60 op_sel:[0,0,0] op_sel_hi:[1,0,0]
    v_fma_mix_f32 v3, v122, v53, v61 op_sel:[1,0,0] op_sel_hi:[1,0,0]
    v_mfma_f32_16x16x32_bf16 v[180:183], a[108:111], v[116:119], v[180:183]
    ds_read_b128 a[72:75], v34 offset:0
    v_cvt_pk_bf16_f32 v122, v2, v3
    v_mfma_f32_16x16x32_bf16 v[196:199], a[112:115], v[116:119], v[196:199]
    v_fma_mix_f32 v2, v123, v54, v62 op_sel:[0,0,0] op_sel_hi:[1,0,0]
    v_fma_mix_f32 v3, v123, v55, v63 op_sel:[1,0,0] op_sel_hi:[1,0,0]
    v_mfma_f32_16x16x32_bf16 v[212:215], a[116:119], v[116:119], v[212:215]
    ds_read_b128 a[76:79], v35 offset:0
    v_cvt_pk_bf16_f32 v123, v2, v3
    v_mfma_f32_16x16x32_bf16 v[228:231], a[120:123], v[116:119], v[228:231]
    s_waitcnt vmcnt(10)
    v_fma_mix_f32 v2, v124, v48, v56 op_sel:[0,0,0] op_sel_hi:[1,0,0]
    v_fma_mix_f32 v3, v124, v49, v57 op_sel:[1,0,0] op_sel_hi:[1,0,0]
    v_mfma_f32_16x16x32_bf16 v[244:247], a[124:127], v[116:119], v[244:247]
    ds_read_b128 a[80:83], v32 offset:4096
    v_cvt_pk_bf16_f32 v124, v2, v3
    v_mfma_f32_16x16x32_bf16 v[136:139], a[96:99], v[120:123], v[136:139]
    v_fma_mix_f32 v2, v125, v50, v58 op_sel:[0,0,0] op_sel_hi:[1,0,0]
    v_fma_mix_f32 v3, v125, v51, v59 op_sel:[1,0,0] op_sel_hi:[1,0,0]
    v_mfma_f32_16x16x32_bf16 v[152:155], a[100:103], v[120:123], v[152:155]
    ds_read_b128 a[84:87], v33 offset:4096
    v_cvt_pk_bf16_f32 v125, v2, v3
    v_mfma_f32_16x16x32_bf16 v[168:171], a[104:107], v[120:123], v[168:171]
    v_fma_mix_f32 v2, v126, v52, v60 op_sel:[0,0,0] op_sel_hi:[1,0,0]
    v_fma_mix_f32 v3, v126, v53, v61 op_sel:[1,0,0] op_sel_hi:[1,0,0]
    v_mfma_f32_16x16x32_bf16 v[184:187], a[108:111], v[120:123], v[184:187]
    ds_read_b128 a[88:91], v34 offset:4096
    v_cvt_pk_bf16_f32 v126, v2, v3
    v_mfma_f32_16x16x32_bf16 v[200:203], a[112:115], v[120:123], v[200:203]
    s_waitcnt lgkmcnt(2)
    v_fma_mix_f32 v2, v127, v54, v62 op_sel:[0,0,0] op_sel_hi:[1,0,0]
    v_fma_mix_f32 v3, v127, v55, v63 op_sel:[1,0,0] op_sel_hi:[1,0,0]
    v_mfma_f32_16x16x32_bf16 v[216:219], a[116:119], v[120:123], v[216:219]
    ds_read_b128 a[92:95], v35 offset:4096
    v_cvt_pk_bf16_f32 v127, v2, v3
    v_mfma_f32_16x16x32_bf16 v[232:235], a[120:123], v[120:123], v[232:235]
    v_cvt_pk_bf16_f32 v16, v128, v129
    v_cvt_pk_bf16_f32 v17, v130, v131
    v_cvt_pk_bf16_f32 v18, v144, v145
    v_cvt_pk_bf16_f32 v19, v146, v147
    v_mfma_f32_16x16x32_bf16 v[248:251], a[124:127], v[120:123], v[248:251]
    v_accvgpr_write_b32 a0, v16
    v_accvgpr_write_b32 a1, v17
    v_accvgpr_write_b32 a2, v18
    v_accvgpr_write_b32 a3, v19
    v_mfma_f32_16x16x32_bf16 v[140:143], a[96:99], v[124:127], v[140:143]
    v_cvt_pk_bf16_f32 v20, v160, v161
    v_cvt_pk_bf16_f32 v21, v162, v163
    v_cvt_pk_bf16_f32 v22, v176, v177
    v_cvt_pk_bf16_f32 v23, v178, v179
    v_mfma_f32_16x16x32_bf16 v[156:159], a[100:103], v[124:127], v[156:159]
    v_accvgpr_write_b32 a4, v20
    v_accvgpr_write_b32 a5, v21
    v_accvgpr_write_b32 a6, v22
    v_accvgpr_write_b32 a7, v23
    v_mfma_f32_16x16x32_bf16 v[172:175], a[104:107], v[124:127], v[172:175]
    v_cvt_pk_bf16_f32 v24, v192, v193
    v_cvt_pk_bf16_f32 v25, v194, v195
    v_cvt_pk_bf16_f32 v26, v208, v209
    v_cvt_pk_bf16_f32 v27, v210, v211
    v_mfma_f32_16x16x32_bf16 v[188:191], a[108:111], v[124:127], v[188:191]
    v_accvgpr_write_b32 a8, v24
    v_accvgpr_write_b32 a9, v25
    v_accvgpr_write_b32 a10, v26
    v_accvgpr_write_b32 a11, v27
    v_mfma_f32_16x16x32_bf16 v[204:207], a[112:115], v[124:127], v[204:207]
    v_cvt_pk_bf16_f32 v28, v224, v225
    v_cvt_pk_bf16_f32 v29, v226, v227
    v_cvt_pk_bf16_f32 v30, v240, v241
    v_cvt_pk_bf16_f32 v31, v242, v243
    v_mfma_f32_16x16x32_bf16 v[220:223], a[116:119], v[124:127], v[220:223]
    v_accvgpr_write_b32 a12, v28
    v_accvgpr_write_b32 a13, v29
    v_accvgpr_write_b32 a14, v30
    v_accvgpr_write_b32 a15, v31
    v_mfma_f32_16x16x32_bf16 v[236:239], a[120:123], v[124:127], v[236:239]
    s_waitcnt lgkmcnt(0)
    v_cvt_pk_bf16_f32 v16, v132, v133
    v_cvt_pk_bf16_f32 v17, v134, v135
    v_cvt_pk_bf16_f32 v18, v148, v149
    v_cvt_pk_bf16_f32 v19, v150, v151
    v_mfma_f32_16x16x32_bf16 v[252:255], a[124:127], v[124:127], v[252:255]
    v_accvgpr_write_b32 a16, v16
    v_accvgpr_write_b32 a17, v17
    v_accvgpr_write_b32 a18, v18
    v_accvgpr_write_b32 a19, v19
    s_and_b32 s42, s2, 7
    s_mul_i32 s42, s42, 28
    s_lshr_b32 s43, s2, 3
    s_add_u32 s42, s42, s43
    s_cmp_lt_u32 s2, 224
    s_cselect_b32 s42, s42, 0x40000
    s_lshl_b32 s3, s42, 4
    s_bfe_u32 s44, s2, 0x30003
    s_mul_i32 s44, s44, 589824
    s_mul_i32 s43, s36, 143360
    s_add_u32 s44, s44, s43
    s_add_u32 s44, s44, 24748032
    s_add_u32 s8, s10, s44
    s_addc_u32 s9, s11, 0
    s_add_u32 s70, s8, 4096
    s_addc_u32 s71, s9, 0
    v_and_b32 v5, 15, v0
    v_lshlrev_b32 v5, 7, v5
    v_add_u32 v5, 48128, v5
    v_mov_b32 v4, 16
    ds_read_b128 a[96:99], v32 offset:8192
    ds_read_b128 a[100:103], v33 offset:8192
    ds_read_b128 a[104:107], v34 offset:8192
    ds_read_b128 a[108:111], v35 offset:8192
    ds_read_b128 a[112:115], v32 offset:12288
    ds_read_b128 a[116:119], v33 offset:12288
    ds_read_b128 a[120:123], v34 offset:12288
    ds_read_b128 a[124:127], v35 offset:12288
    v_mfma_f32_16x16x32_bf16 v[64:67], a[64:67], a[0:3], 0
    v_cvt_pk_bf16_f32 v20, v164, v165
    v_cvt_pk_bf16_f32 v21, v166, v167
    v_cvt_pk_bf16_f32 v22, v180, v181
    v_mfma_f32_16x16x32_bf16 v[64:67], a[68:71], a[4:7], v[64:67]
    v_cvt_pk_bf16_f32 v23, v182, v183
    v_accvgpr_write_b32 a20, v20
    v_accvgpr_write_b32 a21, v21
    v_mfma_f32_16x16x32_bf16 v[64:67], a[72:75], a[8:11], v[64:67]
    v_accvgpr_write_b32 a22, v22
    v_accvgpr_write_b32 a23, v23
    v_cvt_pk_bf16_f32 v24, v196, v197
    v_mfma_f32_16x16x32_bf16 v[64:67], a[76:79], a[12:15], v[64:67]
    v_cvt_pk_bf16_f32 v25, v198, v199
    v_cvt_pk_bf16_f32 v26, v212, v213
    v_cvt_pk_bf16_f32 v27, v214, v215
    v_mfma_f32_16x16x32_bf16 v[72:75], a[80:83], a[0:3], 0
    v_accvgpr_write_b32 a24, v24
    v_accvgpr_write_b32 a25, v25
    v_accvgpr_write_b32 a26, v26
    v_mfma_f32_16x16x32_bf16 v[72:75], a[84:87], a[4:7], v[72:75]
    v_accvgpr_write_b32 a27, v27
    v_cvt_pk_bf16_f32 v28, v228, v229
    v_cvt_pk_bf16_f32 v29, v230, v231
    v_mfma_f32_16x16x32_bf16 v[72:75], a[88:91], a[8:11], v[72:75]
    v_cvt_pk_bf16_f32 v30, v244, v245
    v_cvt_pk_bf16_f32 v31, v246, v247
    v_accvgpr_write_b32 a28, v28
    v_mfma_f32_16x16x32_bf16 v[72:75], a[92:95], a[12:15], v[72:75]
    v_accvgpr_write_b32 a29, v29
    v_accvgpr_write_b32 a30, v30
    v_accvgpr_write_b32 a31, v31
    v_mfma_f32_16x16x32_bf16 v[68:71], a[64:67], a[16:19], 0
    v_cvt_pk_bf16_f32 v16, v136, v137
    v_cvt_pk_bf16_f32 v17, v138, v139
    v_cvt_pk_bf16_f32 v18, v152, v153
    v_mfma_f32_16x16x32_bf16 v[68:71], a[68:71], a[20:23], v[68:71]
    v_cvt_pk_bf16_f32 v19, v154, v155
    v_accvgpr_write_b32 a32, v16
    v_accvgpr_write_b32 a33, v17
    v_mfma_f32_16x16x32_bf16 v[68:71], a[72:75], a[24:27], v[68:71]
    v_accvgpr_write_b32 a34, v18
    v_accvgpr_write_b32 a35, v19
    v_cvt_pk_bf16_f32 v20, v168, v169
    v_mfma_f32_16x16x32_bf16 v[68:71], a[76:79], a[28:31], v[68:71]
    v_cvt_pk_bf16_f32 v21, v170, v171
    v_cvt_pk_bf16_f32 v22, v184, v185
    v_cvt_pk_bf16_f32 v23, v186, v187
    v_mfma_f32_16x16x32_bf16 v[76:79], a[80:83], a[16:19], 0
    v_accvgpr_write_b32 a36, v20
    v_accvgpr_write_b32 a37, v21
    v_accvgpr_write_b32 a38, v22
    v_mfma_f32_16x16x32_bf16 v[76:79], a[84:87], a[20:23], v[76:79]
    v_accvgpr_write_b32 a39, v23
    v_cvt_pk_bf16_f32 v24, v200, v201
    v_cvt_pk_bf16_f32 v25, v202, v203
    v_mfma_f32_16x16x32_bf16 v[76:79], a[88:91], a[24:27], v[76:79]
    v_cvt_pk_bf16_f32 v26, v216, v217
    v_cvt_pk_bf16_f32 v27, v218, v219
    v_accvgpr_write_b32 a40, v24
    v_mfma_f32_16x16x32_bf16 v[76:79], a[92:95], a[28:31], v[76:79]
    v_accvgpr_write_b32 a41, v25
    v_accvgpr_write_b32 a42, v26
    v_accvgpr_write_b32 a43, v27
    s_waitcnt lgkmcnt(7)
    v_mfma_f32_16x16x32_bf16 v[80:83], a[96:99], a[0:3], 0
    v_cvt_pk_bf16_f32 v28, v232, v233
    v_cvt_pk_bf16_f32 v29, v234, v235
    v_cvt_pk_bf16_f32 v30, v248, v249
    s_waitcnt lgkmcnt(6)
    v_mfma_f32_16x16x32_bf16 v[80:83], a[100:103], a[4:7], v[80:83]
    v_cvt_pk_bf16_f32 v31, v250, v251
    v_accvgpr_write_b32 a44, v28
    v_accvgpr_write_b32 a45, v29
    s_waitcnt lgkmcnt(5)
    v_mfma_f32_16x16x32_bf16 v[80:83], a[104:107], a[8:11], v[80:83]
    v_accvgpr_write_b32 a46, v30
    v_accvgpr_write_b32 a47, v31
    v_cvt_pk_bf16_f32 v16, v140, v141
    s_waitcnt lgkmcnt(4)
    v_mfma_f32_16x16x32_bf16 v[80:83], a[108:111], a[12:15], v[80:83]
    v_cvt_pk_bf16_f32 v17, v142, v143
    v_cvt_pk_bf16_f32 v18, v156, v157
    v_cvt_pk_bf16_f32 v19, v158, v159
    s_waitcnt lgkmcnt(3)
    v_mfma_f32_16x16x32_bf16 v[88:91], a[112:115], a[0:3], 0
    v_accvgpr_write_b32 a48, v16
    v_accvgpr_write_b32 a49, v17
    v_accvgpr_write_b32 a50, v18
    s_waitcnt lgkmcnt(2)
    v_mfma_f32_16x16x32_bf16 v[88:91], a[116:119], a[4:7], v[88:91]
    v_accvgpr_write_b32 a51, v19
    v_cvt_pk_bf16_f32 v20, v172, v173
    v_cvt_pk_bf16_f32 v21, v174, v175
    s_waitcnt lgkmcnt(1)
    v_mfma_f32_16x16x32_bf16 v[88:91], a[120:123], a[8:11], v[88:91]
    v_cvt_pk_bf16_f32 v22, v188, v189
    v_cvt_pk_bf16_f32 v23, v190, v191
    v_accvgpr_write_b32 a52, v20
    s_waitcnt lgkmcnt(0)
    v_mfma_f32_16x16x32_bf16 v[88:91], a[124:127], a[12:15], v[88:91]
    v_accvgpr_write_b32 a53, v21
    v_accvgpr_write_b32 a54, v22
    v_accvgpr_write_b32 a55, v23
    v_mfma_f32_16x16x32_bf16 v[84:87], a[96:99], a[16:19], 0
    v_cvt_pk_bf16_f32 v24, v204, v205
    v_cvt_pk_bf16_f32 v25, v206, v207
    v_cvt_pk_bf16_f32 v26, v220, v221
    v_mfma_f32_16x16x32_bf16 v[84:87], a[100:103], a[20:23], v[84:87]
    v_cvt_pk_bf16_f32 v27, v222, v223
    v_accvgpr_write_b32 a56, v24
    v_accvgpr_write_b32 a57, v25
    v_mfma_f32_16x16x32_bf16 v[84:87], a[104:107], a[24:27], v[84:87]
    v_accvgpr_write_b32 a58, v26
    v_accvgpr_write_b32 a59, v27
    v_cvt_pk_bf16_f32 v28, v236, v237
    v_mfma_f32_16x16x32_bf16 v[84:87], a[108:111], a[28:31], v[84:87]
    v_cvt_pk_bf16_f32 v29, v238, v239
    v_cvt_pk_bf16_f32 v30, v252, v253
    v_cvt_pk_bf16_f32 v31, v254, v255
    v_mfma_f32_16x16x32_bf16 v[92:95], a[112:115], a[16:19], 0
    v_accvgpr_write_b32 a60, v28
    v_accvgpr_write_b32 a61, v29
    v_accvgpr_write_b32 a62, v30
    v_mfma_f32_16x16x32_bf16 v[92:95], a[116:119], a[20:23], v[92:95]
    v_accvgpr_write_b32 a63, v31
    v_mov_b32 v8, 0
    v_mov_b32 v9, 0
    v_mfma_f32_16x16x32_bf16 v[92:95], a[120:123], a[24:27], v[92:95]
    v_max3_f32 v12, v64, v65, v66
    v_max3_f32 v12, v12, v67, v72
    v_max3_f32 v12, v12, v73, v74
    v_mfma_f32_16x16x32_bf16 v[92:95], a[124:127], a[28:31], v[92:95]
    v_max_f32 v12, v12, v75
    v_max3_f32 v13, v68, v69, v70
    v_max3_f32 v13, v13, v71, v76
    v_mfma_f32_16x16x32_bf16 v[96:99], a[64:67], a[32:35], 0
    v_max3_f32 v13, v13, v77, v78
    v_max_f32 v13, v13, v79
    v_mov_b32 v14, v12
    v_mfma_f32_16x16x32_bf16 v[96:99], a[68:71], a[36:39], v[96:99]
    v_mov_b32 v15, v13
    v_nop
    v_permlane16_swap_b32 v14, v12
    v_mfma_f32_16x16x32_bf16 v[96:99], a[72:75], a[40:43], v[96:99]
    v_permlane16_swap_b32 v15, v13
    v_max_f32 v12, v14, v12
    v_max_f32 v13, v15, v13
    v_mfma_f32_16x16x32_bf16 v[96:99], a[76:79], a[44:47], v[96:99]
    v_mov_b32 v14, v12
    v_mov_b32 v15, v13
    v_nop
    v_mfma_f32_16x16x32_bf16 v[104:107], a[80:83], a[32:35], 0
    v_permlane32_swap_b32 v14, v12
    v_permlane32_swap_b32 v15, v13
    v_max_f32 v12, v14, v12
    v_mfma_f32_16x16x32_bf16 v[104:107], a[84:87], a[36:39], v[104:107]
    v_max_f32 v13, v15, v13
    v_sub_f32 v48, 0, v12
    v_sub_f32 v49, 0, v12
    v_mfma_f32_16x16x32_bf16 v[104:107], a[88:91], a[40:43], v[104:107]
    v_sub_f32 v50, 0, v12
    v_sub_f32 v51, 0, v12
    v_sub_f32 v52, 0, v13
    v_mfma_f32_16x16x32_bf16 v[104:107], a[92:95], a[44:47], v[104:107]
    v_sub_f32 v53, 0, v13
    v_sub_f32 v54, 0, v13
    v_sub_f32 v55, 0, v13
    v_mfma_f32_16x16x32_bf16 v[100:103], a[64:67], a[48:51], 0
    v_add_f32 v64, v64, v48
    v_add_f32 v65, v65, v48
    v_add_f32 v66, v66, v48
    v_mfma_f32_16x16x32_bf16 v[100:103], a[68:71], a[52:55], v[100:103]
    v_add_f32 v67, v67, v48
    v_add_f32 v68, v68, v52
    v_add_f32 v69, v69, v52
    v_mfma_f32_16x16x32_bf16 v[100:103], a[72:75], a[56:59], v[100:103]
    v_add_f32 v70, v70, v52
    v_add_f32 v71, v71, v52
    v_add_f32 v72, v72, v48
    v_mfma_f32_16x16x32_bf16 v[100:103], a[76:79], a[60:63], v[100:103]
    v_add_f32 v73, v73, v48
    v_add_f32 v74, v74, v48
    v_add_f32 v75, v75, v48
    v_mfma_f32_16x16x32_bf16 v[108:111], a[80:83], a[48:51], 0
    v_add_f32 v76, v76, v52
    v_add_f32 v77, v77, v52
    v_add_f32 v78, v78, v52
    v_mfma_f32_16x16x32_bf16 v[108:111], a[84:87], a[52:55], v[108:111]
    v_add_f32 v79, v79, v52
    v_add_f32 v80, v80, v48
    v_add_f32 v81, v81, v48
    v_mfma_f32_16x16x32_bf16 v[108:111], a[88:91], a[56:59], v[108:111]
    v_add_f32 v82, v82, v48
    v_add_f32 v83, v83, v48
    v_add_f32 v84, v84, v52
    v_mfma_f32_16x16x32_bf16 v[108:111], a[92:95], a[60:63], v[108:111]
    v_add_f32 v85, v85, v52
    v_add_f32 v86, v86, v52
    v_add_f32 v87, v87, v52
    v_mfma_f32_16x16x32_bf16 v[112:115], a[96:99], a[32:35], 0
    v_add_f32 v88, v88, v48
    v_add_f32 v89, v89, v48
    v_add_f32 v90, v90, v48
    v_mfma_f32_16x16x32_bf16 v[112:115], a[100:103], a[36:39], v[112:115]
    v_add_f32 v91, v91, v48
    v_add_f32 v92, v92, v52
    v_add_f32 v93, v93, v52
    v_mfma_f32_16x16x32_bf16 v[112:115], a[104:107], a[40:43], v[112:115]
    v_add_f32 v94, v94, v52
    v_add_f32 v95, v95, v52
    s_waitcnt vmcnt(4)
    s_barrier
    v_exp_f32 v64, v64
    v_mfma_f32_16x16x32_bf16 v[112:115], a[108:111], a[44:47], v[112:115]
    ds_read_b64_tr_b16 a[128:129], v36 offset:0
    v_exp_f32 v65, v65
    v_add_f32 v8, v8, v64
    v_mfma_f32_16x16x32_bf16 v[120:123], a[112:115], a[32:35], 0
    ds_read_b64_tr_b16 a[130:131], v36 offset:4096
    v_exp_f32 v66, v66
    v_add_f32 v8, v8, v65
    v_mfma_f32_16x16x32_bf16 v[120:123], a[116:119], a[36:39], v[120:123]
    ds_read_b64_tr_b16 a[132:133], v36 offset:8192
    v_cvt_pk_bf16_f32 v64, v64, v65
    v_exp_f32 v67, v67
    v_mfma_f32_16x16x32_bf16 v[120:123], a[120:123], a[40:43], v[120:123]
    ds_read_b64_tr_b16 a[134:135], v36 offset:12288
    v_add_f32 v8, v8, v66
    v_exp_f32 v68, v68
    v_mfma_f32_16x16x32_bf16 v[120:123], a[124:127], a[44:47], v[120:123]
    ds_read_b64_tr_b16 a[136:137], v37 offset:0
    v_add_f32 v8, v8, v67
    v_cvt_pk_bf16_f32 v65, v66, v67
    v_exp_f32 v69, v69
    v_mfma_f32_16x16x32_bf16 v[116:119], a[96:99], a[48:51], 0
    ds_read_b64_tr_b16 a[138:139], v37 offset:4096
    v_add_f32 v9, v9, v68
    v_exp_f32 v70, v70
    v_mfma_f32_16x16x32_bf16 v[116:119], a[100:103], a[52:55], v[116:119]
    ds_read_b64_tr_b16 a[140:141], v37 offset:8192
    v_add_f32 v9, v9, v69
    v_cvt_pk_bf16_f32 v68, v68, v69
    v_exp_f32 v71, v71
    v_mfma_f32_16x16x32_bf16 v[116:119], a[104:107], a[56:59], v[116:119]
    ds_read_b64_tr_b16 a[142:143], v37 offset:12288
    v_add_f32 v9, v9, v70
    v_exp_f32 v72, v72
    v_mfma_f32_16x16x32_bf16 v[116:119], a[108:111], a[60:63], v[116:119]
    ds_read_b64_tr_b16 a[144:145], v38 offset:0
    v_add_f32 v9, v9, v71
    v_cvt_pk_bf16_f32 v69, v70, v71
    v_exp_f32 v73, v73
    v_mfma_f32_16x16x32_bf16 v[124:127], a[112:115], a[48:51], 0
    ds_read_b64_tr_b16 a[146:147], v38 offset:4096
    v_add_f32 v8, v8, v72
    v_exp_f32 v74, v74
    v_mfma_f32_16x16x32_bf16 v[124:127], a[116:119], a[52:55], v[124:127]
    ds_read_b64_tr_b16 a[148:149], v38 offset:8192
    v_max3_f32 v12, v96, v97, v98
    v_max3_f32 v12, v12, v99, v104
    v_max3_f32 v12, v12, v105, v106
    v_mfma_f32_16x16x32_bf16 v[124:127], a[120:123], a[56:59], v[124:127]
    ds_read_b64_tr_b16 a[150:151], v38 offset:12288
    v_max_f32 v12, v12, v107
    v_max3_f32 v13, v100, v101, v102
    v_max3_f32 v13, v13, v103, v108
    v_mfma_f32_16x16x32_bf16 v[124:127], a[124:127], a[60:63], v[124:127]
    ds_read_b64_tr_b16 a[152:153], v39 offset:0
    v_max3_f32 v13, v13, v109, v110
    v_max_f32 v13, v13, v111
    v_mov_b32 v14, v12
    v_mfma_f32_32x32x16_bf16 v[128:143], a[212:215], a[212:215], 0
    ds_read_b64_tr_b16 a[154:155], v39 offset:4096
    v_mov_b32 v15, v13
    v_nop
    v_permlane16_swap_b32 v14, v12
    v_permlane16_swap_b32 v15, v13
    v_max_f32 v12, v14, v12
    v_max_f32 v13, v15, v13
    v_mfma_f32_32x32x16_bf16 v[144:159], a[212:215], a[212:215], 0
    ds_read_b64_tr_b16 a[156:157], v39 offset:8192
    v_mov_b32 v14, v12
    v_mov_b32 v15, v13
    v_nop
    v_permlane32_swap_b32 v14, v12
    v_permlane32_swap_b32 v15, v13
    v_max_f32 v12, v14, v12
    v_mfma_f32_32x32x16_bf16 v[160:175], a[212:215], a[212:215], 0
    ds_read_b64_tr_b16 a[158:159], v39 offset:12288
    v_max_f32 v13, v15, v13
    v_sub_f32 v56, 0, v12
    v_sub_f32 v57, 0, v12
    v_sub_f32 v58, 0, v12
    v_sub_f32 v59, 0, v12
    v_sub_f32 v60, 0, v13
    v_mfma_f32_32x32x16_bf16 v[176:191], a[212:215], a[212:215], 0
    ds_read_b64_tr_b16 a[160:161], v40 offset:0
    v_sub_f32 v61, 0, v13
    v_sub_f32 v62, 0, v13
    v_sub_f32 v63, 0, v13
    v_add_f32 v8, v8, v73
    v_cvt_pk_bf16_f32 v66, v72, v73
    v_exp_f32 v75, v75
    v_mfma_f32_32x32x16_bf16 v[192:207], a[212:215], a[212:215], 0
    ds_read_b64_tr_b16 a[162:163], v40 offset:4096
    v_add_f32 v8, v8, v74
    v_exp_f32 v76, v76
    v_add_f32 v8, v8, v75
    v_cvt_pk_bf16_f32 v67, v74, v75
    v_exp_f32 v77, v77
    v_mfma_f32_32x32x16_bf16 v[208:223], a[212:215], a[212:215], 0
    ds_read_b64_tr_b16 a[164:165], v40 offset:8192
    v_add_f32 v9, v9, v76
    v_exp_f32 v78, v78
    v_add_f32 v9, v9, v77
    v_cvt_pk_bf16_f32 v70, v76, v77
    v_exp_f32 v79, v79
    v_mfma_f32_32x32x16_bf16 v[224:239], a[212:215], a[212:215], 0
    ds_read_b64_tr_b16 a[166:167], v40 offset:12288
    v_add_f32 v9, v9, v78
    v_exp_f32 v80, v80
    v_add_f32 v9, v9, v79
    v_cvt_pk_bf16_f32 v71, v78, v79
    v_exp_f32 v81, v81
    v_mfma_f32_32x32x16_bf16 v[240:255], a[212:215], a[212:215], 0
    ds_read_b64_tr_b16 a[168:169], v41 offset:0
    v_add_f32 v8, v8, v80
    v_exp_f32 v82, v82
    v_add_f32 v8, v8, v81
    v_cvt_pk_bf16_f32 v80, v80, v81
    v_exp_f32 v83, v83
    v_mfma_f32_32x32x16_bf16 a[192:207], a[212:215], a[212:215], 0
    ds_read_b64_tr_b16 a[170:171], v41 offset:4096
    v_add_f32 v8, v8, v82
    v_exp_f32 v84, v84
    v_add_f32 v8, v8, v83
    v_cvt_pk_bf16_f32 v81, v82, v83
    v_exp_f32 v85, v85
    ds_read_b64_tr_b16 a[172:173], v41 offset:8192
    ds_read_b64_tr_b16 a[174:175], v41 offset:12288
    ds_read_b64_tr_b16 a[176:177], v42 offset:0
    ds_read_b64_tr_b16 a[178:179], v42 offset:4096
    ds_read_b64_tr_b16 a[180:181], v42 offset:8192
    ds_read_b64_tr_b16 a[182:183], v42 offset:12288
    ds_read_b64_tr_b16 a[184:185], v43 offset:0
    ds_read_b64_tr_b16 a[186:187], v43 offset:4096
    ds_read_b64_tr_b16 a[188:189], v43 offset:8192
    ds_read_b64_tr_b16 a[190:191], v43 offset:12288
    v_add_f32 v9, v9, v84
    v_exp_f32 v86, v86
    v_add_f32 v9, v9, v85
    v_cvt_pk_bf16_f32 v84, v84, v85
    v_exp_f32 v87, v87
    v_add_f32 v9, v9, v86
    v_exp_f32 v88, v88
    v_add_f32 v9, v9, v87
    v_cvt_pk_bf16_f32 v85, v86, v87
    v_exp_f32 v89, v89
    v_add_f32 v8, v8, v88
    v_exp_f32 v90, v90
    v_add_f32 v8, v8, v89
    v_cvt_pk_bf16_f32 v82, v88, v89
    v_exp_f32 v91, v91
    v_exp_f32 v92, v92
    v_cvt_pk_bf16_f32 v83, v90, v91
    v_exp_f32 v93, v93
    v_exp_f32 v94, v94
    v_cvt_pk_bf16_f32 v86, v92, v93
    v_exp_f32 v95, v95
    s_nop 0
    v_cvt_pk_bf16_f32 v87, v94, v95
    v_add_f32 v96, v96, v56
    v_add_f32 v97, v97, v56
    v_add_f32 v98, v98, v56
    v_add_f32 v99, v99, v56
    v_add_f32 v100, v100, v60
    v_add_f32 v101, v101, v60
    v_add_f32 v102, v102, v60
    v_add_f32 v103, v103, v60
    v_add_f32 v104, v104, v56
    v_add_f32 v105, v105, v56
    v_add_f32 v106, v106, v56
    v_add_f32 v107, v107, v56
    v_add_f32 v108, v108, v60
    v_add_f32 v109, v109, v60
    v_add_f32 v110, v110, v60
    v_add_f32 v111, v111, v60
    v_add_f32 v112, v112, v56
    v_add_f32 v113, v113, v56
    v_add_f32 v114, v114, v56
    v_add_f32 v115, v115, v56
    v_add_f32 v116, v116, v60
    v_add_f32 v117, v117, v60
    v_add_f32 v118, v118, v60
    v_add_f32 v119, v119, v60
    v_add_f32 v120, v120, v56
    v_add_f32 v121, v121, v56
    v_add_f32 v122, v122, v56
    v_add_f32 v123, v123, v56
    v_add_f32 v124, v124, v60
    v_add_f32 v125, v125, v60
    v_add_f32 v126, v126, v60
    v_add_f32 v127, v127, v60
    v_exp_f32 v96, v96
    v_exp_f32 v97, v97
    v_exp_f32 v98, v98
    v_cvt_pk_bf16_f32 v96, v96, v97
    v_exp_f32 v99, v99
    v_exp_f32 v100, v100
    v_cvt_pk_bf16_f32 v97, v98, v99
    s_add_u32 s40, s37, 32768
    s_mov_b32 s41, 8
    s_mov_b32 s52, 486
    s_waitcnt lgkmcnt(0)
    s_branch L2_mid
.p2align 6
L2_loop:
    v_mfma_f32_16x16x32_bf16 v[96:99], a[64:67], a[32:35], v[56:59]
    v_exp_f32 v85, v85
    v_mfma_f32_16x16x32_bf16 v[96:99], a[68:71], a[36:39], v[96:99]
    ds_read_b64_tr_b16 a[160:161], v40 offset:0
    v_cvt_pk_bf16_f32 v84, v84, v85
    v_mfma_f32_16x16x32_bf16 v[96:99], a[72:75], a[40:43], v[96:99]
    v_exp_f32 v86, v86
    v_mfma_f32_16x16x32_bf16 v[96:99], a[76:79], a[44:47], v[96:99]
    ds_read_b64_tr_b16 a[162:163], v40 offset:4096
    v_add_f32 v9, v9, v85
    v_mfma_f32_16x16x32_bf16 v[100:103], a[64:67], a[48:51], v[60:63]
    v_exp_f32 v87, v87
    v_mfma_f32_16x16x32_bf16 v[100:103], a[68:71], a[52:55], v[100:103]
    ds_read_b64_tr_b16 a[164:165], v40 offset:8192
    v_cvt_pk_bf16_f32 v85, v86, v87
    v_mfma_f32_16x16x32_bf16 v[100:103], a[72:75], a[56:59], v[100:103]
    v_exp_f32 v88, v88
    v_mfma_f32_16x16x32_bf16 v[100:103], a[76:79], a[60:63], v[100:103]
    ds_read_b64_tr_b16 a[166:167], v40 offset:12288
    v_add_f32 v9, v9, v86
    v_mfma_f32_16x16x32_bf16 v[104:107], a[80:83], a[32:35], v[56:59]
    v_exp_f32 v89, v89
    v_mfma_f32_16x16x32_bf16 v[104:107], a[84:87], a[36:39], v[104:107]
    ds_read_b64_tr_b16 a[168:169], v41 offset:0
    v_cvt_pk_bf16_f32 v82, v88, v89
    v_mfma_f32_16x16x32_bf16 v[104:107], a[88:91], a[40:43], v[104:107]
    v_exp_f32 v90, v90
    v_mfma_f32_16x16x32_bf16 v[104:107], a[92:95], a[44:47], v[104:107]
    ds_read_b64_tr_b16 a[170:171], v41 offset:4096
    v_add_f32 v9, v9, v87
    v_mfma_f32_16x16x32_bf16 v[108:111], a[80:83], a[48:51], v[60:63]
    v_exp_f32 v91, v91
    v_mfma_f32_16x16x32_bf16 v[108:111], a[84:87], a[52:55], v[108:111]
    ds_read_b64_tr_b16 a[172:173], v41 offset:8192
    v_cvt_pk_bf16_f32 v83, v90, v91
    v_mfma_f32_16x16x32_bf16 v[108:111], a[88:91], a[56:59], v[108:111]
    v_exp_f32 v92, v92
    v_mfma_f32_16x16x32_bf16 v[108:111], a[92:95], a[60:63], v[108:111]
    ds_read_b64_tr_b16 a[174:175], v41 offset:12288
    v_add_f32 v9, v9, v77
    v_mfma_f32_16x16x32_bf16 v[112:115], a[96:99], a[32:35], v[56:59]
    v_exp_f32 v93, v93
    v_mfma_f32_16x16x32_bf16 v[112:115], a[100:103], a[36:39], v[112:115]
    ds_read_b64_tr_b16 a[176:177], v42 offset:0
    v_cvt_pk_bf16_f32 v86, v92, v93
    v_mfma_f32_16x16x32_bf16 v[112:115], a[104:107], a[40:43], v[112:115]
    v_exp_f32 v94, v94
    v_mfma_f32_16x16x32_bf16 v[112:115], a[108:111], a[44:47], v[112:115]
    ds_read_b64_tr_b16 a[178:179], v42 offset:4096
    v_add_f32 v9, v9, v78
    v_mfma_f32_16x16x32_bf16 v[116:119], a[96:99], a[48:51], v[60:63]
    v_exp_f32 v95, v95
    v_mfma_f32_16x16x32_bf16 v[116:119], a[100:103], a[52:55], v[116:119]
    ds_read_b64_tr_b16 a[180:181], v42 offset:8192
    v_cvt_pk_bf16_f32 v87, v94, v95
    v_mfma_f32_16x16x32_bf16 v[116:119], a[104:107], a[56:59], v[116:119]
    v_exp_f32 v96, v96
    v_mfma_f32_16x16x32_bf16 v[116:119], a[108:111], a[60:63], v[116:119]
    ds_read_b64_tr_b16 a[182:183], v42 offset:12288
    v_add_f32 v9, v9, v79
    v_mfma_f32_16x16x32_bf16 v[120:123], a[112:115], a[32:35], v[56:59]
    v_exp_f32 v97, v97
    v_mfma_f32_16x16x32_bf16 v[120:123], a[116:119], a[36:39], v[120:123]
    ds_read_b64_tr_b16 a[184:185], v43 offset:0
    v_cvt_pk_bf16_f32 v96, v96, v97
    v_mfma_f32_16x16x32_bf16 v[120:123], a[120:123], a[40:43], v[120:123]
    v_exp_f32 v98, v98
    v_mfma_f32_16x16x32_bf16 v[120:123], a[124:127], a[44:47], v[120:123]
    ds_read_b64_tr_b16 a[186:187], v43 offset:4096
    v_add_f32 v8, v8, v88
    v_mfma_f32_16x16x32_bf16 v[124:127], a[112:115], a[48:51], v[60:63]
    v_exp_f32 v99, v99
    v_mfma_f32_16x16x32_bf16 v[124:127], a[116:119], a[52:55], v[124:127]
    ds_read_b64_tr_b16 a[188:189], v43 offset:8192
    v_cvt_pk_bf16_f32 v97, v98, v99
    v_mfma_f32_16x16x32_bf16 v[124:127], a[120:123], a[56:59], v[124:127]
    s_waitcnt lgkmcnt(15)
    v_exp_f32 v100, v100
    v_mfma_f32_16x16x32_bf16 v[124:127], a[124:127], a[60:63], v[124:127]
    ds_read_b64_tr_b16 a[190:191], v43 offset:12288
    v_add_f32 v8, v8, v89
L2_mid:
    v_mfma_f32_16x16x32_bf16 v[128:131], a[128:131], v[64:67], v[128:131]
    v_exp_f32 v101, v101
    v_mfma_f32_16x16x32_bf16 v[128:131], a[132:135], v[80:83], v[128:131]
    ds_read_b128 a[64:67], v32 offset:16384
    v_cvt_pk_bf16_f32 v100, v100, v101
    v_mfma_f32_16x16x32_bf16 v[132:135], a[128:131], v[68:71], v[132:135]
    v_exp_f32 v102, v102
    v_mfma_f32_16x16x32_bf16 v[132:135], a[132:135], v[84:87], v[132:135]
    ds_read_b128 a[68:71], v33 offset:16384
    v_add_f32 v8, v8, v90
    v_mfma_f32_16x16x32_bf16 v[144:147], a[136:139], v[64:67], v[144:147]
    v_exp_f32 v103, v103
    v_mfma_f32_16x16x32_bf16 v[144:147], a[140:143], v[80:83], v[144:147]
    ds_read_b128 a[72:75], v34 offset:16384
    v_cvt_pk_bf16_f32 v101, v102, v103
    v_mfma_f32_16x16x32_bf16 v[148:151], a[136:139], v[68:71], v[148:151]
    v_exp_f32 v104, v104
    v_mfma_f32_16x16x32_bf16 v[148:151], a[140:143], v[84:87], v[148:151]
    ds_read_b128 a[76:79], v35 offset:16384
    v_add_f32 v8, v8, v91
    v_mfma_f32_16x16x32_bf16 v[160:163], a[144:147], v[64:67], v[160:163]
    v_exp_f32 v105, v105
    v_mfma_f32_16x16x32_bf16 v[160:163], a[148:151], v[80:83], v[160:163]
    ds_read_b128 a[80:83], v32 offset:20480
    v_cvt_pk_bf16_f32 v98, v104, v105
    v_mfma_f32_16x16x32_bf16 v[164:167], a[144:147], v[68:71], v[164:167]
    v_exp_f32 v106, v106
    v_mfma_f32_16x16x32_bf16 v[164:167], a[148:151], v[84:87], v[164:167]
    ds_read_b128 a[84:87], v33 offset:20480
    v_add_f32 v9, v9, v92
    v_mfma_f32_16x16x32_bf16 v[176:179], a[152:155], v[64:67], v[176:179]
    v_exp_f32 v107, v107
    v_mfma_f32_16x16x32_bf16 v[176:179], a[156:159], v[80:83], v[176:179]
    ds_read_b128 a[88:91], v34 offset:20480
    v_cvt_pk_bf16_f32 v99, v106, v107
    v_mfma_f32_16x16x32_bf16 v[180:183], a[152:155], v[68:71], v[180:183]
    s_waitcnt lgkmcnt(7)
    v_exp_f32 v108, v108
    v_mfma_f32_16x16x32_bf16 v[180:183], a[156:159], v[84:87], v[180:183]
    ds_read_b128 a[92:95], v35 offset:20480
    v_add_f32 v9, v9, v93
    v_mfma_f32_16x16x32_bf16 v[192:195], a[160:163], v[64:67], v[192:195]
    v_exp_f32 v109, v109
    v_mfma_f32_16x16x32_bf16 v[192:195], a[164:167], v[80:83], v[192:195]
    ds_read_b128 a[96:99], v32 offset:24576
    v_cvt_pk_bf16_f32 v102, v108, v109
    v_mfma_f32_16x16x32_bf16 v[196:199], a[160:163], v[68:71], v[196:199]
    v_exp_f32 v110, v110
    v_mfma_f32_16x16x32_bf16 v[196:199], a[164:167], v[84:87], v[196:199]
    ds_read_b128 a[100:103], v33 offset:24576
    v_add_f32 v9, v9, v94
    v_mfma_f32_16x16x32_bf16 v[208:211], a[168:171], v[64:67], v[208:211]
    v_exp_f32 v111, v111
    v_mfma_f32_16x16x32_bf16 v[208:211], a[172:175], v[80:83], v[208:211]
    ds_read_b128 a[104:107], v34 offset:24576
    v_cvt_pk_bf16_f32 v103, v110, v111
    v_mfma_f32_16x16x32_bf16 v[212:215], a[168:171], v[68:71], v[212:215]
    v_exp_f32 v112, v112
    v_mfma_f32_16x16x32_bf16 v[212:215], a[172:175], v[84:87], v[212:215]
    ds_read_b128 a[108:111], v35 offset:24576
    v_add_f32 v9, v9, v95
    v_mfma_f32_16x16x32_bf16 v[224:227], a[176:179], v[64:67], v[224:227]
    v_exp_f32 v113, v113
    v_mfma_f32_16x16x32_bf16 v[224:227], a[180:183], v[80:83], v[224:227]
    ds_read_b128 a[112:115], v32 offset:28672
    v_cvt_pk_bf16_f32 v112, v112, v113
    v_mfma_f32_16x16x32_bf16 v[228:231], a[176:179], v[68:71], v[228:231]
    v_exp_f32 v114, v114
    v_mfma_f32_16x16x32_bf16 v[228:231], a[180:183], v[84:87], v[228:231]
    ds_read_b128 a[116:119], v33 offset:28672
    v_mfma_f32_16x16x32_bf16 v[240:243], a[184:187], v[64:67], v[240:243]
    v_exp_f32 v115, v115
    v_mfma_f32_16x16x32_bf16 v[240:243], a[188:191], v[80:83], v[240:243]
    ds_read_b128 a[120:123], v34 offset:28672
    v_cvt_pk_bf16_f32 v113, v114, v115
    v_mfma_f32_16x16x32_bf16 v[244:247], a[184:187], v[68:71], v[244:247]
    s_waitcnt lgkmcnt(3)
    v_exp_f32 v116, v116
    v_mfma_f32_16x16x32_bf16 v[244:247], a[188:191], v[84:87], v[244:247]
    ds_read_b128 a[124:127], v35 offset:28672
    v_mfma_f32_16x16x32_bf16 v[64:67], a[64:67], a[0:3], v[48:51]
    s_add_u32 s40, s40, 16384
    v_exp_f32 v117, v117
    v_mfma_f32_16x16x32_bf16 v[64:67], a[68:71], a[4:7], v[64:67]
    v_cvt_pk_bf16_f32 v116, v116, v117
    v_mfma_f32_16x16x32_bf16 v[64:67], a[72:75], a[8:11], v[64:67]
    s_add_u32 m0, s37, 49152
    v_exp_f32 v118, v118
    v_mfma_f32_16x16x32_bf16 v[64:67], a[76:79], a[12:15], v[64:67]
    buffer_load_dwordx4 v44, s[12:15], s40 offen offset:0 sc1 lds
    v_mfma_f32_16x16x32_bf16 v[68:71], a[64:67], a[16:19], v[52:55]
    v_exp_f32 v119, v119
    v_mfma_f32_16x16x32_bf16 v[68:71], a[68:71], a[20:23], v[68:71]
    v_cvt_pk_bf16_f32 v117, v118, v119
    v_mfma_f32_16x16x32_bf16 v[68:71], a[72:75], a[24:27], v[68:71]
    v_exp_f32 v120, v120
    v_mfma_f32_16x16x32_bf16 v[68:71], a[76:79], a[28:31], v[68:71]
    buffer_load_dwordx4 v45, s[12:15], s40 offen offset:1024 sc1 lds
    v_mfma_f32_16x16x32_bf16 v[72:75], a[80:83], a[0:3], v[48:51]
    v_exp_f32 v121, v121
    v_mfma_f32_16x16x32_bf16 v[72:75], a[84:87], a[4:7], v[72:75]
    v_cvt_pk_bf16_f32 v114, v120, v121
    v_mfma_f32_16x16x32_bf16 v[72:75], a[88:91], a[8:11], v[72:75]
    v_exp_f32 v122, v122
    v_mfma_f32_16x16x32_bf16 v[72:75], a[92:95], a[12:15], v[72:75]
    buffer_load_dwordx4 v44, s[12:15], s40 offen offset:2048 sc1 lds
    v_mfma_f32_16x16x32_bf16 v[76:79], a[80:83], a[16:19], v[52:55]
    v_exp_f32 v123, v123
    v_mfma_f32_16x16x32_bf16 v[76:79], a[84:87], a[20:23], v[76:79]
    v_cvt_pk_bf16_f32 v115, v122, v123
    v_mfma_f32_16x16x32_bf16 v[76:79], a[88:91], a[24:27], v[76:79]
    v_exp_f32 v124, v124
    v_mfma_f32_16x16x32_bf16 v[76:79], a[92:95], a[28:31], v[76:79]
    buffer_load_dwordx4 v45, s[12:15], s40 offen offset:3072 sc1 lds
    v_mfma_f32_16x16x32_bf16 v[80:83], a[96:99], a[0:3], v[48:51]
    v_exp_f32 v125, v125
    v_mfma_f32_16x16x32_bf16 v[80:83], a[100:103], a[4:7], v[80:83]
    v_cvt_pk_bf16_f32 v118, v124, v125
    v_mfma_f32_16x16x32_bf16 v[80:83], a[104:107], a[8:11], v[80:83]
    s_add_u32 m0, s37, 114688
    v_exp_f32 v126, v126
    v_mfma_f32_16x16x32_bf16 v[80:83], a[108:111], a[12:15], v[80:83]
    buffer_load_dwordx4 v44, s[16:19], s40 offen offset:0 sc1 lds
    v_mfma_f32_16x16x32_bf16 v[84:87], a[96:99], a[16:19], v[52:55]
    v_exp_f32 v127, v127
    v_mfma_f32_16x16x32_bf16 v[84:87], a[100:103], a[20:23], v[84:87]
    buffer_load_dwordx4 v45, s[16:19], s40 offen offset:1024 sc1 lds
    v_cvt_pk_bf16_f32 v119, v126, v127
    v_mfma_f32_16x16x32_bf16 v[84:87], a[104:107], a[24:27], v[84:87]
    s_waitcnt lgkmcnt(0)
    v_exp_f32 v64, v64
    v_mfma_f32_16x16x32_bf16 v[84:87], a[108:111], a[28:31], v[84:87]
    v_add_f32 v8, v8, v64
    v_mfma_f32_16x16x32_bf16 v[88:91], a[112:115], a[0:3], v[48:51]
    v_exp_f32 v65, v65
    v_mfma_f32_16x16x32_bf16 v[88:91], a[116:119], a[4:7], v[88:91]
    buffer_load_dwordx4 v44, s[16:19], s40 offen offset:2048 sc1 lds
    v_cvt_pk_bf16_f32 v64, v64, v65
    v_mfma_f32_16x16x32_bf16 v[88:91], a[120:123], a[8:11], v[88:91]
    v_exp_f32 v66, v66
    v_mfma_f32_16x16x32_bf16 v[88:91], a[124:127], a[12:15], v[88:91]
    v_add_f32 v8, v8, v65
    v_add_f32 v8, v8, v66
    v_mfma_f32_16x16x32_bf16 v[92:95], a[112:115], a[16:19], v[52:55]
    v_exp_f32 v67, v67
    v_mfma_f32_16x16x32_bf16 v[92:95], a[116:119], a[20:23], v[92:95]
    buffer_load_dwordx4 v45, s[16:19], s40 offen offset:3072 sc1 lds
    v_cvt_pk_bf16_f32 v65, v66, v67
    v_mfma_f32_16x16x32_bf16 v[92:95], a[120:123], a[24:27], v[92:95]
    v_exp_f32 v68, v68
    v_mfma_f32_16x16x32_bf16 v[92:95], a[124:127], a[28:31], v[92:95]
    v_add_f32 v9, v9, v68
    v_add_f32 v8, v8, v67
    v_mfma_f32_16x16x32_bf16 v[136:139], a[128:131], v[96:99], v[136:139]
    v_exp_f32 v69, v69
    v_mfma_f32_16x16x32_bf16 v[136:139], a[132:135], v[112:115], v[136:139]
    v_cvt_pk_bf16_f32 v68, v68, v69
    v_mfma_f32_16x16x32_bf16 v[140:143], a[128:131], v[100:103], v[140:143]
    v_exp_f32 v70, v70
    v_mfma_f32_16x16x32_bf16 v[140:143], a[132:135], v[116:119], v[140:143]
    v_add_f32 v9, v9, v69
    v_add_f32 v9, v9, v70
    v_mfma_f32_16x16x32_bf16 v[152:155], a[136:139], v[96:99], v[152:155]
    v_exp_f32 v71, v71
    v_mfma_f32_16x16x32_bf16 v[152:155], a[140:143], v[112:115], v[152:155]
    ds_read_b64_tr_b16 a[128:129], v36 offset:16384
    v_cvt_pk_bf16_f32 v69, v70, v71
    v_mfma_f32_16x16x32_bf16 v[156:159], a[136:139], v[100:103], v[156:159]
    v_exp_f32 v72, v72
    v_mfma_f32_16x16x32_bf16 v[156:159], a[140:143], v[116:119], v[156:159]
    ds_read_b64_tr_b16 a[130:131], v36 offset:20480
    v_add_f32 v9, v9, v71
    v_mfma_f32_16x16x32_bf16 v[168:171], a[144:147], v[96:99], v[168:171]
    v_exp_f32 v73, v73
    v_mfma_f32_16x16x32_bf16 v[168:171], a[148:151], v[112:115], v[168:171]
    ds_read_b64_tr_b16 a[132:133], v36 offset:24576
    v_cvt_pk_bf16_f32 v66, v72, v73
    v_mfma_f32_16x16x32_bf16 v[172:175], a[144:147], v[100:103], v[172:175]
    v_exp_f32 v74, v74
    v_mfma_f32_16x16x32_bf16 v[172:175], a[148:151], v[116:119], v[172:175]
    ds_read_b64_tr_b16 a[134:135], v36 offset:28672
    v_add_f32 v8, v8, v72
    v_mfma_f32_16x16x32_bf16 v[184:187], a[152:155], v[96:99], v[184:187]
    v_exp_f32 v75, v75
    v_mfma_f32_16x16x32_bf16 v[184:187], a[156:159], v[112:115], v[184:187]
    ds_read_b64_tr_b16 a[136:137], v37 offset:16384
    v_cvt_pk_bf16_f32 v67, v74, v75
    v_mfma_f32_16x16x32_bf16 v[188:191], a[152:155], v[100:103], v[188:191]
    v_exp_f32 v76, v76
    v_mfma_f32_16x16x32_bf16 v[188:191], a[156:159], v[116:119], v[188:191]
    ds_read_b64_tr_b16 a[138:139], v37 offset:20480
    v_add_f32 v8, v8, v73
    v_mfma_f32_16x16x32_bf16 a[200:203], a[208:211], v[96:99], a[200:203]
    v_exp_f32 v77, v77
    v_mfma_f32_16x16x32_bf16 a[200:203], a[208:211], v[112:115], a[200:203]
    ds_read_b64_tr_b16 a[140:141], v37 offset:24576
    v_cvt_pk_bf16_f32 v70, v76, v77
    v_mfma_f32_16x16x32_bf16 v[200:203], a[160:163], v[96:99], v[200:203]
    v_exp_f32 v78, v78
    v_mfma_f32_16x16x32_bf16 v[200:203], a[164:167], v[112:115], v[200:203]
    ds_read_b64_tr_b16 a[142:143], v37 offset:28672
    v_add_f32 v8, v8, v74
    v_mfma_f32_16x16x32_bf16 v[204:207], a[160:163], v[100:103], v[204:207]
    v_exp_f32 v79, v79
    v_mfma_f32_16x16x32_bf16 v[204:207], a[164:167], v[116:119], v[204:207]
    ds_read_b64_tr_b16 a[144:145], v38 offset:16384
    v_cvt_pk_bf16_f32 v71, v78, v79
    v_mfma_f32_16x16x32_bf16 v[216:219], a[168:171], v[96:99], v[216:219]
    v_exp_f32 v80, v80
    v_mfma_f32_16x16x32_bf16 v[216:219], a[172:175], v[112:115], v[216:219]
    ds_read_b64_tr_b16 a[146:147], v38 offset:20480
    v_add_f32 v8, v8, v80
    v_mfma_f32_16x16x32_bf16 v[220:223], a[168:171], v[100:103], v[220:223]
    v_exp_f32 v81, v81
    v_mfma_f32_16x16x32_bf16 v[220:223], a[172:175], v[116:119], v[220:223]
    ds_read_b64_tr_b16 a[148:149], v38 offset:24576
    v_cvt_pk_bf16_f32 v80, v80, v81
    v_mfma_f32_16x16x32_bf16 v[232:235], a[176:179], v[96:99], v[232:235]
    v_exp_f32 v82, v82
    v_mfma_f32_16x16x32_bf16 v[232:235], a[180:183], v[112:115], v[232:235]
    ds_read_b64_tr_b16 a[150:151], v38 offset:28672
    v_add_f32 v8, v8, v81
    v_mfma_f32_16x16x32_bf16 v[236:239], a[176:179], v[100:103], v[236:239]
    v_exp_f32 v83, v83
    v_mfma_f32_16x16x32_bf16 v[236:239], a[180:183], v[116:119], v[236:239]
    ds_read_b64_tr_b16 a[152:153], v39 offset:16384
    v_cvt_pk_bf16_f32 v81, v82, v83
    v_mfma_f32_16x16x32_bf16 v[248:251], a[184:187], v[96:99], v[248:251]
    v_exp_f32 v84, v84
    v_mfma_f32_16x16x32_bf16 v[248:251], a[188:191], v[112:115], v[248:251]
    ds_read_b64_tr_b16 a[154:155], v39 offset:20480
    v_add_f32 v9, v9, v84
    v_mfma_f32_16x16x32_bf16 v[252:255], a[184:187], v[100:103], v[252:255]
    v_mfma_f32_16x16x32_bf16 v[252:255], a[188:191], v[116:119], v[252:255]
    ds_read_b64_tr_b16 a[156:157], v39 offset:24576
    v_add_f32 v8, v8, v82
    v_add_f32 v8, v8, v83
    v_add_f32 v8, v8, v75
    v_mfma_f32_16x16x32_bf16 a[204:207], a[208:211], v[100:103], a[204:207]
    s_waitcnt vmcnt(8)
    s_barrier
    v_mfma_f32_16x16x32_bf16 a[204:207], a[208:211], v[116:119], a[204:207]
    v_cmp_ne_u32 vcc, 16, v4
    ds_read_b64_tr_b16 a[158:159], v39 offset:28672
    v_add_f32 v9, v9, v76
    v_mfma_f32_16x16x32_bf16 v[96:99], a[64:67], a[32:35], v[56:59]
    v_exp_f32 v85, v85
    v_mfma_f32_16x16x32_bf16 v[96:99], a[68:71], a[36:39], v[96:99]
    ds_read_b64_tr_b16 a[160:161], v40 offset:16384
    v_cvt_pk_bf16_f32 v84, v84, v85
    v_mfma_f32_16x16x32_bf16 v[96:99], a[72:75], a[40:43], v[96:99]
    v_exp_f32 v86, v86
    v_mfma_f32_16x16x32_bf16 v[96:99], a[76:79], a[44:47], v[96:99]
    ds_read_b64_tr_b16 a[162:163], v40 offset:20480
    v_add_f32 v9, v9, v85
    v_mfma_f32_16x16x32_bf16 v[100:103], a[64:67], a[48:51], v[60:63]
    s_cmp_eq_u32 s41, 1
    v_exp_f32 v87, v87
    v_mfma_f32_16x16x32_bf16 v[100:103], a[68:71], a[52:55], v[100:103]
    ds_read_b64_tr_b16 a[164:165], v40 offset:24576
    v_cvt_pk_bf16_f32 v85, v86, v87
    v_mfma_f32_16x16x32_bf16 v[100:103], a[72:75], a[56:59], v[100:103]
    s_cselect_b32 s12, s8, s12
    v_exp_f32 v88, v88
    v_mfma_f32_16x16x32_bf16 v[100:103], a[76:79], a[60:63], v[100:103]
    ds_read_b64_tr_b16 a[166:167], v40 offset:28672
    v_add_f32 v9, v9, v86
    v_mfma_f32_16x16x32_bf16 v[104:107], a[80:83], a[32:35], v[56:59]
    s_cselect_b32 s13, s9, s13
    v_exp_f32 v89, v89
    v_mfma_f32_16x16x32_bf16 v[104:107], a[84:87], a[36:39], v[104:107]
    ds_read_b64_tr_b16 a[168:169], v41 offset:16384
    v_cvt_pk_bf16_f32 v82, v88, v89
    v_mfma_f32_16x16x32_bf16 v[104:107], a[88:91], a[40:43], v[104:107]
    s_cselect_b32 s14, 0x100000, s14
    v_exp_f32 v90, v90
    v_mfma_f32_16x16x32_bf16 v[104:107], a[92:95], a[44:47], v[104:107]
    ds_read_b64_tr_b16 a[170:171], v41 offset:20480
    v_add_f32 v9, v9, v87
    v_mfma_f32_16x16x32_bf16 v[108:111], a[80:83], a[48:51], v[60:63]
    s_cselect_b32 s16, s70, s16
    v_exp_f32 v91, v91
    v_mfma_f32_16x16x32_bf16 v[108:111], a[84:87], a[52:55], v[108:111]
    ds_read_b64_tr_b16 a[172:173], v41 offset:24576
    v_cvt_pk_bf16_f32 v83, v90, v91
    v_mfma_f32_16x16x32_bf16 v[108:111], a[88:91], a[56:59], v[108:111]
    v_exp_f32 v92, v92
    v_mfma_f32_16x16x32_bf16 v[108:111], a[92:95], a[60:63], v[108:111]
    ds_read_b64_tr_b16 a[174:175], v41 offset:28672
    v_add_f32 v9, v9, v77
    v_mfma_f32_16x16x32_bf16 v[112:115], a[96:99], a[32:35], v[56:59]
    s_cselect_b32 s17, s71, s17
    v_exp_f32 v93, v93
    v_mfma_f32_16x16x32_bf16 v[112:115], a[100:103], a[36:39], v[112:115]
    ds_read_b64_tr_b16 a[176:177], v42 offset:16384
    v_cvt_pk_bf16_f32 v86, v92, v93
    v_mfma_f32_16x16x32_bf16 v[112:115], a[104:107], a[40:43], v[112:115]
    s_cselect_b32 s18, 0x100000, s18
    v_exp_f32 v94, v94
    v_mfma_f32_16x16x32_bf16 v[112:115], a[108:111], a[44:47], v[112:115]
    ds_read_b64_tr_b16 a[178:179], v42 offset:20480
    v_add_f32 v9, v9, v78
    v_mfma_f32_16x16x32_bf16 v[116:119], a[96:99], a[48:51], v[60:63]
    s_cbranch_vccnz L2_wspin
L2_wback:
    v_exp_f32 v95, v95
    v_mfma_f32_16x16x32_bf16 v[116:119], a[100:103], a[52:55], v[116:119]
    ds_read_b64_tr_b16 a[180:181], v42 offset:24576
    v_cvt_pk_bf16_f32 v87, v94, v95
    v_mfma_f32_16x16x32_bf16 v[116:119], a[104:107], a[56:59], v[116:119]
    v_exp_f32 v96, v96
    v_mfma_f32_16x16x32_bf16 v[116:119], a[108:111], a[60:63], v[116:119]
    ds_read_b64_tr_b16 a[182:183], v42 offset:28672
    v_add_f32 v9, v9, v79
    v_mfma_f32_16x16x32_bf16 v[120:123], a[112:115], a[32:35], v[56:59]
    v_exp_f32 v97, v97
    v_mfma_f32_16x16x32_bf16 v[120:123], a[116:119], a[36:39], v[120:123]
    ds_read_b64_tr_b16 a[184:185], v43 offset:16384
    v_cvt_pk_bf16_f32 v96, v96, v97
    v_mfma_f32_16x16x32_bf16 v[120:123], a[120:123], a[40:43], v[120:123]
    v_exp_f32 v98, v98
    v_mfma_f32_16x16x32_bf16 v[120:123], a[124:127], a[44:47], v[120:123]
    ds_read_b64_tr_b16 a[186:187], v43 offset:20480
    v_add_f32 v8, v8, v88
    v_mfma_f32_16x16x32_bf16 v[124:127], a[112:115], a[48:51], v[60:63]
    v_exp_f32 v99, v99
    v_mfma_f32_16x16x32_bf16 v[124:127], a[116:119], a[52:55], v[124:127]
    ds_read_b64_tr_b16 a[188:189], v43 offset:24576
    v_cvt_pk_bf16_f32 v97, v98, v99
    v_mfma_f32_16x16x32_bf16 v[124:127], a[120:123], a[56:59], v[124:127]
    s_waitcnt lgkmcnt(15)
    v_exp_f32 v100, v100
    v_mfma_f32_16x16x32_bf16 v[124:127], a[124:127], a[60:63], v[124:127]
    ds_read_b64_tr_b16 a[190:191], v43 offset:28672
    v_add_f32 v8, v8, v89
    v_mfma_f32_16x16x32_bf16 v[128:131], a[128:131], v[64:67], v[128:131]
    v_exp_f32 v101, v101
    v_mfma_f32_16x16x32_bf16 v[128:131], a[132:135], v[80:83], v[128:131]
    ds_read_b128 a[64:67], v32 offset:32768
    v_cvt_pk_bf16_f32 v100, v100, v101
    v_mfma_f32_16x16x32_bf16 v[132:135], a[128:131], v[68:71], v[132:135]
    v_exp_f32 v102, v102
    v_mfma_f32_16x16x32_bf16 v[132:135], a[132:135], v[84:87], v[132:135]
    ds_read_b128 a[68:71], v33 offset:32768
    v_add_f32 v8, v8, v90
    v_mfma_f32_16x16x32_bf16 v[144:147], a[136:139], v[64:67], v[144:147]
    v_exp_f32 v103, v103
    v_mfma_f32_16x16x32_bf16 v[144:147], a[140:143], v[80:83], v[144:147]
    ds_read_b128 a[72:75], v34 offset:32768
    v_cvt_pk_bf16_f32 v101, v102, v103
    v_mfma_f32_16x16x32_bf16 v[148:151], a[136:139], v[68:71], v[148:151]
    v_exp_f32 v104, v104
    v_mfma_f32_16x16x32_bf16 v[148:151], a[140:143], v[84:87], v[148:151]
    ds_read_b128 a[76:79], v35 offset:32768
    v_add_f32 v8, v8, v91
    v_mfma_f32_16x16x32_bf16 v[160:163], a[144:147], v[64:67], v[160:163]
    v_exp_f32 v105, v105
    v_mfma_f32_16x16x32_bf16 v[160:163], a[148:151], v[80:83], v[160:163]
    ds_read_b128 a[80:83], v32 offset:36864
    v_cvt_pk_bf16_f32 v98, v104, v105
    v_mfma_f32_16x16x32_bf16 v[164:167], a[144:147], v[68:71], v[164:167]
    v_exp_f32 v106, v106
    v_mfma_f32_16x16x32_bf16 v[164:167], a[148:151], v[84:87], v[164:167]
    ds_read_b128 a[84:87], v33 offset:36864
    v_add_f32 v9, v9, v92
    v_mfma_f32_16x16x32_bf16 v[176:179], a[152:155], v[64:67], v[176:179]
    v_exp_f32 v107, v107
    v_mfma_f32_16x16x32_bf16 v[176:179], a[156:159], v[80:83], v[176:179]
    ds_read_b128 a[88:91], v34 offset:36864
    v_cvt_pk_bf16_f32 v99, v106, v107
    v_mfma_f32_16x16x32_bf16 v[180:183], a[152:155], v[68:71], v[180:183]
    s_waitcnt lgkmcnt(7)
    v_exp_f32 v108, v108
    v_mfma_f32_16x16x32_bf16 v[180:183], a[156:159], v[84:87], v[180:183]
    ds_read_b128 a[92:95], v35 offset:36864
    v_add_f32 v9, v9, v93
    v_mfma_f32_16x16x32_bf16 v[192:195], a[160:163], v[64:67], v[192:195]
    v_exp_f32 v109, v109
    v_mfma_f32_16x16x32_bf16 v[192:195], a[164:167], v[80:83], v[192:195]
    ds_read_b128 a[96:99], v32 offset:40960
    v_cvt_pk_bf16_f32 v102, v108, v109
    v_mfma_f32_16x16x32_bf16 v[196:199], a[160:163], v[68:71], v[196:199]
    v_exp_f32 v110, v110
    v_mfma_f32_16x16x32_bf16 v[196:199], a[164:167], v[84:87], v[196:199]
    ds_read_b128 a[100:103], v33 offset:40960
    v_add_f32 v9, v9, v94
    v_mfma_f32_16x16x32_bf16 v[208:211], a[168:171], v[64:67], v[208:211]
    v_exp_f32 v111, v111
    v_mfma_f32_16x16x32_bf16 v[208:211], a[172:175], v[80:83], v[208:211]
    ds_read_b128 a[104:107], v34 offset:40960
    v_cvt_pk_bf16_f32 v103, v110, v111
    v_mfma_f32_16x16x32_bf16 v[212:215], a[168:171], v[68:71], v[212:215]
    v_exp_f32 v112, v112
    v_mfma_f32_16x16x32_bf16 v[212:215], a[172:175], v[84:87], v[212:215]
    ds_read_b128 a[108:111], v35 offset:40960
    v_add_f32 v9, v9, v95
    v_mfma_f32_16x16x32_bf16 v[224:227], a[176:179], v[64:67], v[224:227]
    v_exp_f32 v113, v113
    v_mfma_f32_16x16x32_bf16 v[224:227], a[180:183], v[80:83], v[224:227]
    ds_read_b128 a[112:115], v32 offset:45056
    v_cvt_pk_bf16_f32 v112, v112, v113
    v_mfma_f32_16x16x32_bf16 v[228:231], a[176:179], v[68:71], v[228:231]
    v_exp_f32 v114, v114
    v_mfma_f32_16x16x32_bf16 v[228:231], a[180:183], v[84:87], v[228:231]
    ds_read_b128 a[116:119], v33 offset:45056
    v_mfma_f32_16x16x32_bf16 v[240:243], a[184:187], v[64:67], v[240:243]
    v_exp_f32 v115, v115
    v_mfma_f32_16x16x32_bf16 v[240:243], a[188:191], v[80:83], v[240:243]
    ds_read_b128 a[120:123], v34 offset:45056
    v_cvt_pk_bf16_f32 v113, v114, v115
    v_mfma_f32_16x16x32_bf16 v[244:247], a[184:187], v[68:71], v[244:247]
    s_waitcnt lgkmcnt(3)
    v_exp_f32 v116, v116
    v_mfma_f32_16x16x32_bf16 v[244:247], a[188:191], v[84:87], v[244:247]
    ds_read_b128 a[124:127], v35 offset:45056
    v_mfma_f32_16x16x32_bf16 v[64:67], a[64:67], a[0:3], v[48:51]
    s_add_u32 s40, s40, 16384
    v_exp_f32 v117, v117
    v_mfma_f32_16x16x32_bf16 v[64:67], a[68:71], a[4:7], v[64:67]
    v_cvt_pk_bf16_f32 v116, v116, v117
    v_mfma_f32_16x16x32_bf16 v[64:67], a[72:75], a[8:11], v[64:67]
    s_add_u32 m0, s37, 0
    v_exp_f32 v118, v118
    v_mfma_f32_16x16x32_bf16 v[64:67], a[76:79], a[12:15], v[64:67]
    buffer_load_dwordx4 v44, s[12:15], s40 offen offset:0 sc1 lds
    v_mfma_f32_16x16x32_bf16 v[68:71], a[64:67], a[16:19], v[52:55]
    v_exp_f32 v119, v119
    v_mfma_f32_16x16x32_bf16 v[68:71], a[68:71], a[20:23], v[68:71]
    v_cvt_pk_bf16_f32 v117, v118, v119
    v_mfma_f32_16x16x32_bf16 v[68:71], a[72:75], a[24:27], v[68:71]
    v_exp_f32 v120, v120
    v_mfma_f32_16x16x32_bf16 v[68:71], a[76:79], a[28:31], v[68:71]
    buffer_load_dwordx4 v45, s[12:15], s40 offen offset:1024 sc1 lds
    v_mfma_f32_16x16x32_bf16 v[72:75], a[80:83], a[0:3], v[48:51]
    v_exp_f32 v121, v121
    v_mfma_f32_16x16x32_bf16 v[72:75], a[84:87], a[4:7], v[72:75]
    v_cvt_pk_bf16_f32 v114, v120, v121
    v_mfma_f32_16x16x32_bf16 v[72:75], a[88:91], a[8:11], v[72:75]
    v_exp_f32 v122, v122
    v_mfma_f32_16x16x32_bf16 v[72:75], a[92:95], a[12:15], v[72:75]
    buffer_load_dwordx4 v44, s[12:15], s40 offen offset:2048 sc1 lds
    v_mfma_f32_16x16x32_bf16 v[76:79], a[80:83], a[16:19], v[52:55]
    v_exp_f32 v123, v123
    v_mfma_f32_16x16x32_bf16 v[76:79], a[84:87], a[20:23], v[76:79]
    v_cvt_pk_bf16_f32 v115, v122, v123
    v_mfma_f32_16x16x32_bf16 v[76:79], a[88:91], a[24:27], v[76:79]
    v_exp_f32 v124, v124
    v_mfma_f32_16x16x32_bf16 v[76:79], a[92:95], a[28:31], v[76:79]
    buffer_load_dwordx4 v45, s[12:15], s40 offen offset:3072 sc1 lds
    v_mfma_f32_16x16x32_bf16 v[80:83], a[96:99], a[0:3], v[48:51]
    v_exp_f32 v125, v125
    v_mfma_f32_16x16x32_bf16 v[80:83], a[100:103], a[4:7], v[80:83]
    v_cvt_pk_bf16_f32 v118, v124, v125
    v_mfma_f32_16x16x32_bf16 v[80:83], a[104:107], a[8:11], v[80:83]
    s_add_u32 m0, s37, 65536
    v_exp_f32 v126, v126
    v_mfma_f32_16x16x32_bf16 v[80:83], a[108:111], a[12:15], v[80:83]
    buffer_load_dwordx4 v44, s[16:19], s40 offen offset:0 sc1 lds
    v_mfma_f32_16x16x32_bf16 v[84:87], a[96:99], a[16:19], v[52:55]
    v_exp_f32 v127, v127
    v_mfma_f32_16x16x32_bf16 v[84:87], a[100:103], a[20:23], v[84:87]
    buffer_load_dwordx4 v45, s[16:19], s40 offen offset:1024 sc1 lds
    v_cvt_pk_bf16_f32 v119, v126, v127
    v_mfma_f32_16x16x32_bf16 v[84:87], a[104:107], a[24:27], v[84:87]
    s_waitcnt lgkmcnt(0)
    v_exp_f32 v64, v64
    v_mfma_f32_16x16x32_bf16 v[84:87], a[108:111], a[28:31], v[84:87]
    v_add_f32 v8, v8, v64
    v_mfma_f32_16x16x32_bf16 v[88:91], a[112:115], a[0:3], v[48:51]
    v_exp_f32 v65, v65
    v_mfma_f32_16x16x32_bf16 v[88:91], a[116:119], a[4:7], v[88:91]
    buffer_load_dwordx4 v44, s[16:19], s40 offen offset:2048 sc1 lds
    v_cvt_pk_bf16_f32 v64, v64, v65
    v_mfma_f32_16x16x32_bf16 v[88:91], a[120:123], a[8:11], v[88:91]
    v_exp_f32 v66, v66
    v_mfma_f32_16x16x32_bf16 v[88:91], a[124:127], a[12:15], v[88:91]
    v_add_f32 v8, v8, v65
    v_add_f32 v8, v8, v66
    v_mfma_f32_16x16x32_bf16 v[92:95], a[112:115], a[16:19], v[52:55]
    v_exp_f32 v67, v67
    v_mfma_f32_16x16x32_bf16 v[92:95], a[116:119], a[20:23], v[92:95]
    buffer_load_dwordx4 v45, s[16:19], s40 offen offset:3072 sc1 lds
    v_cvt_pk_bf16_f32 v65, v66, v67
    v_mfma_f32_16x16x32_bf16 v[92:95], a[120:123], a[24:27], v[92:95]
    v_exp_f32 v68, v68
    v_mfma_f32_16x16x32_bf16 v[92:95], a[124:127], a[28:31], v[92:95]
    v_add_f32 v9, v9, v68
    v_add_f32 v8, v8, v67
    v_mfma_f32_16x16x32_bf16 v[136:139], a[128:131], v[96:99], v[136:139]
    v_exp_f32 v69, v69
    v_mfma_f32_16x16x32_bf16 v[136:139], a[132:135], v[112:115], v[136:139]
    v_cvt_pk_bf16_f32 v68, v68, v69
    v_mfma_f32_16x16x32_bf16 v[140:143], a[128:131], v[100:103], v[140:143]
    v_exp_f32 v70, v70
    v_mfma_f32_16x16x32_bf16 v[140:143], a[132:135], v[116:119], v[140:143]
    v_add_f32 v9, v9, v69
    v_add_f32 v9, v9, v70
    v_mfma_f32_16x16x32_bf16 v[152:155], a[136:139], v[96:99], v[152:155]
    v_exp_f32 v71, v71
    v_mfma_f32_16x16x32_bf16 v[152:155], a[140:143], v[112:115], v[152:155]
    ds_read_b64_tr_b16 a[128:129], v36 offset:32768
    v_cvt_pk_bf16_f32 v69, v70, v71
    v_mfma_f32_16x16x32_bf16 v[156:159], a[136:139], v[100:103], v[156:159]
    v_exp_f32 v72, v72
    v_mfma_f32_16x16x32_bf16 v[156:159], a[140:143], v[116:119], v[156:159]
    ds_read_b64_tr_b16 a[130:131], v36 offset:36864
    v_add_f32 v9, v9, v71
    v_mfma_f32_16x16x32_bf16 v[168:171], a[144:147], v[96:99], v[168:171]
    v_exp_f32 v73, v73
    v_mfma_f32_16x16x32_bf16 v[168:171], a[148:151], v[112:115], v[168:171]
    ds_read_b64_tr_b16 a[132:133], v36 offset:40960
    v_cvt_pk_bf16_f32 v66, v72, v73
    v_mfma_f32_16x16x32_bf16 v[172:175], a[144:147], v[100:103], v[172:175]
    v_exp_f32 v74, v74
    v_mfma_f32_16x16x32_bf16 v[172:175], a[148:151], v[116:119], v[172:175]
    ds_read_b64_tr_b16 a[134:135], v36 offset:45056
    v_add_f32 v8, v8, v72
    v_mfma_f32_16x16x32_bf16 v[184:187], a[152:155], v[96:99], v[184:187]
    v_exp_f32 v75, v75
    v_mfma_f32_16x16x32_bf16 v[184:187], a[156:159], v[112:115], v[184:187]
    ds_read_b64_tr_b16 a[136:137], v37 offset:32768
    v_cvt_pk_bf16_f32 v67, v74, v75
    v_mfma_f32_16x16x32_bf16 v[188:191], a[152:155], v[100:103], v[188:191]
    v_exp_f32 v76, v76
    v_mfma_f32_16x16x32_bf16 v[188:191], a[156:159], v[116:119], v[188:191]
    ds_read_b64_tr_b16 a[138:139], v37 offset:36864
    v_add_f32 v8, v8, v73
    v_mfma_f32_16x16x32_bf16 a[200:203], a[208:211], v[96:99], a[200:203]
    v_exp_f32 v77, v77
    v_mfma_f32_16x16x32_bf16 a[200:203], a[208:211], v[112:115], a[200:203]
    ds_read_b64_tr_b16 a[140:141], v37 offset:40960
    v_cvt_pk_bf16_f32 v70, v76, v77
    v_mfma_f32_16x16x32_bf16 v[200:203], a[160:163], v[96:99], v[200:203]
    v_exp_f32 v78, v78
    v_mfma_f32_16x16x32_bf16 v[200:203], a[164:167], v[112:115], v[200:203]
    ds_read_b64_tr_b16 a[142:143], v37 offset:45056
    v_add_f32 v8, v8, v74
    v_mfma_f32_16x16x32_bf16 v[204:207], a[160:163], v[100:103], v[204:207]
    v_exp_f32 v79, v79
    v_mfma_f32_16x16x32_bf16 v[204:207], a[164:167], v[116:119], v[204:207]
    ds_read_b64_tr_b16 a[144:145], v38 offset:32768
    v_cvt_pk_bf16_f32 v71, v78, v79
    v_mfma_f32_16x16x32_bf16 v[216:219], a[168:171], v[96:99], v[216:219]
    v_exp_f32 v80, v80
    v_mfma_f32_16x16x32_bf16 v[216:219], a[172:175], v[112:115], v[216:219]
    ds_read_b64_tr_b16 a[146:147], v38 offset:36864
    v_add_f32 v8, v8, v80
    v_mfma_f32_16x16x32_bf16 v[220:223], a[168:171], v[100:103], v[220:223]
    v_exp_f32 v81, v81
    v_mfma_f32_16x16x32_bf16 v[220:223], a[172:175], v[116:119], v[220:223]
    ds_read_b64_tr_b16 a[148:149], v38 offset:40960
    v_cvt_pk_bf16_f32 v80, v80, v81
    v_mfma_f32_16x16x32_bf16 v[232:235], a[176:179], v[96:99], v[232:235]
    v_exp_f32 v82, v82
    v_mfma_f32_16x16x32_bf16 v[232:235], a[180:183], v[112:115], v[232:235]
    ds_read_b64_tr_b16 a[150:151], v38 offset:45056
    v_add_f32 v8, v8, v81
    v_mfma_f32_16x16x32_bf16 v[236:239], a[176:179], v[100:103], v[236:239]
    v_exp_f32 v83, v83
    v_mfma_f32_16x16x32_bf16 v[236:239], a[180:183], v[116:119], v[236:239]
    ds_read_b64_tr_b16 a[152:153], v39 offset:32768
    v_cvt_pk_bf16_f32 v81, v82, v83
    v_mfma_f32_16x16x32_bf16 v[248:251], a[184:187], v[96:99], v[248:251]
    v_exp_f32 v84, v84
    v_mfma_f32_16x16x32_bf16 v[248:251], a[188:191], v[112:115], v[248:251]
    ds_read_b64_tr_b16 a[154:155], v39 offset:36864
    v_add_f32 v9, v9, v84
    v_mfma_f32_16x16x32_bf16 v[252:255], a[184:187], v[100:103], v[252:255]
    v_mfma_f32_16x16x32_bf16 v[252:255], a[188:191], v[116:119], v[252:255]
    ds_read_b64_tr_b16 a[156:157], v39 offset:40960
    v_add_f32 v8, v8, v82
    v_add_f32 v8, v8, v83
    v_add_f32 v8, v8, v75
    v_mfma_f32_16x16x32_bf16 a[204:207], a[208:211], v[100:103], a[204:207]
    s_waitcnt vmcnt(8)
    s_barrier
    v_mfma_f32_16x16x32_bf16 a[204:207], a[208:211], v[116:119], a[204:207]
    ds_read_b64_tr_b16 a[158:159], v39 offset:45056
    v_add_f32 v9, v9, v76
    v_mfma_f32_16x16x32_bf16 v[96:99], a[64:67], a[32:35], v[56:59]
    v_exp_f32 v85, v85
    v_mfma_f32_16x16x32_bf16 v[96:99], a[68:71], a[36:39], v[96:99]
    ds_read_b64_tr_b16 a[160:161], v40 offset:32768
    v_cvt_pk_bf16_f32 v84, v84, v85
    v_mfma_f32_16x16x32_bf16 v[96:99], a[72:75], a[40:43], v[96:99]
    v_exp_f32 v86, v86
    v_mfma_f32_16x16x32_bf16 v[96:99], a[76:79], a[44:47], v[96:99]
    ds_read_b64_tr_b16 a[162:163], v40 offset:36864
    v_add_f32 v9, v9, v85
    v_mfma_f32_16x16x32_bf16 v[100:103], a[64:67], a[48:51], v[60:63]
    v_exp_f32 v87, v87
    v_mfma_f32_16x16x32_bf16 v[100:103], a[68:71], a[52:55], v[100:103]
    ds_read_b64_tr_b16 a[164:165], v40 offset:40960
    v_cvt_pk_bf16_f32 v85, v86, v87
    v_mfma_f32_16x16x32_bf16 v[100:103], a[72:75], a[56:59], v[100:103]
    v_exp_f32 v88, v88
    v_mfma_f32_16x16x32_bf16 v[100:103], a[76:79], a[60:63], v[100:103]
    ds_read_b64_tr_b16 a[166:167], v40 offset:45056
    v_add_f32 v9, v9, v86
    v_mfma_f32_16x16x32_bf16 v[104:107], a[80:83], a[32:35], v[56:59]
    v_exp_f32 v89, v89
    v_mfma_f32_16x16x32_bf16 v[104:107], a[84:87], a[36:39], v[104:107]
    ds_read_b64_tr_b16 a[168:169], v41 offset:32768
    v_cvt_pk_bf16_f32 v82, v88, v89
    v_mfma_f32_16x16x32_bf16 v[104:107], a[88:91], a[40:43], v[104:107]
    v_exp_f32 v90, v90
    v_mfma_f32_16x16x32_bf16 v[104:107], a[92:95], a[44:47], v[104:107]
    ds_read_b64_tr_b16 a[170:171], v41 offset:36864
    v_add_f32 v9, v9, v87
    v_mfma_f32_16x16x32_bf16 v[108:111], a[80:83], a[48:51], v[60:63]
    v_exp_f32 v91, v91
    v_mfma_f32_16x16x32_bf16 v[108:111], a[84:87], a[52:55], v[108:111]
    ds_read_b64_tr_b16 a[172:173], v41 offset:40960
    v_cvt_pk_bf16_f32 v83, v90, v91
    v_mfma_f32_16x16x32_bf16 v[108:111], a[88:91], a[56:59], v[108:111]
    v_exp_f32 v92, v92
    v_mfma_f32_16x16x32_bf16 v[108:111], a[92:95], a[60:63], v[108:111]
    ds_read_b64_tr_b16 a[174:175], v41 offset:45056
    v_add_f32 v9, v9, v77
    v_mfma_f32_16x16x32_bf16 v[112:115], a[96:99], a[32:35], v[56:59]
    v_exp_f32 v93, v93
    v_mfma_f32_16x16x32_bf16 v[112:115], a[100:103], a[36:39], v[112:115]
    ds_read_b64_tr_b16 a[176:177], v42 offset:32768
    v_cvt_pk_bf16_f32 v86, v92, v93
    v_mfma_f32_16x16x32_bf16 v[112:115], a[104:107], a[40:43], v[112:115]
    v_exp_f32 v94, v94
    v_mfma_f32_16x16x32_bf16 v[112:115], a[108:111], a[44:47], v[112:115]
    ds_read_b64_tr_b16 a[178:179], v42 offset:36864
    v_add_f32 v9, v9, v78
    v_mfma_f32_16x16x32_bf16 v[116:119], a[96:99], a[48:51], v[60:63]
    v_exp_f32 v95, v95
    v_mfma_f32_16x16x32_bf16 v[116:119], a[100:103], a[52:55], v[116:119]
    ds_read_b64_tr_b16 a[180:181], v42 offset:40960
    v_cvt_pk_bf16_f32 v87, v94, v95
    v_mfma_f32_16x16x32_bf16 v[116:119], a[104:107], a[56:59], v[116:119]
    v_exp_f32 v96, v96
    v_mfma_f32_16x16x32_bf16 v[116:119], a[108:111], a[60:63], v[116:119]
    ds_read_b64_tr_b16 a[182:183], v42 offset:45056
    v_add_f32 v9, v9, v79
    v_mfma_f32_16x16x32_bf16 v[120:123], a[112:115], a[32:35], v[56:59]
    v_exp_f32 v97, v97
    v_mfma_f32_16x16x32_bf16 v[120:123], a[116:119], a[36:39], v[120:123]
    ds_read_b64_tr_b16 a[184:185], v43 offset:32768
    v_cvt_pk_bf16_f32 v96, v96, v97
    v_mfma_f32_16x16x32_bf16 v[120:123], a[120:123], a[40:43], v[120:123]
    v_exp_f32 v98, v98
    v_mfma_f32_16x16x32_bf16 v[120:123], a[124:127], a[44:47], v[120:123]
    ds_read_b64_tr_b16 a[186:187], v43 offset:36864
    v_add_f32 v8, v8, v88
    v_mfma_f32_16x16x32_bf16 v[124:127], a[112:115], a[48:51], v[60:63]
    v_exp_f32 v99, v99
    v_mfma_f32_16x16x32_bf16 v[124:127], a[116:119], a[52:55], v[124:127]
    ds_read_b64_tr_b16 a[188:189], v43 offset:40960
    v_cvt_pk_bf16_f32 v97, v98, v99
    v_mfma_f32_16x16x32_bf16 v[124:127], a[120:123], a[56:59], v[124:127]
    s_waitcnt lgkmcnt(15)
    v_exp_f32 v100, v100
    v_mfma_f32_16x16x32_bf16 v[124:127], a[124:127], a[60:63], v[124:127]
    ds_read_b64_tr_b16 a[190:191], v43 offset:45056
    v_add_f32 v8, v8, v89
    v_mfma_f32_16x16x32_bf16 v[128:131], a[128:131], v[64:67], v[128:131]
    v_exp_f32 v101, v101
    v_mfma_f32_16x16x32_bf16 v[128:131], a[132:135], v[80:83], v[128:131]
    ds_read_b128 a[64:67], v32 offset:49152
    v_cvt_pk_bf16_f32 v100, v100, v101
    v_mfma_f32_16x16x32_bf16 v[132:135], a[128:131], v[68:71], v[132:135]
    v_exp_f32 v102, v102
    v_mfma_f32_16x16x32_bf16 v[132:135], a[132:135], v[84:87], v[132:135]
    ds_read_b128 a[68:71], v33 offset:49152
    v_add_f32 v8, v8, v90
    v_mfma_f32_16x16x32_bf16 v[144:147], a[136:139], v[64:67], v[144:147]
    v_exp_f32 v103, v103
    v_mfma_f32_16x16x32_bf16 v[144:147], a[140:143], v[80:83], v[144:147]
    ds_read_b128 a[72:75], v34 offset:49152
    v_cvt_pk_bf16_f32 v101, v102, v103
    v_mfma_f32_16x16x32_bf16 v[148:151], a[136:139], v[68:71], v[148:151]
    v_exp_f32 v104, v104
    v_mfma_f32_16x16x32_bf16 v[148:151], a[140:143], v[84:87], v[148:151]
    ds_read_b128 a[76:79], v35 offset:49152
    v_add_f32 v8, v8, v91
    v_mfma_f32_16x16x32_bf16 v[160:163], a[144:147], v[64:67], v[160:163]
    v_exp_f32 v105, v105
    v_mfma_f32_16x16x32_bf16 v[160:163], a[148:151], v[80:83], v[160:163]
    ds_read_b128 a[80:83], v32 offset:53248
    v_cvt_pk_bf16_f32 v98, v104, v105
    v_mfma_f32_16x16x32_bf16 v[164:167], a[144:147], v[68:71], v[164:167]
    v_exp_f32 v106, v106
    v_mfma_f32_16x16x32_bf16 v[164:167], a[148:151], v[84:87], v[164:167]
    ds_read_b128 a[84:87], v33 offset:53248
    v_add_f32 v9, v9, v92
    v_mfma_f32_16x16x32_bf16 v[176:179], a[152:155], v[64:67], v[176:179]
    v_exp_f32 v107, v107
    v_mfma_f32_16x16x32_bf16 v[176:179], a[156:159], v[80:83], v[176:179]
    ds_read_b128 a[88:91], v34 offset:53248
    v_cvt_pk_bf16_f32 v99, v106, v107
    v_mfma_f32_16x16x32_bf16 v[180:183], a[152:155], v[68:71], v[180:183]
    s_waitcnt lgkmcnt(7)
    v_exp_f32 v108, v108
    v_mfma_f32_16x16x32_bf16 v[180:183], a[156:159], v[84:87], v[180:183]
    ds_read_b128 a[92:95], v35 offset:53248
    v_add_f32 v9, v9, v93
    v_mfma_f32_16x16x32_bf16 v[192:195], a[160:163], v[64:67], v[192:195]
    v_exp_f32 v109, v109
    v_mfma_f32_16x16x32_bf16 v[192:195], a[164:167], v[80:83], v[192:195]
    ds_read_b128 a[96:99], v32 offset:57344
    v_cvt_pk_bf16_f32 v102, v108, v109
    v_mfma_f32_16x16x32_bf16 v[196:199], a[160:163], v[68:71], v[196:199]
    v_exp_f32 v110, v110
    v_mfma_f32_16x16x32_bf16 v[196:199], a[164:167], v[84:87], v[196:199]
    ds_read_b128 a[100:103], v33 offset:57344
    v_add_f32 v9, v9, v94
    v_mfma_f32_16x16x32_bf16 v[208:211], a[168:171], v[64:67], v[208:211]
    v_exp_f32 v111, v111
    v_mfma_f32_16x16x32_bf16 v[208:211], a[172:175], v[80:83], v[208:211]
    ds_read_b128 a[104:107], v34 offset:57344
    v_cvt_pk_bf16_f32 v103, v110, v111
    v_mfma_f32_16x16x32_bf16 v[212:215], a[168:171], v[68:71], v[212:215]
    v_exp_f32 v112, v112
    v_mfma_f32_16x16x32_bf16 v[212:215], a[172:175], v[84:87], v[212:215]
    ds_read_b128 a[108:111], v35 offset:57344
    v_add_f32 v9, v9, v95
    v_mfma_f32_16x16x32_bf16 v[224:227], a[176:179], v[64:67], v[224:227]
    v_exp_f32 v113, v113
    v_mfma_f32_16x16x32_bf16 v[224:227], a[180:183], v[80:83], v[224:227]
    ds_read_b128 a[112:115], v32 offset:61440
    v_cvt_pk_bf16_f32 v112, v112, v113
    v_mfma_f32_16x16x32_bf16 v[228:231], a[176:179], v[68:71], v[228:231]
    v_exp_f32 v114, v114
    v_mfma_f32_16x16x32_bf16 v[228:231], a[180:183], v[84:87], v[228:231]
    ds_read_b128 a[116:119], v33 offset:61440
    v_mfma_f32_16x16x32_bf16 v[240:243], a[184:187], v[64:67], v[240:243]
    v_exp_f32 v115, v115
    v_mfma_f32_16x16x32_bf16 v[240:243], a[188:191], v[80:83], v[240:243]
    ds_read_b128 a[120:123], v34 offset:61440
    v_cvt_pk_bf16_f32 v113, v114, v115
    v_mfma_f32_16x16x32_bf16 v[244:247], a[184:187], v[68:71], v[244:247]
    s_waitcnt lgkmcnt(3)
    v_exp_f32 v116, v116
    v_mfma_f32_16x16x32_bf16 v[244:247], a[188:191], v[84:87], v[244:247]
    ds_read_b128 a[124:127], v35 offset:61440
    v_mfma_f32_16x16x32_bf16 v[64:67], a[64:67], a[0:3], v[48:51]
    s_add_u32 s40, s40, 16384
    v_exp_f32 v117, v117
    v_mfma_f32_16x16x32_bf16 v[64:67], a[68:71], a[4:7], v[64:67]
    v_cvt_pk_bf16_f32 v116, v116, v117
    v_mfma_f32_16x16x32_bf16 v[64:67], a[72:75], a[8:11], v[64:67]
    s_add_u32 m0, s37, 16384
    v_exp_f32 v118, v118
    v_mfma_f32_16x16x32_bf16 v[64:67], a[76:79], a[12:15], v[64:67]
    buffer_load_dwordx4 v44, s[12:15], s40 offen offset:0 sc1 lds
    v_mfma_f32_16x16x32_bf16 v[68:71], a[64:67], a[16:19], v[52:55]
    v_exp_f32 v119, v119
    v_mfma_f32_16x16x32_bf16 v[68:71], a[68:71], a[20:23], v[68:71]
    v_cvt_pk_bf16_f32 v117, v118, v119
    v_mfma_f32_16x16x32_bf16 v[68:71], a[72:75], a[24:27], v[68:71]
    v_exp_f32 v120, v120
    v_mfma_f32_16x16x32_bf16 v[68:71], a[76:79], a[28:31], v[68:71]
    buffer_load_dwordx4 v45, s[12:15], s40 offen offset:1024 sc1 lds
    v_mfma_f32_16x16x32_bf16 v[72:75], a[80:83], a[0:3], v[48:51]
    v_exp_f32 v121, v121
    v_mfma_f32_16x16x32_bf16 v[72:75], a[84:87], a[4:7], v[72:75]
    v_cvt_pk_bf16_f32 v114, v120, v121
    v_mfma_f32_16x16x32_bf16 v[72:75], a[88:91], a[8:11], v[72:75]
    v_exp_f32 v122, v122
    v_mfma_f32_16x16x32_bf16 v[72:75], a[92:95], a[12:15], v[72:75]
    buffer_load_dwordx4 v44, s[12:15], s40 offen offset:2048 sc1 lds
    v_mfma_f32_16x16x32_bf16 v[76:79], a[80:83], a[16:19], v[52:55]
    v_exp_f32 v123, v123
    v_mfma_f32_16x16x32_bf16 v[76:79], a[84:87], a[20:23], v[76:79]
    v_cvt_pk_bf16_f32 v115, v122, v123
    v_mfma_f32_16x16x32_bf16 v[76:79], a[88:91], a[24:27], v[76:79]
    v_exp_f32 v124, v124
    v_mfma_f32_16x16x32_bf16 v[76:79], a[92:95], a[28:31], v[76:79]
    buffer_load_dwordx4 v45, s[12:15], s40 offen offset:3072 sc1 lds
    v_mfma_f32_16x16x32_bf16 v[80:83], a[96:99], a[0:3], v[48:51]
    v_exp_f32 v125, v125
    v_mfma_f32_16x16x32_bf16 v[80:83], a[100:103], a[4:7], v[80:83]
    v_cvt_pk_bf16_f32 v118, v124, v125
    v_mfma_f32_16x16x32_bf16 v[80:83], a[104:107], a[8:11], v[80:83]
    s_add_u32 m0, s37, 81920
    v_exp_f32 v126, v126
    v_mfma_f32_16x16x32_bf16 v[80:83], a[108:111], a[12:15], v[80:83]
    buffer_load_dwordx4 v44, s[16:19], s40 offen offset:0 sc1 lds
    v_mfma_f32_16x16x32_bf16 v[84:87], a[96:99], a[16:19], v[52:55]
    v_exp_f32 v127, v127
    v_mfma_f32_16x16x32_bf16 v[84:87], a[100:103], a[20:23], v[84:87]
    buffer_load_dwordx4 v45, s[16:19], s40 offen offset:1024 sc1 lds
    v_cvt_pk_bf16_f32 v119, v126, v127
    v_mfma_f32_16x16x32_bf16 v[84:87], a[104:107], a[24:27], v[84:87]
    s_waitcnt lgkmcnt(0)
    v_exp_f32 v64, v64
    v_mfma_f32_16x16x32_bf16 v[84:87], a[108:111], a[28:31], v[84:87]
    v_add_f32 v8, v8, v64
    v_mfma_f32_16x16x32_bf16 v[88:91], a[112:115], a[0:3], v[48:51]
    v_exp_f32 v65, v65
    v_mfma_f32_16x16x32_bf16 v[88:91], a[116:119], a[4:7], v[88:91]
    buffer_load_dwordx4 v44, s[16:19], s40 offen offset:2048 sc1 lds
    v_cvt_pk_bf16_f32 v64, v64, v65
    v_mfma_f32_16x16x32_bf16 v[88:91], a[120:123], a[8:11], v[88:91]
    v_exp_f32 v66, v66
    v_mfma_f32_16x16x32_bf16 v[88:91], a[124:127], a[12:15], v[88:91]
    v_add_f32 v8, v8, v65
    v_add_f32 v8, v8, v66
    v_mfma_f32_16x16x32_bf16 v[92:95], a[112:115], a[16:19], v[52:55]
    v_exp_f32 v67, v67
    v_mfma_f32_16x16x32_bf16 v[92:95], a[116:119], a[20:23], v[92:95]
    buffer_load_dwordx4 v45, s[16:19], s40 offen offset:3072 sc1 lds
    v_cvt_pk_bf16_f32 v65, v66, v67
    v_mfma_f32_16x16x32_bf16 v[92:95], a[120:123], a[24:27], v[92:95]
    v_exp_f32 v68, v68
    v_mfma_f32_16x16x32_bf16 v[92:95], a[124:127], a[28:31], v[92:95]
    v_add_f32 v9, v9, v68
    v_add_f32 v8, v8, v67
    v_mfma_f32_16x16x32_bf16 v[136:139], a[128:131], v[96:99], v[136:139]
    v_exp_f32 v69, v69
    v_mfma_f32_16x16x32_bf16 v[136:139], a[132:135], v[112:115], v[136:139]
    v_cvt_pk_bf16_f32 v68, v68, v69
    v_mfma_f32_16x16x32_bf16 v[140:143], a[128:131], v[100:103], v[140:143]
    v_exp_f32 v70, v70
    v_mfma_f32_16x16x32_bf16 v[140:143], a[132:135], v[116:119], v[140:143]
    v_add_f32 v9, v9, v69
    v_add_f32 v9, v9, v70
    v_mfma_f32_16x16x32_bf16 v[152:155], a[136:139], v[96:99], v[152:155]
    v_exp_f32 v71, v71
    v_mfma_f32_16x16x32_bf16 v[152:155], a[140:143], v[112:115], v[152:155]
    ds_read_b64_tr_b16 a[128:129], v36 offset:49152
    v_cvt_pk_bf16_f32 v69, v70, v71
    v_mfma_f32_16x16x32_bf16 v[156:159], a[136:139], v[100:103], v[156:159]
    v_exp_f32 v72, v72
    v_mfma_f32_16x16x32_bf16 v[156:159], a[140:143], v[116:119], v[156:159]
    ds_read_b64_tr_b16 a[130:131], v36 offset:53248
    v_add_f32 v9, v9, v71
    v_mfma_f32_16x16x32_bf16 v[168:171], a[144:147], v[96:99], v[168:171]
    v_exp_f32 v73, v73
    v_mfma_f32_16x16x32_bf16 v[168:171], a[148:151], v[112:115], v[168:171]
    ds_read_b64_tr_b16 a[132:133], v36 offset:57344
    v_cvt_pk_bf16_f32 v66, v72, v73
    v_mfma_f32_16x16x32_bf16 v[172:175], a[144:147], v[100:103], v[172:175]
    v_exp_f32 v74, v74
    v_mfma_f32_16x16x32_bf16 v[172:175], a[148:151], v[116:119], v[172:175]
    ds_read_b64_tr_b16 a[134:135], v36 offset:61440
    v_add_f32 v8, v8, v72
    v_mfma_f32_16x16x32_bf16 v[184:187], a[152:155], v[96:99], v[184:187]
    v_exp_f32 v75, v75
    v_mfma_f32_16x16x32_bf16 v[184:187], a[156:159], v[112:115], v[184:187]
    ds_read_b64_tr_b16 a[136:137], v37 offset:49152
    v_cvt_pk_bf16_f32 v67, v74, v75
    v_mfma_f32_16x16x32_bf16 v[188:191], a[152:155], v[100:103], v[188:191]
    v_exp_f32 v76, v76
    v_mfma_f32_16x16x32_bf16 v[188:191], a[156:159], v[116:119], v[188:191]
    ds_read_b64_tr_b16 a[138:139], v37 offset:53248
    v_add_f32 v8, v8, v73
    v_mfma_f32_16x16x32_bf16 a[200:203], a[208:211], v[96:99], a[200:203]
    v_exp_f32 v77, v77
    v_mfma_f32_16x16x32_bf16 a[200:203], a[208:211], v[112:115], a[200:203]
    ds_read_b64_tr_b16 a[140:141], v37 offset:57344
    v_cvt_pk_bf16_f32 v70, v76, v77
    v_mfma_f32_16x16x32_bf16 v[200:203], a[160:163], v[96:99], v[200:203]
    v_exp_f32 v78, v78
    v_mfma_f32_16x16x32_bf16 v[200:203], a[164:167], v[112:115], v[200:203]
    ds_read_b64_tr_b16 a[142:143], v37 offset:61440
    v_add_f32 v8, v8, v74
    v_mfma_f32_16x16x32_bf16 v[204:207], a[160:163], v[100:103], v[204:207]
    v_exp_f32 v79, v79
    v_mfma_f32_16x16x32_bf16 v[204:207], a[164:167], v[116:119], v[204:207]
    ds_read_b64_tr_b16 a[144:145], v38 offset:49152
    v_cvt_pk_bf16_f32 v71, v78, v79
    v_mfma_f32_16x16x32_bf16 v[216:219], a[168:171], v[96:99], v[216:219]
    v_exp_f32 v80, v80
    v_mfma_f32_16x16x32_bf16 v[216:219], a[172:175], v[112:115], v[216:219]
    ds_read_b64_tr_b16 a[146:147], v38 offset:53248
    v_add_f32 v8, v8, v80
    v_mfma_f32_16x16x32_bf16 v[220:223], a[168:171], v[100:103], v[220:223]
    v_exp_f32 v81, v81
    v_mfma_f32_16x16x32_bf16 v[220:223], a[172:175], v[116:119], v[220:223]
    ds_read_b64_tr_b16 a[148:149], v38 offset:57344
    v_cvt_pk_bf16_f32 v80, v80, v81
    v_mfma_f32_16x16x32_bf16 v[232:235], a[176:179], v[96:99], v[232:235]
    v_exp_f32 v82, v82
    v_mfma_f32_16x16x32_bf16 v[232:235], a[180:183], v[112:115], v[232:235]
    ds_read_b64_tr_b16 a[150:151], v38 offset:61440
    v_add_f32 v8, v8, v81
    v_mfma_f32_16x16x32_bf16 v[236:239], a[176:179], v[100:103], v[236:239]
    v_exp_f32 v83, v83
    v_mfma_f32_16x16x32_bf16 v[236:239], a[180:183], v[116:119], v[236:239]
    ds_read_b64_tr_b16 a[152:153], v39 offset:49152
    v_cvt_pk_bf16_f32 v81, v82, v83
    v_mfma_f32_16x16x32_bf16 v[248:251], a[184:187], v[96:99], v[248:251]
    s_bitcmp1_b32 s52, s41
    v_exp_f32 v84, v84
    v_mfma_f32_16x16x32_bf16 v[248:251], a[188:191], v[112:115], v[248:251]
    ds_read_b64_tr_b16 a[154:155], v39 offset:53248
    v_add_f32 v9, v9, v84
    v_mfma_f32_16x16x32_bf16 v[252:255], a[184:187], v[100:103], v[252:255]
    v_mfma_f32_16x16x32_bf16 v[252:255], a[188:191], v[116:119], v[252:255]
    ds_read_b64_tr_b16 a[156:157], v39 offset:57344
    v_add_f32 v8, v8, v82
    v_add_f32 v8, v8, v83
    v_add_f32 v8, v8, v75
    v_mfma_f32_16x16x32_bf16 a[204:207], a[208:211], v[100:103], a[204:207]
    s_waitcnt vmcnt(8)
    s_barrier
    v_mfma_f32_16x16x32_bf16 a[204:207], a[208:211], v[116:119], a[204:207]
    s_cbranch_scc1 L2_bg
L2_bgb:
    ds_read_b64_tr_b16 a[158:159], v39 offset:61440
    v_add_f32 v9, v9, v76
    v_mfma_f32_16x16x32_bf16 v[96:99], a[64:67], a[32:35], v[56:59]
    v_exp_f32 v85, v85
    v_mfma_f32_16x16x32_bf16 v[96:99], a[68:71], a[36:39], v[96:99]
    ds_read_b64_tr_b16 a[160:161], v40 offset:49152
    v_cvt_pk_bf16_f32 v84, v84, v85
    v_mfma_f32_16x16x32_bf16 v[96:99], a[72:75], a[40:43], v[96:99]
    v_exp_f32 v86, v86
    v_mfma_f32_16x16x32_bf16 v[96:99], a[76:79], a[44:47], v[96:99]
    ds_read_b64_tr_b16 a[162:163], v40 offset:53248
    v_add_f32 v9, v9, v85
    v_mfma_f32_16x16x32_bf16 v[100:103], a[64:67], a[48:51], v[60:63]
    v_exp_f32 v87, v87
    v_mfma_f32_16x16x32_bf16 v[100:103], a[68:71], a[52:55], v[100:103]
    ds_read_b64_tr_b16 a[164:165], v40 offset:57344
    v_cvt_pk_bf16_f32 v85, v86, v87
    v_mfma_f32_16x16x32_bf16 v[100:103], a[72:75], a[56:59], v[100:103]
    v_exp_f32 v88, v88
    v_mfma_f32_16x16x32_bf16 v[100:103], a[76:79], a[60:63], v[100:103]
    ds_read_b64_tr_b16 a[166:167], v40 offset:61440
    v_add_f32 v9, v9, v86
    v_mfma_f32_16x16x32_bf16 v[104:107], a[80:83], a[32:35], v[56:59]
    v_exp_f32 v89, v89
    v_mfma_f32_16x16x32_bf16 v[104:107], a[84:87], a[36:39], v[104:107]
    ds_read_b64_tr_b16 a[168:169], v41 offset:49152
    v_cvt_pk_bf16_f32 v82, v88, v89
    v_mfma_f32_16x16x32_bf16 v[104:107], a[88:91], a[40:43], v[104:107]
    v_exp_f32 v90, v90
    v_mfma_f32_16x16x32_bf16 v[104:107], a[92:95], a[44:47], v[104:107]
    ds_read_b64_tr_b16 a[170:171], v41 offset:53248
    v_add_f32 v9, v9, v87
    v_mfma_f32_16x16x32_bf16 v[108:111], a[80:83], a[48:51], v[60:63]
    v_exp_f32 v91, v91
    v_mfma_f32_16x16x32_bf16 v[108:111], a[84:87], a[52:55], v[108:111]
    ds_read_b64_tr_b16 a[172:173], v41 offset:57344
    v_cvt_pk_bf16_f32 v83, v90, v91
    v_mfma_f32_16x16x32_bf16 v[108:111], a[88:91], a[56:59], v[108:111]
    v_exp_f32 v92, v92
    v_mfma_f32_16x16x32_bf16 v[108:111], a[92:95], a[60:63], v[108:111]
    ds_read_b64_tr_b16 a[174:175], v41 offset:61440
    v_add_f32 v9, v9, v77
    v_mfma_f32_16x16x32_bf16 v[112:115], a[96:99], a[32:35], v[56:59]
    v_exp_f32 v93, v93
    v_mfma_f32_16x16x32_bf16 v[112:115], a[100:103], a[36:39], v[112:115]
    ds_read_b64_tr_b16 a[176:177], v42 offset:49152
    v_cvt_pk_bf16_f32 v86, v92, v93
    v_mfma_f32_16x16x32_bf16 v[112:115], a[104:107], a[40:43], v[112:115]
    v_exp_f32 v94, v94
    v_mfma_f32_16x16x32_bf16 v[112:115], a[108:111], a[44:47], v[112:115]
    ds_read_b64_tr_b16 a[178:179], v42 offset:53248
    v_add_f32 v9, v9, v78
    v_mfma_f32_16x16x32_bf16 v[116:119], a[96:99], a[48:51], v[60:63]
    v_exp_f32 v95, v95
    v_mfma_f32_16x16x32_bf16 v[116:119], a[100:103], a[52:55], v[116:119]
    ds_read_b64_tr_b16 a[180:181], v42 offset:57344
    v_cvt_pk_bf16_f32 v87, v94, v95
    v_mfma_f32_16x16x32_bf16 v[116:119], a[104:107], a[56:59], v[116:119]
    v_exp_f32 v96, v96
    v_mfma_f32_16x16x32_bf16 v[116:119], a[108:111], a[60:63], v[116:119]
    ds_read_b64_tr_b16 a[182:183], v42 offset:61440
    v_add_f32 v9, v9, v79
    v_mfma_f32_16x16x32_bf16 v[120:123], a[112:115], a[32:35], v[56:59]
    v_exp_f32 v97, v97
    v_mfma_f32_16x16x32_bf16 v[120:123], a[116:119], a[36:39], v[120:123]
    ds_read_b64_tr_b16 a[184:185], v43 offset:49152
    v_cvt_pk_bf16_f32 v96, v96, v97
    v_mfma_f32_16x16x32_bf16 v[120:123], a[120:123], a[40:43], v[120:123]
    v_exp_f32 v98, v98
    v_mfma_f32_16x16x32_bf16 v[120:123], a[124:127], a[44:47], v[120:123]
    ds_read_b64_tr_b16 a[186:187], v43 offset:53248
    v_add_f32 v8, v8, v88
    v_mfma_f32_16x16x32_bf16 v[124:127], a[112:115], a[48:51], v[60:63]
    v_exp_f32 v99, v99
    v_mfma_f32_16x16x32_bf16 v[124:127], a[116:119], a[52:55], v[124:127]
    ds_read_b64_tr_b16 a[188:189], v43 offset:57344
    v_cvt_pk_bf16_f32 v97, v98, v99
    v_mfma_f32_16x16x32_bf16 v[124:127], a[120:123], a[56:59], v[124:127]
    s_waitcnt lgkmcnt(15)
    v_exp_f32 v100, v100
    v_mfma_f32_16x16x32_bf16 v[124:127], a[124:127], a[60:63], v[124:127]
    ds_read_b64_tr_b16 a[190:191], v43 offset:61440
    v_add_f32 v8, v8, v89
    v_mfma_f32_16x16x32_bf16 v[128:131], a[128:131], v[64:67], v[128:131]
    v_exp_f32 v101, v101
    v_mfma_f32_16x16x32_bf16 v[128:131], a[132:135], v[80:83], v[128:131]
    ds_read_b128 a[64:67], v32 offset:0
    v_cvt_pk_bf16_f32 v100, v100, v101
    v_mfma_f32_16x16x32_bf16 v[132:135], a[128:131], v[68:71], v[132:135]
    v_exp_f32 v102, v102
    v_mfma_f32_16x16x32_bf16 v[132:135], a[132:135], v[84:87], v[132:135]
    ds_read_b128 a[68:71], v33 offset:0
    v_add_f32 v8, v8, v90
    v_mfma_f32_16x16x32_bf16 v[144:147], a[136:139], v[64:67], v[144:147]
    v_exp_f32 v103, v103
    v_mfma_f32_16x16x32_bf16 v[144:147], a[140:143], v[80:83], v[144:147]
    ds_read_b128 a[72:75], v34 offset:0
    v_cvt_pk_bf16_f32 v101, v102, v103
    v_mfma_f32_16x16x32_bf16 v[148:151], a[136:139], v[68:71], v[148:151]
    v_exp_f32 v104, v104
    v_mfma_f32_16x16x32_bf16 v[148:151], a[140:143], v[84:87], v[148:151]
    ds_read_b128 a[76:79], v35 offset:0
    v_add_f32 v8, v8, v91
    v_mfma_f32_16x16x32_bf16 v[160:163], a[144:147], v[64:67], v[160:163]
    v_exp_f32 v105, v105
    v_mfma_f32_16x16x32_bf16 v[160:163], a[148:151], v[80:83], v[160:163]
    ds_read_b128 a[80:83], v32 offset:4096
    v_cvt_pk_bf16_f32 v98, v104, v105
    v_mfma_f32_16x16x32_bf16 v[164:167], a[144:147], v[68:71], v[164:167]
    v_exp_f32 v106, v106
    v_mfma_f32_16x16x32_bf16 v[164:167], a[148:151], v[84:87], v[164:167]
    ds_read_b128 a[84:87], v33 offset:4096
    v_add_f32 v9, v9, v92
    v_mfma_f32_16x16x32_bf16 v[176:179], a[152:155], v[64:67], v[176:179]
    v_exp_f32 v107, v107
    v_mfma_f32_16x16x32_bf16 v[176:179], a[156:159], v[80:83], v[176:179]
    ds_read_b128 a[88:91], v34 offset:4096
    v_cvt_pk_bf16_f32 v99, v106, v107
    v_mfma_f32_16x16x32_bf16 v[180:183], a[152:155], v[68:71], v[180:183]
    s_waitcnt lgkmcnt(7)
    v_exp_f32 v108, v108
    v_mfma_f32_16x16x32_bf16 v[180:183], a[156:159], v[84:87], v[180:183]
    ds_read_b128 a[92:95], v35 offset:4096
    v_add_f32 v9, v9, v93
    v_mfma_f32_16x16x32_bf16 v[192:195], a[160:163], v[64:67], v[192:195]
    v_exp_f32 v109, v109
    v_mfma_f32_16x16x32_bf16 v[192:195], a[164:167], v[80:83], v[192:195]
    ds_read_b128 a[96:99], v32 offset:8192
    v_cvt_pk_bf16_f32 v102, v108, v109
    v_mfma_f32_16x16x32_bf16 v[196:199], a[160:163], v[68:71], v[196:199]
    v_exp_f32 v110, v110
    v_mfma_f32_16x16x32_bf16 v[196:199], a[164:167], v[84:87], v[196:199]
    ds_read_b128 a[100:103], v33 offset:8192
    v_add_f32 v9, v9, v94
    v_mfma_f32_16x16x32_bf16 v[208:211], a[168:171], v[64:67], v[208:211]
    v_exp_f32 v111, v111
    v_mfma_f32_16x16x32_bf16 v[208:211], a[172:175], v[80:83], v[208:211]
    ds_read_b128 a[104:107], v34 offset:8192
    v_cvt_pk_bf16_f32 v103, v110, v111
    v_mfma_f32_16x16x32_bf16 v[212:215], a[168:171], v[68:71], v[212:215]
    v_exp_f32 v112, v112
    v_mfma_f32_16x16x32_bf16 v[212:215], a[172:175], v[84:87], v[212:215]
    ds_read_b128 a[108:111], v35 offset:8192
    v_add_f32 v9, v9, v95
    v_mfma_f32_16x16x32_bf16 v[224:227], a[176:179], v[64:67], v[224:227]
    v_exp_f32 v113, v113
    v_mfma_f32_16x16x32_bf16 v[224:227], a[180:183], v[80:83], v[224:227]
    ds_read_b128 a[112:115], v32 offset:12288
    v_cvt_pk_bf16_f32 v112, v112, v113
    v_mfma_f32_16x16x32_bf16 v[228:231], a[176:179], v[68:71], v[228:231]
    s_cmp_eq_u32 s41, 1
    v_exp_f32 v114, v114
    v_mfma_f32_16x16x32_bf16 v[228:231], a[180:183], v[84:87], v[228:231]
    ds_read_b128 a[116:119], v33 offset:12288
    v_mfma_f32_16x16x32_bf16 v[240:243], a[184:187], v[64:67], v[240:243]
    v_exp_f32 v115, v115
    v_mfma_f32_16x16x32_bf16 v[240:243], a[188:191], v[80:83], v[240:243]
    ds_read_b128 a[120:123], v34 offset:12288
    v_cvt_pk_bf16_f32 v113, v114, v115
    v_mfma_f32_16x16x32_bf16 v[244:247], a[184:187], v[68:71], v[244:247]
    s_waitcnt lgkmcnt(3)
    v_exp_f32 v116, v116
    v_mfma_f32_16x16x32_bf16 v[244:247], a[188:191], v[84:87], v[244:247]
    ds_read_b128 a[124:127], v35 offset:12288
    s_cbranch_scc1 L2_tail
    v_mfma_f32_16x16x32_bf16 v[64:67], a[64:67], a[0:3], v[48:51]
    s_add_u32 s40, s40, 16384
    v_exp_f32 v117, v117
    v_mfma_f32_16x16x32_bf16 v[64:67], a[68:71], a[4:7], v[64:67]
    v_cvt_pk_bf16_f32 v116, v116, v117
    v_mfma_f32_16x16x32_bf16 v[64:67], a[72:75], a[8:11], v[64:67]
    s_add_u32 m0, s37, 32768
    v_exp_f32 v118, v118
    v_mfma_f32_16x16x32_bf16 v[64:67], a[76:79], a[12:15], v[64:67]
    buffer_load_dwordx4 v44, s[12:15], s40 offen offset:0 sc1 lds
    v_mfma_f32_16x16x32_bf16 v[68:71], a[64:67], a[16:19], v[52:55]
    v_exp_f32 v119, v119
    v_mfma_f32_16x16x32_bf16 v[68:71], a[68:71], a[20:23], v[68:71]
    v_cvt_pk_bf16_f32 v117, v118, v119
    v_mfma_f32_16x16x32_bf16 v[68:71], a[72:75], a[24:27], v[68:71]
    v_exp_f32 v120, v120
    v_mfma_f32_16x16x32_bf16 v[68:71], a[76:79], a[28:31], v[68:71]
    buffer_load_dwordx4 v45, s[12:15], s40 offen offset:1024 sc1 lds
    v_mfma_f32_16x16x32_bf16 v[72:75], a[80:83], a[0:3], v[48:51]
    v_exp_f32 v121, v121
    v_mfma_f32_16x16x32_bf16 v[72:75], a[84:87], a[4:7], v[72:75]
    v_cvt_pk_bf16_f32 v114, v120, v121
    v_mfma_f32_16x16x32_bf16 v[72:75], a[88:91], a[8:11], v[72:75]
    v_exp_f32 v122, v122
    v_mfma_f32_16x16x32_bf16 v[72:75], a[92:95], a[12:15], v[72:75]
    buffer_load_dwordx4 v44, s[12:15], s40 offen offset:2048 sc1 lds
    v_mfma_f32_16x16x32_bf16 v[76:79], a[80:83], a[16:19], v[52:55]
    v_exp_f32 v123, v123
    v_mfma_f32_16x16x32_bf16 v[76:79], a[84:87], a[20:23], v[76:79]
    v_cvt_pk_bf16_f32 v115, v122, v123
    v_mfma_f32_16x16x32_bf16 v[76:79], a[88:91], a[24:27], v[76:79]
    v_exp_f32 v124, v124
    v_mfma_f32_16x16x32_bf16 v[76:79], a[92:95], a[28:31], v[76:79]
    buffer_load_dwordx4 v45, s[12:15], s40 offen offset:3072 sc1 lds
    v_mfma_f32_16x16x32_bf16 v[80:83], a[96:99], a[0:3], v[48:51]
    v_exp_f32 v125, v125
    v_mfma_f32_16x16x32_bf16 v[80:83], a[100:103], a[4:7], v[80:83]
    v_cvt_pk_bf16_f32 v118, v124, v125
    v_mfma_f32_16x16x32_bf16 v[80:83], a[104:107], a[8:11], v[80:83]
    s_add_u32 m0, s37, 98304
    v_exp_f32 v126, v126
    v_mfma_f32_16x16x32_bf16 v[80:83], a[108:111], a[12:15], v[80:83]
    buffer_load_dwordx4 v44, s[16:19], s40 offen offset:0 sc1 lds
    v_mfma_f32_16x16x32_bf16 v[84:87], a[96:99], a[16:19], v[52:55]
    v_exp_f32 v127, v127
    v_mfma_f32_16x16x32_bf16 v[84:87], a[100:103], a[20:23], v[84:87]
    buffer_load_dwordx4 v45, s[16:19], s40 offen offset:1024 sc1 lds
    v_cvt_pk_bf16_f32 v119, v126, v127
    v_mfma_f32_16x16x32_bf16 v[84:87], a[104:107], a[24:27], v[84:87]
    s_waitcnt lgkmcnt(0)
    v_exp_f32 v64, v64
    v_mfma_f32_16x16x32_bf16 v[84:87], a[108:111], a[28:31], v[84:87]
    v_add_f32 v8, v8, v64
    v_mfma_f32_16x16x32_bf16 v[88:91], a[112:115], a[0:3], v[48:51]
    v_exp_f32 v65, v65
    v_mfma_f32_16x16x32_bf16 v[88:91], a[116:119], a[4:7], v[88:91]
    buffer_load_dwordx4 v44, s[16:19], s40 offen offset:2048 sc1 lds
    v_cvt_pk_bf16_f32 v64, v64, v65
    v_mfma_f32_16x16x32_bf16 v[88:91], a[120:123], a[8:11], v[88:91]
    v_exp_f32 v66, v66
    v_mfma_f32_16x16x32_bf16 v[88:91], a[124:127], a[12:15], v[88:91]
    v_add_f32 v8, v8, v65
    v_add_f32 v8, v8, v66
    v_mfma_f32_16x16x32_bf16 v[92:95], a[112:115], a[16:19], v[52:55]
    v_exp_f32 v67, v67
    v_mfma_f32_16x16x32_bf16 v[92:95], a[116:119], a[20:23], v[92:95]
    buffer_load_dwordx4 v45, s[16:19], s40 offen offset:3072 sc1 lds
    v_cvt_pk_bf16_f32 v65, v66, v67
    v_mfma_f32_16x16x32_bf16 v[92:95], a[120:123], a[24:27], v[92:95]
    v_exp_f32 v68, v68
    v_mfma_f32_16x16x32_bf16 v[92:95], a[124:127], a[28:31], v[92:95]
    v_add_f32 v9, v9, v68
    v_add_f32 v8, v8, v67
    v_mfma_f32_16x16x32_bf16 v[136:139], a[128:131], v[96:99], v[136:139]
    v_exp_f32 v69, v69
    v_mfma_f32_16x16x32_bf16 v[136:139], a[132:135], v[112:115], v[136:139]
    v_cvt_pk_bf16_f32 v68, v68, v69
    v_mfma_f32_16x16x32_bf16 v[140:143], a[128:131], v[100:103], v[140:143]
    v_exp_f32 v70, v70
    v_mfma_f32_16x16x32_bf16 v[140:143], a[132:135], v[116:119], v[140:143]
    v_add_f32 v9, v9, v69
    v_add_f32 v9, v9, v70
    v_mfma_f32_16x16x32_bf16 v[152:155], a[136:139], v[96:99], v[152:155]
    v_exp_f32 v71, v71
    v_mfma_f32_16x16x32_bf16 v[152:155], a[140:143], v[112:115], v[152:155]
    ds_read_b64_tr_b16 a[128:129], v36 offset:0
    v_cvt_pk_bf16_f32 v69, v70, v71
    v_mfma_f32_16x16x32_bf16 v[156:159], a[136:139], v[100:103], v[156:159]
    v_exp_f32 v72, v72
    v_mfma_f32_16x16x32_bf16 v[156:159], a[140:143], v[116:119], v[156:159]
    ds_read_b64_tr_b16 a[130:131], v36 offset:4096
    v_add_f32 v9, v9, v71
    v_mfma_f32_16x16x32_bf16 v[168:171], a[144:147], v[96:99], v[168:171]
    v_exp_f32 v73, v73
    v_mfma_f32_16x16x32_bf16 v[168:171], a[148:151], v[112:115], v[168:171]
    ds_read_b64_tr_b16 a[132:133], v36 offset:8192
    v_cvt_pk_bf16_f32 v66, v72, v73
    v_mfma_f32_16x16x32_bf16 v[172:175], a[144:147], v[100:103], v[172:175]
    v_exp_f32 v74, v74
    v_mfma_f32_16x16x32_bf16 v[172:175], a[148:151], v[116:119], v[172:175]
    ds_read_b64_tr_b16 a[134:135], v36 offset:12288
    v_add_f32 v8, v8, v72
    v_mfma_f32_16x16x32_bf16 v[184:187], a[152:155], v[96:99], v[184:187]
    v_exp_f32 v75, v75
    v_mfma_f32_16x16x32_bf16 v[184:187], a[156:159], v[112:115], v[184:187]
    ds_read_b64_tr_b16 a[136:137], v37 offset:0
    v_cvt_pk_bf16_f32 v67, v74, v75
    v_mfma_f32_16x16x32_bf16 v[188:191], a[152:155], v[100:103], v[188:191]
    v_exp_f32 v76, v76
    v_mfma_f32_16x16x32_bf16 v[188:191], a[156:159], v[116:119], v[188:191]
    ds_read_b64_tr_b16 a[138:139], v37 offset:4096
    v_add_f32 v8, v8, v73
    v_mfma_f32_16x16x32_bf16 a[200:203], a[208:211], v[96:99], a[200:203]
    v_exp_f32 v77, v77
    v_mfma_f32_16x16x32_bf16 a[200:203], a[208:211], v[112:115], a[200:203]
    ds_read_b64_tr_b16 a[140:141], v37 offset:8192
    v_cvt_pk_bf16_f32 v70, v76, v77
    v_mfma_f32_16x16x32_bf16 v[200:203], a[160:163], v[96:99], v[200:203]
    v_exp_f32 v78, v78
    v_mfma_f32_16x16x32_bf16 v[200:203], a[164:167], v[112:115], v[200:203]
    ds_read_b64_tr_b16 a[142:143], v37 offset:12288
    v_add_f32 v8, v8, v74
    v_mfma_f32_16x16x32_bf16 v[204:207], a[160:163], v[100:103], v[204:207]
    v_exp_f32 v79, v79
    v_mfma_f32_16x16x32_bf16 v[204:207], a[164:167], v[116:119], v[204:207]
    ds_read_b64_tr_b16 a[144:145], v38 offset:0
    v_cvt_pk_bf16_f32 v71, v78, v79
    v_mfma_f32_16x16x32_bf16 v[216:219], a[168:171], v[96:99], v[216:219]
    v_exp_f32 v80, v80
    v_mfma_f32_16x16x32_bf16 v[216:219], a[172:175], v[112:115], v[216:219]
    ds_read_b64_tr_b16 a[146:147], v38 offset:4096
    v_add_f32 v8, v8, v80
    v_mfma_f32_16x16x32_bf16 v[220:223], a[168:171], v[100:103], v[220:223]
    v_exp_f32 v81, v81
    v_mfma_f32_16x16x32_bf16 v[220:223], a[172:175], v[116:119], v[220:223]
    ds_read_b64_tr_b16 a[148:149], v38 offset:8192
    v_cvt_pk_bf16_f32 v80, v80, v81
    v_mfma_f32_16x16x32_bf16 v[232:235], a[176:179], v[96:99], v[232:235]
    v_exp_f32 v82, v82
    v_mfma_f32_16x16x32_bf16 v[232:235], a[180:183], v[112:115], v[232:235]
    ds_read_b64_tr_b16 a[150:151], v38 offset:12288
    v_add_f32 v8, v8, v81
    v_mfma_f32_16x16x32_bf16 v[236:239], a[176:179], v[100:103], v[236:239]
    s_sub_u32 s41, s41, 1
    v_exp_f32 v83, v83
    v_mfma_f32_16x16x32_bf16 v[236:239], a[180:183], v[116:119], v[236:239]
    ds_read_b64_tr_b16 a[152:153], v39 offset:0
    v_cvt_pk_bf16_f32 v81, v82, v83
    v_mfma_f32_16x16x32_bf16 v[248:251], a[184:187], v[96:99], v[248:251]
    v_exp_f32 v84, v84
    v_mfma_f32_16x16x32_bf16 v[248:251], a[188:191], v[112:115], v[248:251]
    ds_read_b64_tr_b16 a[154:155], v39 offset:4096
    v_add_f32 v9, v9, v84
    v_mfma_f32_16x16x32_bf16 v[252:255], a[184:187], v[100:103], v[252:255]
    v_mfma_f32_16x16x32_bf16 v[252:255], a[188:191], v[116:119], v[252:255]
    ds_read_b64_tr_b16 a[156:157], v39 offset:8192
    v_add_f32 v8, v8, v82
    v_add_f32 v8, v8, v83
    v_add_f32 v8, v8, v75
    v_mfma_f32_16x16x32_bf16 a[204:207], a[208:211], v[100:103], a[204:207]
    s_waitcnt vmcnt(8)
    s_barrier
    v_mfma_f32_16x16x32_bf16 a[204:207], a[208:211], v[116:119], a[204:207]
    ds_read_b64_tr_b16 a[158:159], v39 offset:12288
    v_add_f32 v9, v9, v76
    s_branch L2_loop
L2_tail:
    s_barrier
    s_add_u32 s40, s40, 16384
    s_add_u32 m0, s37, 32768
    s_lshl_b32 s42, s39, 21
    s_lshl_b32 s43, s36, 19
    s_add_u32 s42, s42, s43
    s_lshl_b32 s43, s38, 12
    s_add_u32 s42, s42, s43
    s_add_u32 s42, s42, 8388608
    s_add_u32 s28, s10, s42
    s_addc_u32 s29, s11, 0
    s_mov_b32 s30, 397312
    s_mov_b32 s31, 0x20000
    v_exp_f32 v120, v120
    buffer_load_dwordx4 v44, s[12:15], s40 offen offset:0 sc1 lds
    v_exp_f32 v121, v121
    buffer_load_dwordx4 v45, s[12:15], s40 offen offset:1024 sc1 lds
    v_exp_f32 v122, v122
    v_cvt_pk_bf16_f32 v114, v120, v121
    buffer_load_dwordx4 v44, s[12:15], s40 offen offset:2048 sc1 lds
    v_exp_f32 v123, v123
    buffer_load_dwordx4 v45, s[12:15], s40 offen offset:3072 sc1 lds
    v_exp_f32 v117, v117
    v_cvt_pk_bf16_f32 v115, v122, v123
    s_add_u32 m0, s37, 98304
    v_mfma_f32_16x16x32_bf16 a[200:203], a[208:211], v[96:99], a[200:203]
    buffer_load_dwordx4 v44, s[16:19], s40 offen offset:0 sc1 lds
    v_exp_f32 v118, v118
    v_mfma_f32_16x16x32_bf16 a[200:203], a[208:211], v[112:115], a[200:203]
    v_cvt_pk_bf16_f32 v116, v116, v117
    buffer_load_dwordx4 v45, s[16:19], s40 offen offset:1024 sc1 lds
    v_exp_f32 v119, v119
    v_mfma_f32_16x16x32_bf16 v[136:139], a[128:131], v[96:99], v[136:139]
    v_exp_f32 v124, v124
    v_cvt_pk_bf16_f32 v117, v118, v119
    v_mfma_f32_16x16x32_bf16 v[136:139], a[132:135], v[112:115], v[136:139]
    buffer_load_dwordx4 v44, s[16:19], s40 offen offset:2048 sc1 lds
    v_exp_f32 v125, v125
    v_mfma_f32_16x16x32_bf16 v[152:155], a[136:139], v[96:99], v[152:155]
    v_exp_f32 v126, v126
    v_cvt_pk_bf16_f32 v118, v124, v125
    v_mfma_f32_16x16x32_bf16 v[152:155], a[140:143], v[112:115], v[152:155]
    buffer_load_dwordx4 v45, s[16:19], s40 offen offset:3072 sc1 lds
    v_exp_f32 v127, v127
    v_mfma_f32_16x16x32_bf16 v[168:171], a[144:147], v[96:99], v[168:171]
    v_mov_b32 v16, v8
    v_mov_b32 v17, v9
    v_mov_b32 v18, v16
    v_mfma_f32_16x16x32_bf16 v[168:171], a[148:151], v[112:115], v[168:171]
    v_mov_b32 v19, v17
    v_permlane16_swap_b32 v18, v16
    s_nop 0
    v_permlane16_swap_b32 v19, v17
    v_mfma_f32_16x16x32_bf16 v[184:187], a[152:155], v[96:99], v[184:187]
    v_add_f32 v16, v16, v18
    v_add_f32 v17, v17, v19
    v_cvt_pk_bf16_f32 v119, v126, v127
    v_mfma_f32_16x16x32_bf16 v[184:187], a[156:159], v[112:115], v[184:187]
    v_mov_b32 v18, v16
    v_mov_b32 v19, v17
    s_nop 0
    v_permlane32_swap_b32 v18, v16
    v_mfma_f32_16x16x32_bf16 v[200:203], a[160:163], v[96:99], v[200:203]
    v_permlane32_swap_b32 v19, v17
    v_add_f32 v16, v16, v18
    v_add_f32 v17, v17, v19
    v_mfma_f32_16x16x32_bf16 v[200:203], a[164:167], v[112:115], v[200:203]
    v_maximum3_f32 v22, v16, v17, v17
    v_rcp_f32 v16, v16
    v_mfma_f32_16x16x32_bf16 v[216:219], a[168:171], v[96:99], v[216:219]
    v_rcp_f32 v17, v17
    v_mov_b32 v20, 0
    v_mfma_f32_16x16x32_bf16 v[216:219], a[172:175], v[112:115], v[216:219]
    v_mov_b32 v21, 0
    s_mov_b32 s43, 0
    v_mul_f32 v128, v128, v16
    v_mfma_f32_16x16x32_bf16 v[232:235], a[176:179], v[96:99], v[232:235]
    v_mul_f32 v129, v129, v16
    v_mul_f32 v130, v130, v16
    v_mul_f32 v131, v131, v16
    v_mfma_f32_16x16x32_bf16 v[232:235], a[180:183], v[112:115], v[232:235]
    v_mul_f32 v144, v144, v16
    v_mul_f32 v145, v145, v16
    v_mul_f32 v146, v146, v16
    v_mfma_f32_16x16x32_bf16 v[248:251], a[184:187], v[96:99], v[248:251]
    v_mul_f32 v147, v147, v16
    v_cvt_pk_bf16_f32 v64, v128, v129
    v_cvt_pk_bf16_f32 v65, v130, v131
    v_mfma_f32_16x16x32_bf16 v[248:251], a[188:191], v[112:115], v[248:251]
    v_cvt_pk_bf16_f32 v66, v144, v145
    v_cvt_pk_bf16_f32 v67, v146, v147
    buffer_store_dwordx4 v[64:67], v47, s[28:31], s43 offen offset:0 sc1
    v_mfma_f32_16x16x32_bf16 a[204:207], a[208:211], v[100:103], a[204:207]
    v_maximum3_f32 v20, v20, abs(v128), abs(v129)
    v_maximum3_f32 v21, v21, abs(v130), abs(v131)
    v_maximum3_f32 v20, v20, abs(v144), abs(v145)
    v_mfma_f32_16x16x32_bf16 a[204:207], a[208:211], v[116:119], a[204:207]
    v_maximum3_f32 v21, v21, abs(v146), abs(v147)
    v_mul_f32 v160, v160, v16
    v_mul_f32 v161, v161, v16
    v_mfma_f32_16x16x32_bf16 v[140:143], a[128:131], v[100:103], v[140:143]
    v_mul_f32 v162, v162, v16
    v_mul_f32 v163, v163, v16
    v_mul_f32 v176, v176, v16
    v_mfma_f32_16x16x32_bf16 v[140:143], a[132:135], v[116:119], v[140:143]
    v_mul_f32 v177, v177, v16
    v_mul_f32 v178, v178, v16
    v_mul_f32 v179, v179, v16
    v_mfma_f32_16x16x32_bf16 v[156:159], a[136:139], v[100:103], v[156:159]
    v_cvt_pk_bf16_f32 v68, v160, v161
    v_cvt_pk_bf16_f32 v69, v162, v163
    v_cvt_pk_bf16_f32 v70, v176, v177
    v_mfma_f32_16x16x32_bf16 v[156:159], a[140:143], v[116:119], v[156:159]
    v_cvt_pk_bf16_f32 v71, v178, v179
    buffer_store_dwordx4 v[68:71], v47, s[28:31], s43 offen offset:1024 sc1
    v_maximum3_f32 v20, v20, abs(v160), abs(v161)
    v_mfma_f32_16x16x32_bf16 v[172:175], a[144:147], v[100:103], v[172:175]
    v_maximum3_f32 v21, v21, abs(v162), abs(v163)
    v_maximum3_f32 v20, v20, abs(v176), abs(v177)
    v_maximum3_f32 v21, v21, abs(v178), abs(v179)
    v_mfma_f32_16x16x32_bf16 v[172:175], a[148:151], v[116:119], v[172:175]
    v_mul_f32 v192, v192, v16
    v_mul_f32 v193, v193, v16
    v_mul_f32 v194, v194, v16
    v_mfma_f32_16x16x32_bf16 v[188:191], a[152:155], v[100:103], v[188:191]
    v_mul_f32 v195, v195, v16
    v_mul_f32 v208, v208, v16
    v_mul_f32 v209, v209, v16
    v_mfma_f32_16x16x32_bf16 v[188:191], a[156:159], v[116:119], v[188:191]
    v_mul_f32 v210, v210, v16
    v_mul_f32 v211, v211, v16
    v_cvt_pk_bf16_f32 v72, v192, v193
    v_mfma_f32_16x16x32_bf16 v[204:207], a[160:163], v[100:103], v[204:207]
    v_cvt_pk_bf16_f32 v73, v194, v195
    v_cvt_pk_bf16_f32 v74, v208, v209
    v_cvt_pk_bf16_f32 v75, v210, v211
    v_mfma_f32_16x16x32_bf16 v[204:207], a[164:167], v[116:119], v[204:207]
    buffer_store_dwordx4 v[72:75], v47, s[28:31], s43 offen offset:2048 sc1
    v_maximum3_f32 v20, v20, abs(v192), abs(v193)
    v_maximum3_f32 v21, v21, abs(v194), abs(v195)
    v_mfma_f32_16x16x32_bf16 v[220:223], a[168:171], v[100:103], v[220:223]
    v_maximum3_f32 v20, v20, abs(v208), abs(v209)
    v_maximum3_f32 v21, v21, abs(v210), abs(v211)
    v_mul_f32 v224, v224, v16
    v_mfma_f32_16x16x32_bf16 v[220:223], a[172:175], v[116:119], v[220:223]
    v_mul_f32 v225, v225, v16
    v_mul_f32 v226, v226, v16
    v_mul_f32 v227, v227, v16
    v_mfma_f32_16x16x32_bf16 v[236:239], a[176:179], v[100:103], v[236:239]
    v_mul_f32 v240, v240, v16
    v_mul_f32 v241, v241, v16
    v_mul_f32 v242, v242, v16
    v_mfma_f32_16x16x32_bf16 v[236:239], a[180:183], v[116:119], v[236:239]
    v_mul_f32 v243, v243, v16
    v_cvt_pk_bf16_f32 v76, v224, v225
    v_cvt_pk_bf16_f32 v77, v226, v227
    v_mfma_f32_16x16x32_bf16 v[252:255], a[184:187], v[100:103], v[252:255]
    v_cvt_pk_bf16_f32 v78, v240, v241
    v_cvt_pk_bf16_f32 v79, v242, v243
    buffer_store_dwordx4 v[76:79], v47, s[28:31], s43 offen offset:3072 sc1
    v_mfma_f32_16x16x32_bf16 v[252:255], a[188:191], v[116:119], v[252:255]
    v_maximum3_f32 v20, v20, abs(v224), abs(v225)
    v_maximum3_f32 v21, v21, abs(v226), abs(v227)
    v_maximum3_f32 v20, v20, abs(v240), abs(v241)
    v_maximum3_f32 v21, v21, abs(v242), abs(v243)
    s_mov_b32 s43, 131072
    v_mul_f32 v132, v132, v17
    v_mul_f32 v133, v133, v17
    v_mul_f32 v134, v134, v17
    v_mul_f32 v135, v135, v17
    v_mul_f32 v148, v148, v17
    v_mul_f32 v149, v149, v17
    v_mul_f32 v150, v150, v17
    v_mul_f32 v151, v151, v17
    v_cvt_pk_bf16_f32 v80, v132, v133
    v_cvt_pk_bf16_f32 v81, v134, v135
    v_cvt_pk_bf16_f32 v82, v148, v149
    v_cvt_pk_bf16_f32 v83, v150, v151
    buffer_store_dwordx4 v[80:83], v47, s[28:31], s43 offen offset:0 sc1
    v_maximum3_f32 v20, v20, abs(v132), abs(v133)
    v_maximum3_f32 v21, v21, abs(v134), abs(v135)
    v_maximum3_f32 v20, v20, abs(v148), abs(v149)
    v_maximum3_f32 v21, v21, abs(v150), abs(v151)
    v_mul_f32 v164, v164, v17
    v_mul_f32 v165, v165, v17
    v_mul_f32 v166, v166, v17
    v_mul_f32 v167, v167, v17
    v_mul_f32 v180, v180, v17
    v_mul_f32 v181, v181, v17
    v_mul_f32 v182, v182, v17
    v_mul_f32 v183, v183, v17
    v_cvt_pk_bf16_f32 v84, v164, v165
    v_cvt_pk_bf16_f32 v85, v166, v167
    v_cvt_pk_bf16_f32 v86, v180, v181
    v_cvt_pk_bf16_f32 v87, v182, v183
    buffer_store_dwordx4 v[84:87], v47, s[28:31], s43 offen offset:1024 sc1
    v_maximum3_f32 v20, v20, abs(v164), abs(v165)
    v_maximum3_f32 v21, v21, abs(v166), abs(v167)
    v_maximum3_f32 v20, v20, abs(v180), abs(v181)
    v_maximum3_f32 v21, v21, abs(v182), abs(v183)
    v_mul_f32 v196, v196, v17
    v_mul_f32 v197, v197, v17
    v_mul_f32 v198, v198, v17
    v_mul_f32 v199, v199, v17
    v_mul_f32 v212, v212, v17
    v_mul_f32 v213, v213, v17
    v_mul_f32 v214, v214, v17
    v_mul_f32 v215, v215, v17
    v_cvt_pk_bf16_f32 v88, v196, v197
    v_cvt_pk_bf16_f32 v89, v198, v199
    v_cvt_pk_bf16_f32 v90, v212, v213
    v_cvt_pk_bf16_f32 v91, v214, v215
    buffer_store_dwordx4 v[88:91], v47, s[28:31], s43 offen offset:2048 sc1
    v_maximum3_f32 v20, v20, abs(v196), abs(v197)
    v_maximum3_f32 v21, v21, abs(v198), abs(v199)
    v_maximum3_f32 v20, v20, abs(v212), abs(v213)
    v_maximum3_f32 v21, v21, abs(v214), abs(v215)
    v_mul_f32 v228, v228, v17
    v_mul_f32 v229, v229, v17
    v_mul_f32 v230, v230, v17
    v_mul_f32 v231, v231, v17
    v_mul_f32 v244, v244, v17
    v_mul_f32 v245, v245, v17
    v_mul_f32 v246, v246, v17
    v_mul_f32 v247, v247, v17
    v_cvt_pk_bf16_f32 v92, v228, v229
    v_cvt_pk_bf16_f32 v93, v230, v231
    v_cvt_pk_bf16_f32 v94, v244, v245
    v_cvt_pk_bf16_f32 v95, v246, v247
    buffer_store_dwordx4 v[92:95], v47, s[28:31], s43 offen offset:3072 sc1
    v_maximum3_f32 v20, v20, abs(v228), abs(v229)
    v_maximum3_f32 v21, v21, abs(v230), abs(v231)
    v_maximum3_f32 v20, v20, abs(v244), abs(v245)
    v_maximum3_f32 v21, v21, abs(v246), abs(v247)
    v_accvgpr_read_b32 v18, a200
    v_maximum3_f32 v22, v22, v18, v18
    v_rcp_f32 v18, v18
    s_mov_b32 s43, 262144
    v_mul_f32 v136, v136, v18
    v_mul_f32 v137, v137, v18
    v_mul_f32 v138, v138, v18
    v_mul_f32 v139, v139, v18
    v_mul_f32 v152, v152, v18
    v_mul_f32 v153, v153, v18
    v_mul_f32 v154, v154, v18
    v_mul_f32 v155, v155, v18
    v_cvt_pk_bf16_f32 v64, v136, v137
    v_cvt_pk_bf16_f32 v65, v138, v139
    v_cvt_pk_bf16_f32 v66, v152, v153
    v_cvt_pk_bf16_f32 v67, v154, v155
    buffer_store_dwordx4 v[64:67], v47, s[28:31], s43 offen offset:0 sc1
    v_maximum3_f32 v20, v20, abs(v136), abs(v137)
    v_maximum3_f32 v21, v21, abs(v138), abs(v139)
    v_maximum3_f32 v20, v20, abs(v152), abs(v153)
    v_maximum3_f32 v21, v21, abs(v154), abs(v155)
    v_mul_f32 v168, v168, v18
    v_mul_f32 v169, v169, v18
    v_mul_f32 v170, v170, v18
    v_mul_f32 v171, v171, v18
    v_mul_f32 v184, v184, v18
    v_mul_f32 v185, v185, v18
    v_mul_f32 v186, v186, v18
    v_mul_f32 v187, v187, v18
    v_cvt_pk_bf16_f32 v68, v168, v169
    v_cvt_pk_bf16_f32 v69, v170, v171
    v_cvt_pk_bf16_f32 v70, v184, v185
    v_cvt_pk_bf16_f32 v71, v186, v187
    buffer_store_dwordx4 v[68:71], v47, s[28:31], s43 offen offset:1024 sc1
    v_maximum3_f32 v20, v20, abs(v168), abs(v169)
    v_maximum3_f32 v21, v21, abs(v170), abs(v171)
    v_maximum3_f32 v20, v20, abs(v184), abs(v185)
    v_maximum3_f32 v21, v21, abs(v186), abs(v187)
    v_mul_f32 v200, v200, v18
    v_mul_f32 v201, v201, v18
    v_mul_f32 v202, v202, v18
    v_mul_f32 v203, v203, v18
    v_mul_f32 v216, v216, v18
    v_mul_f32 v217, v217, v18
    v_mul_f32 v218, v218, v18
    v_mul_f32 v219, v219, v18
    v_cvt_pk_bf16_f32 v72, v200, v201
    v_cvt_pk_bf16_f32 v73, v202, v203
    v_cvt_pk_bf16_f32 v74, v216, v217
    v_cvt_pk_bf16_f32 v75, v218, v219
    buffer_store_dwordx4 v[72:75], v47, s[28:31], s43 offen offset:2048 sc1
    v_maximum3_f32 v20, v20, abs(v200), abs(v201)
    v_maximum3_f32 v21, v21, abs(v202), abs(v203)
    v_maximum3_f32 v20, v20, abs(v216), abs(v217)
    v_maximum3_f32 v21, v21, abs(v218), abs(v219)
    v_mul_f32 v232, v232, v18
    v_mul_f32 v233, v233, v18
    v_mul_f32 v234, v234, v18
    v_mul_f32 v235, v235, v18
    v_mul_f32 v248, v248, v18
    v_mul_f32 v249, v249, v18
    v_mul_f32 v250, v250, v18
    v_mul_f32 v251, v251, v18
    v_cvt_pk_bf16_f32 v76, v232, v233
    v_cvt_pk_bf16_f32 v77, v234, v235
    v_cvt_pk_bf16_f32 v78, v248, v249
    v_cvt_pk_bf16_f32 v79, v250, v251
    buffer_store_dwordx4 v[76:79], v47, s[28:31], s43 offen offset:3072 sc1
    v_maximum3_f32 v20, v20, abs(v232), abs(v233)
    v_maximum3_f32 v21, v21, abs(v234), abs(v235)
    v_maximum3_f32 v20, v20, abs(v248), abs(v249)
    v_maximum3_f32 v21, v21, abs(v250), abs(v251)
    v_accvgpr_read_b32 v19, a204
    v_maximum3_f32 v22, v22, v19, v19
    v_rcp_f32 v19, v19
    s_mov_b32 s43, 393216
    v_mul_f32 v140, v140, v19
    v_mul_f32 v141, v141, v19
    v_mul_f32 v142, v142, v19
    v_mul_f32 v143, v143, v19
    v_mul_f32 v156, v156, v19
    v_mul_f32 v157, v157, v19
    v_mul_f32 v158, v158, v19
    v_mul_f32 v159, v159, v19
    v_cvt_pk_bf16_f32 v80, v140, v141
    v_cvt_pk_bf16_f32 v81, v142, v143
    v_cvt_pk_bf16_f32 v82, v156, v157
    v_cvt_pk_bf16_f32 v83, v158, v159
    buffer_store_dwordx4 v[80:83], v47, s[28:31], s43 offen offset:0 sc1
    v_maximum3_f32 v20, v20, abs(v140), abs(v141)
    v_maximum3_f32 v21, v21, abs(v142), abs(v143)
    v_maximum3_f32 v20, v20, abs(v156), abs(v157)
    v_maximum3_f32 v21, v21, abs(v158), abs(v159)
    v_mul_f32 v172, v172, v19
    v_mul_f32 v173, v173, v19
    v_mul_f32 v174, v174, v19
    v_mul_f32 v175, v175, v19
    v_mul_f32 v188, v188, v19
    v_mul_f32 v189, v189, v19
    v_mul_f32 v190, v190, v19
    v_mul_f32 v191, v191, v19
    v_cvt_pk_bf16_f32 v84, v172, v173
    v_cvt_pk_bf16_f32 v85, v174, v175
    v_cvt_pk_bf16_f32 v86, v188, v189
    v_cvt_pk_bf16_f32 v87, v190, v191
    buffer_store_dwordx4 v[84:87], v47, s[28:31], s43 offen offset:1024 sc1
    v_maximum3_f32 v20, v20, abs(v172), abs(v173)
    v_maximum3_f32 v21, v21, abs(v174), abs(v175)
    v_maximum3_f32 v20, v20, abs(v188), abs(v189)
    v_maximum3_f32 v21, v21, abs(v190), abs(v191)
    v_mul_f32 v204, v204, v19
    v_mul_f32 v205, v205, v19
    v_mul_f32 v206, v206, v19
    v_mul_f32 v207, v207, v19
    v_mul_f32 v220, v220, v19
    v_mul_f32 v221, v221, v19
    v_mul_f32 v222, v222, v19
    v_mul_f32 v223, v223, v19
    v_cvt_pk_bf16_f32 v88, v204, v205
    v_cvt_pk_bf16_f32 v89, v206, v207
    v_cvt_pk_bf16_f32 v90, v220, v221
    v_cvt_pk_bf16_f32 v91, v222, v223
    buffer_store_dwordx4 v[88:91], v47, s[28:31], s43 offen offset:2048 sc1
    v_maximum3_f32 v20, v20, abs(v204), abs(v205)
    v_maximum3_f32 v21, v21, abs(v206), abs(v207)
    v_maximum3_f32 v20, v20, abs(v220), abs(v221)
    v_maximum3_f32 v21, v21, abs(v222), abs(v223)
    v_mul_f32 v236, v236, v19
    v_mul_f32 v237, v237, v19
    v_mul_f32 v238, v238, v19
    v_mul_f32 v239, v239, v19
    v_mul_f32 v252, v252, v19
    v_mul_f32 v253, v253, v19
    v_mul_f32 v254, v254, v19
    v_mul_f32 v255, v255, v19
    v_cvt_pk_bf16_f32 v92, v236, v237
    v_cvt_pk_bf16_f32 v93, v238, v239
    v_cvt_pk_bf16_f32 v94, v252, v253
    v_cvt_pk_bf16_f32 v95, v254, v255
    buffer_store_dwordx4 v[92:95], v47, s[28:31], s43 offen offset:3072 sc1
    v_maximum3_f32 v20, v20, abs(v236), abs(v237)
    v_maximum3_f32 v21, v21, abs(v238), abs(v239)
    v_maximum3_f32 v20, v20, abs(v252), abs(v253)
    v_maximum3_f32 v21, v21, abs(v254), abs(v255)
    s_mov_b32 s43, 0x5d800000
    s_mov_b32 s44, 0x7e800000
    v_maximum3_f32 v20, v20, v21, v21
    v_cmp_nlt_f32 vcc, v22, s43
    v_cmp_nlt_f32 s[46:47], v20, s44
    s_or_b64 vcc, vcc, s[46:47]
    s_cbranch_vccnz L2_slow
L2_done:
    s_and_b32 s40, s2, 7
    s_lshl_b32 s38, s40, 2
    s_lshr_b32 s41, s2, 6
    s_add_u32 s38, s38, s41
    s_bfe_u32 s41, s2, 0x30003
    s_mul_i32 s42, s36, 147456
    s_mul_i32 s43, s41, 589824
    s_add_u32 s42, s42, s43
    s_add_u32 s42, s42, 25165824
    s_add_u32 s12, s10, s42
    s_addc_u32 s13, s11, 0
    s_mov_b32 s14, 147456
    s_mov_b32 s15, 0x20000
    s_lshr_b32 s55, s2, 6
    s_lshl_b32 s55, s55, 1
    s_add_u32 s55, s55, s41
    s_and_b32 s55, s55, 0
    s_lshl_b32 s55, s55, 10
    s_add_u32 m0, s37, 49152
    s_add_u32 s45, s55, 0
    s_and_b32 s45, s45, 0x1fff
    s_add_u32 s45, s45, 0
    s_lshl_b32 s45, s45, 2
    buffer_load_dwordx4 v44, s[12:15], s45 offen offset:0 sc1 lds
    buffer_load_dwordx4 v45, s[12:15], s45 offen offset:1024 sc1 lds
    buffer_load_dwordx4 v44, s[12:15], s45 offen offset:2048 sc1 lds
    buffer_load_dwordx4 v45, s[12:15], s45 offen offset:3072 sc1 lds
    s_add_u32 m0, s37, 114688
    s_add_u32 s45, s55, 1024
    s_and_b32 s45, s45, 0x1fff
    s_add_u32 s45, s45, 0
    s_lshl_b32 s45, s45, 2
    buffer_load_dwordx4 v44, s[12:15], s45 offen offset:0 sc1 lds
    buffer_load_dwordx4 v45, s[12:15], s45 offen offset:1024 sc1 lds
    buffer_load_dwordx4 v44, s[12:15], s45 offen offset:2048 sc1 lds
    buffer_load_dwordx4 v45, s[12:15], s45 offen offset:3072 sc1 lds
    v_lshrrev_b32 v1, 3, v0
    v_bfe_u32 v2, v0, 2, 1
    v_bfe_u32 v3, v0, 1, 1
    v_lshl_add_u32 v2, v2, 3, v3
    v_lshlrev_b32 v3, 1, v1
    v_xor_b32 v2, v2, v3
    v_and_b32 v3, 1, v0
    v_lshlrev_b32 v3, 3, v3
    v_lshl_add_u32 v1, v1, 8, v3
    v_add_u32 v1, s37, v1
    v_xor_b32 v3, 0, v2
    s_waitcnt vmcnt(32)
    v_lshl_add_u32 v4, v3, 4, v1
    v_add_u32 v12, 0x10000, v4
    v_xor_b32 v3, 2, v2
    v_lshl_add_u32 v5, v3, 4, v1
    v_add_u32 v13, 0x10000, v5
    v_xor_b32 v3, 4, v2
    v_lshl_add_u32 v6, v3, 4, v1
    v_add_u32 v14, 0x10000, v6
    v_xor_b32 v3, 6, v2
    v_lshl_add_u32 v7, v3, 4, v1
    v_add_u32 v15, 0x10000, v7
    v_add_u32 v8, 0, v47
    v_add_u32 v9, 131072, v47
    v_add_u32 v10, 262144, v47
    v_add_u32 v11, 393216, v47
    s_lshl_b32 s42, s38, 19
    s_lshl_b32 s43, s36, 15
    s_add_u32 s42, s42, s43
    s_add_u32 s42, s42, 8388608
    s_add_u32 s16, s10, s42
    s_addc_u32 s17, s11, 0
    s_mov_b32 s18, 425984
    s_mov_b32 s19, 0x20000
    v_mov_b32 v40, 0
    v_mov_b32 v41, 0
    v_mov_b32 v42, 0
    v_mov_b32 v43, 0
    v_mov_b32 v33, 1
    s_waitcnt vmcnt(24)
    ds_read_b64_tr_b16 a[0:1], v4 offset:0
    ds_read_b64_tr_b16 a[2:3], v4 offset:2048
    ds_read_b64_tr_b16 a[4:5], v5 offset:0
    ds_read_b64_tr_b16 a[6:7], v5 offset:2048
    ds_read_b64_tr_b16 a[8:9], v6 offset:0
    ds_read_b64_tr_b16 a[10:11], v6 offset:2048
    ds_read_b64_tr_b16 a[12:13], v7 offset:0
    ds_read_b64_tr_b16 a[14:15], v7 offset:2048
    ds_read_b64_tr_b16 a[16:17], v4 offset:16384
    ds_read_b64_tr_b16 a[18:19], v4 offset:18432
    ds_read_b64_tr_b16 a[20:21], v5 offset:16384
    ds_read_b64_tr_b16 a[22:23], v5 offset:18432
    ds_read_b64_tr_b16 a[24:25], v6 offset:16384
    ds_read_b64_tr_b16 a[26:27], v6 offset:18432
    ds_read_b64_tr_b16 a[28:29], v7 offset:16384
    ds_read_b64_tr_b16 a[30:31], v7 offset:18432
    s_waitcnt lgkmcnt(8)
    s_add_u32 m0, s37, 0
    s_add_u32 s45, s55, 2048
    s_and_b32 s45, s45, 0x1fff
    s_add_u32 s45, s45, 0
    s_lshl_b32 s45, s45, 2
    buffer_load_dwordx4 v44, s[12:15], s45 offen offset:0 sc1 lds
    buffer_load_dwordx4 v45, s[12:15], s45 offen offset:1024 sc1 lds
    buffer_load_dwordx4 v44, s[12:15], s45 offen offset:2048 sc1 lds
    buffer_load_dwordx4 v45, s[12:15], s45 offen offset:3072 sc1 lds
    ds_read_b64_tr_b16 a[32:33], v4 offset:32768
    ds_read_b64_tr_b16 a[34:35], v4 offset:34816
    ds_read_b64_tr_b16 a[36:37], v5 offset:32768
    ds_read_b64_tr_b16 a[38:39], v5 offset:34816
    ds_read_b64_tr_b16 a[40:41], v6 offset:32768
    ds_read_b64_tr_b16 a[42:43], v6 offset:34816
    ds_read_b64_tr_b16 a[44:45], v7 offset:32768
    ds_read_b64_tr_b16 a[46:47], v7 offset:34816
    s_waitcnt lgkmcnt(8)
    s_add_u32 m0, s37, 16384
    s_add_u32 s45, s55, 3072
    s_and_b32 s45, s45, 0x1fff
    s_add_u32 s45, s45, 0
    s_lshl_b32 s45, s45, 2
    buffer_load_dwordx4 v44, s[12:15], s45 offen offset:0 sc1 lds
    buffer_load_dwordx4 v45, s[12:15], s45 offen offset:1024 sc1 lds
    buffer_load_dwordx4 v44, s[12:15], s45 offen offset:2048 sc1 lds
    buffer_load_dwordx4 v45, s[12:15], s45 offen offset:3072 sc1 lds
    ds_read_b64_tr_b16 a[48:49], v12 offset:0
    ds_read_b64_tr_b16 a[50:51], v12 offset:2048
    ds_read_b64_tr_b16 a[52:53], v13 offset:0
    ds_read_b64_tr_b16 a[54:55], v13 offset:2048
    ds_read_b64_tr_b16 a[56:57], v14 offset:0
    ds_read_b64_tr_b16 a[58:59], v14 offset:2048
    ds_read_b64_tr_b16 a[60:61], v15 offset:0
    ds_read_b64_tr_b16 a[62:63], v15 offset:2048
    s_waitcnt lgkmcnt(8)
    s_add_u32 m0, s37, 32768
    s_add_u32 s45, s55, 4096
    s_and_b32 s45, s45, 0x1fff
    s_add_u32 s45, s45, 0
    s_lshl_b32 s45, s45, 2
    buffer_load_dwordx4 v44, s[12:15], s45 offen offset:0 sc1 lds
    buffer_load_dwordx4 v45, s[12:15], s45 offen offset:1024 sc1 lds
    buffer_load_dwordx4 v44, s[12:15], s45 offen offset:2048 sc1 lds
    buffer_load_dwordx4 v45, s[12:15], s45 offen offset:3072 sc1 lds
    ds_read_b64_tr_b16 a[64:65], v12 offset:16384
    ds_read_b64_tr_b16 a[66:67], v12 offset:18432
    ds_read_b64_tr_b16 a[68:69], v13 offset:16384
    ds_read_b64_tr_b16 a[70:71], v13 offset:18432
    ds_read_b64_tr_b16 a[72:73], v14 offset:16384
    ds_read_b64_tr_b16 a[74:75], v14 offset:18432
    ds_read_b64_tr_b16 a[76:77], v15 offset:16384
    ds_read_b64_tr_b16 a[78:79], v15 offset:18432
    s_waitcnt lgkmcnt(8)
    s_add_u32 m0, s37, 65536
    s_add_u32 s45, s55, 5120
    s_and_b32 s45, s45, 0x1fff
    s_add_u32 s45, s45, 0
    s_lshl_b32 s45, s45, 2
    buffer_load_dwordx4 v44, s[12:15], s45 offen offset:0 sc1 lds
    buffer_load_dwordx4 v45, s[12:15], s45 offen offset:1024 sc1 lds
    buffer_load_dwordx4 v44, s[12:15], s45 offen offset:2048 sc1 lds
    buffer_load_dwordx4 v45, s[12:15], s45 offen offset:3072 sc1 lds
    ds_read_b64_tr_b16 a[80:81], v12 offset:32768
    ds_read_b64_tr_b16 a[82:83], v12 offset:34816
    ds_read_b64_tr_b16 a[84:85], v13 offset:32768
    ds_read_b64_tr_b16 a[86:87], v13 offset:34816
    ds_read_b64_tr_b16 a[88:89], v14 offset:32768
    ds_read_b64_tr_b16 a[90:91], v14 offset:34816
    ds_read_b64_tr_b16 a[92:93], v15 offset:32768
    ds_read_b64_tr_b16 a[94:95], v15 offset:34816
    s_waitcnt lgkmcnt(8)
    s_add_u32 m0, s37, 81920
    s_add_u32 s45, s55, 6144
    s_and_b32 s45, s45, 0x1fff
    s_add_u32 s45, s45, 0
    s_lshl_b32 s45, s45, 2
    buffer_load_dwordx4 v44, s[12:15], s45 offen offset:0 sc1 lds
    buffer_load_dwordx4 v45, s[12:15], s45 offen offset:1024 sc1 lds
    buffer_load_dwordx4 v44, s[12:15], s45 offen offset:2048 sc1 lds
    buffer_load_dwordx4 v45, s[12:15], s45 offen offset:3072 sc1 lds
    s_waitcnt vmcnt(28)
    s_barrier
    s_lshl_b32 s42, s39, 7
    s_add_u32 s42, s42, 40960
    s_cmp_lg_u32 s36, 0
    s_cbranch_scc1 L3_ns
    s_mov_b64 exec, 1
    buffer_atomic_add v33, v40, s[32:35], s42 offen
    s_mov_b64 exec, -1
L3_ns:
    v_mfma_f32_32x32x16_bf16 v[64:79], v[40:43], v[40:43], 0
    v_mfma_f32_32x32x16_bf16 v[80:95], v[40:43], v[40:43], 0
    v_mfma_f32_32x32x16_bf16 v[96:111], v[40:43], v[40:43], 0
    v_mfma_f32_32x32x16_bf16 v[112:127], v[40:43], v[40:43], 0
    s_waitcnt vmcnt(24)
    ds_read_b64_tr_b16 a[96:97], v4 offset:49152
    ds_read_b64_tr_b16 a[98:99], v4 offset:51200
    ds_read_b64_tr_b16 a[100:101], v5 offset:49152
    ds_read_b64_tr_b16 a[102:103], v5 offset:51200
    ds_read_b64_tr_b16 a[104:105], v6 offset:49152
    ds_read_b64_tr_b16 a[106:107], v6 offset:51200
    ds_read_b64_tr_b16 a[108:109], v7 offset:49152
    ds_read_b64_tr_b16 a[110:111], v7 offset:51200
    s_waitcnt lgkmcnt(8)
    s_add_u32 m0, s37, 98304
    s_add_u32 s45, s55, 7168
    s_and_b32 s45, s45, 0x1fff
    s_add_u32 s45, s45, 0
    s_lshl_b32 s45, s45, 2
    buffer_load_dwordx4 v44, s[12:15], s45 offen offset:0 sc1 lds
    buffer_load_dwordx4 v45, s[12:15], s45 offen offset:1024 sc1 lds
    buffer_load_dwordx4 v44, s[12:15], s45 offen offset:2048 sc1 lds
    buffer_load_dwordx4 v45, s[12:15], s45 offen offset:3072 sc1 lds
    s_waitcnt vmcnt(24)
    ds_read_b64_tr_b16 a[112:113], v12 offset:49152
    ds_read_b64_tr_b16 a[114:115], v12 offset:51200
    ds_read_b64_tr_b16 a[116:117], v13 offset:49152
    ds_read_b64_tr_b16 a[118:119], v13 offset:51200
    ds_read_b64_tr_b16 a[120:121], v14 offset:49152
    ds_read_b64_tr_b16 a[122:123], v14 offset:51200
    ds_read_b64_tr_b16 a[124:125], v15 offset:49152
    ds_read_b64_tr_b16 a[126:127], v15 offset:51200
    s_waitcnt lgkmcnt(8)
    s_add_u32 m0, s37, 49152
    s_add_u32 s45, s55, 0
    s_and_b32 s45, s45, 0x1fff
    s_add_u32 s45, s45, 8192
    s_lshl_b32 s45, s45, 2
    buffer_load_dwordx4 v44, s[12:15], s45 offen offset:0 sc1 lds
    buffer_load_dwordx4 v45, s[12:15], s45 offen offset:1024 sc1 lds
    buffer_load_dwordx4 v44, s[12:15], s45 offen offset:2048 sc1 lds
    buffer_load_dwordx4 v45, s[12:15], s45 offen offset:3072 sc1 lds
    s_waitcnt vmcnt(24)
    ds_read_b64_tr_b16 a[128:129], v4 offset:0
    ds_read_b64_tr_b16 a[130:131], v4 offset:2048
    ds_read_b64_tr_b16 a[132:133], v5 offset:0
    ds_read_b64_tr_b16 a[134:135], v5 offset:2048
    ds_read_b64_tr_b16 a[136:137], v6 offset:0
    ds_read_b64_tr_b16 a[138:139], v6 offset:2048
    ds_read_b64_tr_b16 a[140:141], v7 offset:0
    ds_read_b64_tr_b16 a[142:143], v7 offset:2048
    s_waitcnt lgkmcnt(8)
    s_add_u32 m0, s37, 114688
    s_add_u32 s45, s55, 1024
    s_and_b32 s45, s45, 0x1fff
    s_add_u32 s45, s45, 8192
    s_lshl_b32 s45, s45, 2
    buffer_load_dwordx4 v44, s[12:15], s45 offen offset:0 sc1 lds
    buffer_load_dwordx4 v45, s[12:15], s45 offen offset:1024 sc1 lds
    buffer_load_dwordx4 v44, s[12:15], s45 offen offset:2048 sc1 lds
    buffer_load_dwordx4 v45, s[12:15], s45 offen offset:3072 sc1 lds
    s_waitcnt vmcnt(24)
    ds_read_b64_tr_b16 a[144:145], v4 offset:16384
    ds_read_b64_tr_b16 a[146:147], v4 offset:18432
    ds_read_b64_tr_b16 a[148:149], v5 offset:16384
    ds_read_b64_tr_b16 a[150:151], v5 offset:18432
    ds_read_b64_tr_b16 a[152:153], v6 offset:16384
    ds_read_b64_tr_b16 a[154:155], v6 offset:18432
    ds_read_b64_tr_b16 a[156:157], v7 offset:16384
    ds_read_b64_tr_b16 a[158:159], v7 offset:18432
    s_waitcnt lgkmcnt(8)
    s_add_u32 m0, s37, 0
    s_add_u32 s45, s55, 2048
    s_and_b32 s45, s45, 0x1fff
    s_add_u32 s45, s45, 8192
    s_lshl_b32 s45, s45, 2
    buffer_load_dwordx4 v44, s[12:15], s45 offen offset:0 sc1 lds
    buffer_load_dwordx4 v45, s[12:15], s45 offen offset:1024 sc1 lds
    buffer_load_dwordx4 v44, s[12:15], s45 offen offset:2048 sc1 lds
    buffer_load_dwordx4 v45, s[12:15], s45 offen offset:3072 sc1 lds
    s_waitcnt vmcnt(24)
    ds_read_b64_tr_b16 a[160:161], v4 offset:32768
    ds_read_b64_tr_b16 a[162:163], v4 offset:34816
    ds_read_b64_tr_b16 a[164:165], v5 offset:32768
    ds_read_b64_tr_b16 a[166:167], v5 offset:34816
    ds_read_b64_tr_b16 a[168:169], v6 offset:32768
    ds_read_b64_tr_b16 a[170:171], v6 offset:34816
    ds_read_b64_tr_b16 a[172:173], v7 offset:32768
    ds_read_b64_tr_b16 a[174:175], v7 offset:34816
    s_waitcnt lgkmcnt(8)
    s_add_u32 m0, s37, 16384
    s_add_u32 s45, s55, 3072
    s_and_b32 s45, s45, 0x1fff
    s_add_u32 s45, s45, 8192
    s_lshl_b32 s45, s45, 2
    buffer_load_dwordx4 v44, s[12:15], s45 offen offset:0 sc1 lds
    buffer_load_dwordx4 v45, s[12:15], s45 offen offset:1024 sc1 lds
    buffer_load_dwordx4 v44, s[12:15], s45 offen offset:2048 sc1 lds
    buffer_load_dwordx4 v45, s[12:15], s45 offen offset:3072 sc1 lds
    s_waitcnt vmcnt(24)
    ds_read_b64_tr_b16 a[176:177], v12 offset:0
    ds_read_b64_tr_b16 a[178:179], v12 offset:2048
    ds_read_b64_tr_b16 a[180:181], v13 offset:0
    ds_read_b64_tr_b16 a[182:183], v13 offset:2048
    ds_read_b64_tr_b16 a[184:185], v14 offset:0
    ds_read_b64_tr_b16 a[186:187], v14 offset:2048
    ds_read_b64_tr_b16 a[188:189], v15 offset:0
    ds_read_b64_tr_b16 a[190:191], v15 offset:2048
    s_waitcnt lgkmcnt(8)
    s_add_u32 m0, s37, 32768
    s_add_u32 s45, s55, 4096
    s_and_b32 s45, s45, 0x1fff
    s_add_u32 s45, s45, 8192
    s_lshl_b32 s45, s45, 2
    buffer_load_dwordx4 v44, s[12:15], s45 offen offset:0 sc1 lds
    buffer_load_dwordx4 v45, s[12:15], s45 offen offset:1024 sc1 lds
    buffer_load_dwordx4 v44, s[12:15], s45 offen offset:2048 sc1 lds
    buffer_load_dwordx4 v45, s[12:15], s45 offen offset:3072 sc1 lds
    s_waitcnt vmcnt(24)
    ds_read_b64_tr_b16 a[192:193], v12 offset:16384
    ds_read_b64_tr_b16 a[194:195], v12 offset:18432
    ds_read_b64_tr_b16 a[196:197], v13 offset:16384
    ds_read_b64_tr_b16 a[198:199], v13 offset:18432
    ds_read_b64_tr_b16 a[200:201], v14 offset:16384
    ds_read_b64_tr_b16 a[202:203], v14 offset:18432
    ds_read_b64_tr_b16 a[204:205], v15 offset:16384
    ds_read_b64_tr_b16 a[206:207], v15 offset:18432
    s_waitcnt lgkmcnt(8)
    s_add_u32 m0, s37, 65536
    s_add_u32 s45, s55, 5120
    s_and_b32 s45, s45, 0x1fff
    s_add_u32 s45, s45, 8192
    s_lshl_b32 s45, s45, 2
    buffer_load_dwordx4 v44, s[12:15], s45 offen offset:0 sc1 lds
    buffer_load_dwordx4 v45, s[12:15], s45 offen offset:1024 sc1 lds
    buffer_load_dwordx4 v44, s[12:15], s45 offen offset:2048 sc1 lds
    buffer_load_dwordx4 v45, s[12:15], s45 offen offset:3072 sc1 lds
    s_waitcnt vmcnt(24)
    ds_read_b64_tr_b16 a[208:209], v12 offset:32768
    ds_read_b64_tr_b16 a[210:211], v12 offset:34816
    ds_read_b64_tr_b16 a[212:213], v13 offset:32768
    ds_read_b64_tr_b16 a[214:215], v13 offset:34816
    ds_read_b64_tr_b16 a[216:217], v14 offset:32768
    ds_read_b64_tr_b16 a[218:219], v14 offset:34816
    ds_read_b64_tr_b16 a[220:221], v15 offset:32768
    ds_read_b64_tr_b16 a[222:223], v15 offset:34816
    s_waitcnt lgkmcnt(8)
    s_add_u32 m0, s37, 81920
    s_add_u32 s45, s55, 6144
    s_and_b32 s45, s45, 0x1fff
    s_add_u32 s45, s45, 8192
    s_lshl_b32 s45, s45, 2
    buffer_load_dwordx4 v44, s[12:15], s45 offen offset:0 sc1 lds
    buffer_load_dwordx4 v45, s[12:15], s45 offen offset:1024 sc1 lds
    buffer_load_dwordx4 v44, s[12:15], s45 offen offset:2048 sc1 lds
    buffer_load_dwordx4 v45, s[12:15], s45 offen offset:3072 sc1 lds
    s_waitcnt vmcnt(24)
    ds_read_b64_tr_b16 a[224:225], v4 offset:49152
    ds_read_b64_tr_b16 a[226:227], v4 offset:51200
    ds_read_b64_tr_b16 a[228:229], v5 offset:49152
    ds_read_b64_tr_b16 a[230:231], v5 offset:51200
    ds_read_b64_tr_b16 a[232:233], v6 offset:49152
    ds_read_b64_tr_b16 a[234:235], v6 offset:51200
    ds_read_b64_tr_b16 a[236:237], v7 offset:49152
    ds_read_b64_tr_b16 a[238:239], v7 offset:51200
    s_waitcnt lgkmcnt(8)
    s_add_u32 m0, s37, 98304
    s_add_u32 s45, s55, 7168
    s_and_b32 s45, s45, 0x1fff
    s_add_u32 s45, s45, 8192
    s_lshl_b32 s45, s45, 2
    buffer_load_dwordx4 v44, s[12:15], s45 offen offset:0 sc1 lds
    buffer_load_dwordx4 v45, s[12:15], s45 offen offset:1024 sc1 lds
    buffer_load_dwordx4 v44, s[12:15], s45 offen offset:2048 sc1 lds
    buffer_load_dwordx4 v45, s[12:15], s45 offen offset:3072 sc1 lds
    s_waitcnt vmcnt(24)
    ds_read_b64_tr_b16 a[240:241], v12 offset:49152
    ds_read_b64_tr_b16 a[242:243], v12 offset:51200
    ds_read_b64_tr_b16 a[244:245], v13 offset:49152
    ds_read_b64_tr_b16 a[246:247], v13 offset:51200
    ds_read_b64_tr_b16 a[248:249], v14 offset:49152
    ds_read_b64_tr_b16 a[250:251], v14 offset:51200
    ds_read_b64_tr_b16 a[252:253], v15 offset:49152
    ds_read_b64_tr_b16 a[254:255], v15 offset:51200
    s_waitcnt lgkmcnt(8)
    s_add_u32 m0, s37, 49152
    s_add_u32 s45, s55, 0
    s_and_b32 s45, s45, 0x1fff
    s_add_u32 s45, s45, 16384
    s_lshl_b32 s45, s45, 2
    buffer_load_dwordx4 v44, s[12:15], s45 offen offset:0 sc1 lds
    buffer_load_dwordx4 v45, s[12:15], s45 offen offset:1024 sc1 lds
    buffer_load_dwordx4 v44, s[12:15], s45 offen offset:2048 sc1 lds
    buffer_load_dwordx4 v45, s[12:15], s45 offen offset:3072 sc1 lds
    s_waitcnt lgkmcnt(0)
    s_add_u32 m0, s37, 114688
    s_add_u32 s45, s55, 1024
    s_and_b32 s45, s45, 0x1fff
    s_add_u32 s45, s45, 16384
    s_lshl_b32 s45, s45, 2
    buffer_load_dwordx4 v44, s[12:15], s45 offen offset:0 sc1 lds
    buffer_load_dwordx4 v45, s[12:15], s45 offen offset:1024 sc1 lds
    buffer_load_dwordx4 v44, s[12:15], s45 offen offset:2048 sc1 lds
    buffer_load_dwordx4 v45, s[12:15], s45 offen offset:3072 sc1 lds
    s_lshl_b32 s42, s40, 7
    s_add_u32 s42, s42, 40960
    s_cmp_lg_u32 s36, 0
    s_cbranch_scc1 L3_poll_j
    s_mov_b32 s70, 0
    s_mov_b64 exec, 0x1
L3_poll:
    buffer_load_dword v3, v40, s[32:35], s42 offen sc1
    s_waitcnt vmcnt(0)
    v_cmp_ne_u32 vcc, 32, v3
    s_add_u32 s70, s70, 1
    s_cmp_gt_u32 s70, 0x8000
    s_cbranch_scc1 L3_poll_x
    s_cbranch_vccz L3_poll_x
    s_sleep 1
    s_branch L3_poll
L3_poll_x:
    s_mov_b64 exec, -1
L3_poll_j:
    s_barrier
    s_mov_b32 s44, 26624
    buffer_load_dwordx4 v[128:131], v8, s[16:19], s44 offen sc1
    buffer_load_dwordx4 v[132:135], v9, s[16:19], s44 offen sc1
    buffer_load_dwordx4 v[136:139], v10, s[16:19], s44 offen sc1
    buffer_load_dwordx4 v[140:143], v11, s[16:19], s44 offen sc1
    s_mov_b32 s44, 27648
    buffer_load_dwordx4 v[144:147], v8, s[16:19], s44 offen sc1
    buffer_load_dwordx4 v[148:151], v9, s[16:19], s44 offen sc1
    buffer_load_dwordx4 v[152:155], v10, s[16:19], s44 offen sc1
    buffer_load_dwordx4 v[156:159], v11, s[16:19], s44 offen sc1
    s_mov_b32 s44, 28672
    buffer_load_dwordx4 v[160:163], v8, s[16:19], s44 offen sc1
    buffer_load_dwordx4 v[164:167], v9, s[16:19], s44 offen sc1
    buffer_load_dwordx4 v[168:171], v10, s[16:19], s44 offen sc1
    buffer_load_dwordx4 v[172:175], v11, s[16:19], s44 offen sc1
    s_mov_b32 s44, 29696
    buffer_load_dwordx4 v[176:179], v8, s[16:19], s44 offen sc1
    buffer_load_dwordx4 v[180:183], v9, s[16:19], s44 offen sc1
    buffer_load_dwordx4 v[184:187], v10, s[16:19], s44 offen sc1
    buffer_load_dwordx4 v[188:191], v11, s[16:19], s44 offen sc1
    s_mov_b32 s44, 30720
    buffer_load_dwordx4 v[192:195], v8, s[16:19], s44 offen sc1
    buffer_load_dwordx4 v[196:199], v9, s[16:19], s44 offen sc1
    buffer_load_dwordx4 v[200:203], v10, s[16:19], s44 offen sc1
    buffer_load_dwordx4 v[204:207], v11, s[16:19], s44 offen sc1
    s_mov_b32 s44, 31744
    buffer_load_dwordx4 v[208:211], v8, s[16:19], s44 offen sc1
    buffer_load_dwordx4 v[212:215], v9, s[16:19], s44 offen sc1
    buffer_load_dwordx4 v[216:219], v10, s[16:19], s44 offen sc1
    buffer_load_dwordx4 v[220:223], v11, s[16:19], s44 offen sc1
    s_add_u32 s44, s55, 0
    s_and_b32 s44, s44, 0x1fff
    s_add_u32 s44, s44, 0
    buffer_load_dwordx4 v[224:227], v8, s[16:19], s44 offen sc1
    buffer_load_dwordx4 v[228:231], v9, s[16:19], s44 offen sc1
    buffer_load_dwordx4 v[232:235], v10, s[16:19], s44 offen sc1
    buffer_load_dwordx4 v[236:239], v11, s[16:19], s44 offen sc1
    s_lshl_b32 s42, s36, 6
    v_add_u32 v34, s42, v0
    v_lshrrev_b32 v46, 2, v34
    v_and_b32 v48, 3, v0
    v_lshlrev_b32 v49, 10, v46
    v_lshl_add_u32 v49, v48, 4, v49
    s_lshl_b32 s46, s38, 16
    s_lshl_b32 s47, s41, 7
    s_add_u32 s46, s46, s47
    s_lshl_b32 s48, s41, 8
    s_add_u32 s48, s48, 139264
    s_add_u32 s47, s47, 156672
    v_lshlrev_b32 v50, 5, v48
    v_add_u32 v50, s48, v50
    v_lshlrev_b32 v51, 4, v48
    v_lshl_add_u32 v32, v46, 7, v51
    v_add_u32 v32, 131072, v32
    v_add_u32 v51, s47, v51
    v_lshlrev_b32 v2, 3, v34
    v_add_u32 v2, 139264, v2
    v_and_b32 v3, 31, v0
    v_lshlrev_b32 v3, 2, v3
    v_add_u32 v3, 155648, v3
    s_add_u32 s24, s10, 3145728
    s_addc_u32 s25, s11, 0
    s_mov_b32 s26, 2097152
    s_mov_b32 s27, 0x20000
    s_add_u32 s44, s55, 1024
    s_and_b32 s44, s44, 0x1fff
    s_add_u32 s44, s44, 0
    s_waitcnt vmcnt(27)
    v_mfma_f32_16x16x32_bf16 v[64:67], a[0:3], v[128:131], v[64:67]
    buffer_load_dwordx4 v[240:243], v8, s[16:19], s44 offen sc1
    s_waitcnt vmcnt(27)
    v_mfma_f32_16x16x32_bf16 v[68:71], a[0:3], v[132:135], v[68:71]
    s_waitcnt vmcnt(26)
    v_mfma_f32_16x16x32_bf16 v[72:75], a[0:3], v[136:139], v[72:75]
    s_waitcnt vmcnt(25)
    v_mfma_f32_16x16x32_bf16 v[76:79], a[0:3], v[140:143], v[76:79]
    ds_read_b64_tr_b16 a[0:1], v4 offset:0
    ds_read_b64_tr_b16 a[2:3], v4 offset:2048
    v_mfma_f32_16x16x32_bf16 v[80:83], a[4:7], v[128:131], v[80:83]
    buffer_load_dwordx4 v[244:247], v9, s[16:19], s44 offen sc1
    v_mfma_f32_16x16x32_bf16 v[84:87], a[4:7], v[132:135], v[84:87]
    v_mfma_f32_16x16x32_bf16 v[88:91], a[4:7], v[136:139], v[88:91]
    v_mfma_f32_16x16x32_bf16 v[92:95], a[4:7], v[140:143], v[92:95]
    ds_read_b64_tr_b16 a[4:5], v5 offset:0
    ds_read_b64_tr_b16 a[6:7], v5 offset:2048
    v_mfma_f32_16x16x32_bf16 v[96:99], a[8:11], v[128:131], v[96:99]
    buffer_load_dwordx4 v[248:251], v10, s[16:19], s44 offen sc1
    v_mfma_f32_16x16x32_bf16 v[100:103], a[8:11], v[132:135], v[100:103]
    v_mfma_f32_16x16x32_bf16 v[104:107], a[8:11], v[136:139], v[104:107]
    v_mfma_f32_16x16x32_bf16 v[108:111], a[8:11], v[140:143], v[108:111]
    ds_read_b64_tr_b16 a[8:9], v6 offset:0
    ds_read_b64_tr_b16 a[10:11], v6 offset:2048
    v_mfma_f32_16x16x32_bf16 v[112:115], a[12:15], v[128:131], v[112:115]
    buffer_load_dwordx4 v[252:255], v11, s[16:19], s44 offen sc1
    v_mfma_f32_16x16x32_bf16 v[116:119], a[12:15], v[132:135], v[116:119]
    v_mfma_f32_16x16x32_bf16 v[120:123], a[12:15], v[136:139], v[120:123]
    v_mfma_f32_16x16x32_bf16 v[124:127], a[12:15], v[140:143], v[124:127]
    ds_read_b64_tr_b16 a[12:13], v7 offset:0
    ds_read_b64_tr_b16 a[14:15], v7 offset:2048
    s_add_u32 s44, s55, 2048
    s_and_b32 s44, s44, 0x1fff
    s_add_u32 s44, s44, 0
    s_waitcnt lgkmcnt(0)
    s_add_u32 m0, s37, 0
    s_add_u32 s45, s55, 2048
    s_and_b32 s45, s45, 0x1fff
    s_add_u32 s45, s45, 16384
    s_lshl_b32 s45, s45, 2
    buffer_load_dwordx4 v44, s[12:15], s45 offen offset:0 sc1 lds
    buffer_load_dwordx4 v45, s[12:15], s45 offen offset:1024 sc1 lds
    buffer_load_dwordx4 v44, s[12:15], s45 offen offset:2048 sc1 lds
    buffer_load_dwordx4 v45, s[12:15], s45 offen offset:3072 sc1 lds
    s_waitcnt vmcnt(31)
    v_mfma_f32_16x16x32_bf16 v[64:67], a[16:19], v[144:147], v[64:67]
    buffer_load_dwordx4 v[128:131], v8, s[16:19], s44 offen sc1
    s_waitcnt vmcnt(31)
    v_mfma_f32_16x16x32_bf16 v[68:71], a[16:19], v[148:151], v[68:71]
    s_waitcnt vmcnt(30)
    v_mfma_f32_16x16x32_bf16 v[72:75], a[16:19], v[152:155], v[72:75]
    s_waitcnt vmcnt(29)
    v_mfma_f32_16x16x32_bf16 v[76:79], a[16:19], v[156:159], v[76:79]
    ds_read_b64_tr_b16 a[16:17], v4 offset:16384
    ds_read_b64_tr_b16 a[18:19], v4 offset:18432
    v_mfma_f32_16x16x32_bf16 v[80:83], a[20:23], v[144:147], v[80:83]
    buffer_load_dwordx4 v[132:135], v9, s[16:19], s44 offen sc1
    v_mfma_f32_16x16x32_bf16 v[84:87], a[20:23], v[148:151], v[84:87]
    v_mfma_f32_16x16x32_bf16 v[88:91], a[20:23], v[152:155], v[88:91]
    v_mfma_f32_16x16x32_bf16 v[92:95], a[20:23], v[156:159], v[92:95]
    ds_read_b64_tr_b16 a[20:21], v5 offset:16384
    ds_read_b64_tr_b16 a[22:23], v5 offset:18432
    v_mfma_f32_16x16x32_bf16 v[96:99], a[24:27], v[144:147], v[96:99]
    buffer_load_dwordx4 v[136:139], v10, s[16:19], s44 offen sc1
    v_mfma_f32_16x16x32_bf16 v[100:103], a[24:27], v[148:151], v[100:103]
    v_mfma_f32_16x16x32_bf16 v[104:107], a[24:27], v[152:155], v[104:107]
    v_mfma_f32_16x16x32_bf16 v[108:111], a[24:27], v[156:159], v[108:111]
    ds_read_b64_tr_b16 a[24:25], v6 offset:16384
    ds_read_b64_tr_b16 a[26:27], v6 offset:18432
    v_mfma_f32_16x16x32_bf16 v[112:115], a[28:31], v[144:147], v[112:115]
    buffer_load_dwordx4 v[140:143], v11, s[16:19], s44 offen sc1
    v_mfma_f32_16x16x32_bf16 v[116:119], a[28:31], v[148:151], v[116:119]
    v_mfma_f32_16x16x32_bf16 v[120:123], a[28:31], v[152:155], v[120:123]
    v_mfma_f32_16x16x32_bf16 v[124:127], a[28:31], v[156:159], v[124:127]
    ds_read_b64_tr_b16 a[28:29], v7 offset:16384
    ds_read_b64_tr_b16 a[30:31], v7 offset:18432
    s_add_u32 s44, s55, 3072
    s_and_b32 s44, s44, 0x1fff
    s_add_u32 s44, s44, 0
    s_waitcnt lgkmcnt(0)
    s_add_u32 m0, s37, 16384
    s_add_u32 s45, s55, 3072
    s_and_b32 s45, s45, 0x1fff
    s_add_u32 s45, s45, 16384
    s_lshl_b32 s45, s45, 2
    buffer_load_dwordx4 v44, s[12:15], s45 offen offset:0 sc1 lds
    buffer_load_dwordx4 v45, s[12:15], s45 offen offset:1024 sc1 lds
    buffer_load_dwordx4 v44, s[12:15], s45 offen offset:2048 sc1 lds
    buffer_load_dwordx4 v45, s[12:15], s45 offen offset:3072 sc1 lds
    s_waitcnt vmcnt(35)
    v_mfma_f32_16x16x32_bf16 v[64:67], a[32:35], v[160:163], v[64:67]
    buffer_load_dwordx4 v[144:147], v8, s[16:19], s44 offen sc1
    s_waitcnt vmcnt(35)
    v_mfma_f32_16x16x32_bf16 v[68:71], a[32:35], v[164:167], v[68:71]
    s_waitcnt vmcnt(34)
    v_mfma_f32_16x16x32_bf16 v[72:75], a[32:35], v[168:171], v[72:75]
    s_waitcnt vmcnt(33)
    v_mfma_f32_16x16x32_bf16 v[76:79], a[32:35], v[172:175], v[76:79]
    ds_read_b64_tr_b16 a[32:33], v4 offset:32768
    ds_read_b64_tr_b16 a[34:35], v4 offset:34816
    v_mfma_f32_16x16x32_bf16 v[80:83], a[36:39], v[160:163], v[80:83]
    buffer_load_dwordx4 v[148:151], v9, s[16:19], s44 offen sc1
    v_mfma_f32_16x16x32_bf16 v[84:87], a[36:39], v[164:167], v[84:87]
    v_mfma_f32_16x16x32_bf16 v[88:91], a[36:39], v[168:171], v[88:91]
    v_mfma_f32_16x16x32_bf16 v[92:95], a[36:39], v[172:175], v[92:95]
    ds_read_b64_tr_b16 a[36:37], v5 offset:32768
    ds_read_b64_tr_b16 a[38:39], v5 offset:34816
    v_mfma_f32_16x16x32_bf16 v[96:99], a[40:43], v[160:163], v[96:99]
    buffer_load_dwordx4 v[152:155], v10, s[16:19], s44 offen sc1
    v_mfma_f32_16x16x32_bf16 v[100:103], a[40:43], v[164:167], v[100:103]
    v_mfma_f32_16x16x32_bf16 v[104:107], a[40:43], v[168:171], v[104:107]
    v_mfma_f32_16x16x32_bf16 v[108:111], a[40:43], v[172:175], v[108:111]
    ds_read_b64_tr_b16 a[40:41], v6 offset:32768
    ds_read_b64_tr_b16 a[42:43], v6 offset:34816
    v_mfma_f32_16x16x32_bf16 v[112:115], a[44:47], v[160:163], v[112:115]
    buffer_load_dwordx4 v[156:159], v11, s[16:19], s44 offen sc1
    v_mfma_f32_16x16x32_bf16 v[116:119], a[44:47], v[164:167], v[116:119]
    v_mfma_f32_16x16x32_bf16 v[120:123], a[44:47], v[168:171], v[120:123]
    v_mfma_f32_16x16x32_bf16 v[124:127], a[44:47], v[172:175], v[124:127]
    ds_read_b64_tr_b16 a[44:45], v7 offset:32768
    ds_read_b64_tr_b16 a[46:47], v7 offset:34816
    s_add_u32 s44, s55, 4096
    s_and_b32 s44, s44, 0x1fff
    s_add_u32 s44, s44, 0
    s_waitcnt lgkmcnt(0)
    s_add_u32 m0, s37, 32768
    s_add_u32 s45, s55, 4096
    s_and_b32 s45, s45, 0x1fff
    s_add_u32 s45, s45, 16384
    s_lshl_b32 s45, s45, 2
    buffer_load_dwordx4 v44, s[12:15], s45 offen offset:0 sc1 lds
    buffer_load_dwordx4 v45, s[12:15], s45 offen offset:1024 sc1 lds
    buffer_load_dwordx4 v44, s[12:15], s45 offen offset:2048 sc1 lds
    buffer_load_dwordx4 v45, s[12:15], s45 offen offset:3072 sc1 lds
    s_waitcnt vmcnt(39)
    v_mfma_f32_16x16x32_bf16 v[64:67], a[48:51], v[176:179], v[64:67]
    buffer_load_dwordx4 v[160:163], v8, s[16:19], s44 offen sc1
    s_waitcnt vmcnt(39)
    v_mfma_f32_16x16x32_bf16 v[68:71], a[48:51], v[180:183], v[68:71]
    s_waitcnt vmcnt(38)
    v_mfma_f32_16x16x32_bf16 v[72:75], a[48:51], v[184:187], v[72:75]
    s_waitcnt vmcnt(37)
    v_mfma_f32_16x16x32_bf16 v[76:79], a[48:51], v[188:191], v[76:79]
    ds_read_b64_tr_b16 a[48:49], v12 offset:0
    ds_read_b64_tr_b16 a[50:51], v12 offset:2048
    v_mfma_f32_16x16x32_bf16 v[80:83], a[52:55], v[176:179], v[80:83]
    buffer_load_dwordx4 v[164:167], v9, s[16:19], s44 offen sc1
    v_mfma_f32_16x16x32_bf16 v[84:87], a[52:55], v[180:183], v[84:87]
    v_mfma_f32_16x16x32_bf16 v[88:91], a[52:55], v[184:187], v[88:91]
    v_mfma_f32_16x16x32_bf16 v[92:95], a[52:55], v[188:191], v[92:95]
    ds_read_b64_tr_b16 a[52:53], v13 offset:0
    ds_read_b64_tr_b16 a[54:55], v13 offset:2048
    v_mfma_f32_16x16x32_bf16 v[96:99], a[56:59], v[176:179], v[96:99]
    buffer_load_dwordx4 v[168:171], v10, s[16:19], s44 offen sc1
    v_mfma_f32_16x16x32_bf16 v[100:103], a[56:59], v[180:183], v[100:103]
    v_mfma_f32_16x16x32_bf16 v[104:107], a[56:59], v[184:187], v[104:107]
    v_mfma_f32_16x16x32_bf16 v[108:111], a[56:59], v[188:191], v[108:111]
    ds_read_b64_tr_b16 a[56:57], v14 offset:0
    ds_read_b64_tr_b16 a[58:59], v14 offset:2048
    v_mfma_f32_16x16x32_bf16 v[112:115], a[60:63], v[176:179], v[112:115]
    buffer_load_dwordx4 v[172:175], v11, s[16:19], s44 offen sc1
    v_mfma_f32_16x16x32_bf16 v[116:119], a[60:63], v[180:183], v[116:119]
    v_mfma_f32_16x16x32_bf16 v[120:123], a[60:63], v[184:187], v[120:123]
    v_mfma_f32_16x16x32_bf16 v[124:127], a[60:63], v[188:191], v[124:127]
    ds_read_b64_tr_b16 a[60:61], v15 offset:0
    ds_read_b64_tr_b16 a[62:63], v15 offset:2048
    s_add_u32 s44, s55, 5120
    s_and_b32 s44, s44, 0x1fff
    s_add_u32 s44, s44, 0
    s_waitcnt lgkmcnt(0)
    s_add_u32 m0, s37, 65536
    s_add_u32 s45, s55, 5120
    s_and_b32 s45, s45, 0x1fff
    s_add_u32 s45, s45, 16384
    s_lshl_b32 s45, s45, 2
    buffer_load_dwordx4 v44, s[12:15], s45 offen offset:0 sc1 lds
    buffer_load_dwordx4 v45, s[12:15], s45 offen offset:1024 sc1 lds
    buffer_load_dwordx4 v44, s[12:15], s45 offen offset:2048 sc1 lds
    buffer_load_dwordx4 v45, s[12:15], s45 offen offset:3072 sc1 lds
    s_waitcnt vmcnt(43)
    v_mfma_f32_16x16x32_bf16 v[64:67], a[64:67], v[192:195], v[64:67]
    buffer_load_dwordx4 v[176:179], v8, s[16:19], s44 offen sc1
    s_waitcnt vmcnt(43)
    v_mfma_f32_16x16x32_bf16 v[68:71], a[64:67], v[196:199], v[68:71]
    s_waitcnt vmcnt(42)
    v_mfma_f32_16x16x32_bf16 v[72:75], a[64:67], v[200:203], v[72:75]
    s_waitcnt vmcnt(41)
    v_mfma_f32_16x16x32_bf16 v[76:79], a[64:67], v[204:207], v[76:79]
    ds_read_b64_tr_b16 a[64:65], v12 offset:16384
    ds_read_b64_tr_b16 a[66:67], v12 offset:18432
    v_mfma_f32_16x16x32_bf16 v[80:83], a[68:71], v[192:195], v[80:83]
    buffer_load_dwordx4 v[180:183], v9, s[16:19], s44 offen sc1
    v_mfma_f32_16x16x32_bf16 v[84:87], a[68:71], v[196:199], v[84:87]
    v_mfma_f32_16x16x32_bf16 v[88:91], a[68:71], v[200:203], v[88:91]
    v_mfma_f32_16x16x32_bf16 v[92:95], a[68:71], v[204:207], v[92:95]
    ds_read_b64_tr_b16 a[68:69], v13 offset:16384
    ds_read_b64_tr_b16 a[70:71], v13 offset:18432
    v_mfma_f32_16x16x32_bf16 v[96:99], a[72:75], v[192:195], v[96:99]
    buffer_load_dwordx4 v[184:187], v10, s[16:19], s44 offen sc1
    v_mfma_f32_16x16x32_bf16 v[100:103], a[72:75], v[196:199], v[100:103]
    v_mfma_f32_16x16x32_bf16 v[104:107], a[72:75], v[200:203], v[104:107]
    v_mfma_f32_16x16x32_bf16 v[108:111], a[72:75], v[204:207], v[108:111]
    ds_read_b64_tr_b16 a[72:73], v14 offset:16384
    ds_read_b64_tr_b16 a[74:75], v14 offset:18432
    v_mfma_f32_16x16x32_bf16 v[112:115], a[76:79], v[192:195], v[112:115]
    buffer_load_dwordx4 v[188:191], v11, s[16:19], s44 offen sc1
    v_mfma_f32_16x16x32_bf16 v[116:119], a[76:79], v[196:199], v[116:119]
    v_mfma_f32_16x16x32_bf16 v[120:123], a[76:79], v[200:203], v[120:123]
    v_mfma_f32_16x16x32_bf16 v[124:127], a[76:79], v[204:207], v[124:127]
    ds_read_b64_tr_b16 a[76:77], v15 offset:16384
    ds_read_b64_tr_b16 a[78:79], v15 offset:18432
    s_add_u32 s44, s55, 6144
    s_and_b32 s44, s44, 0x1fff
    s_add_u32 s44, s44, 0
    s_waitcnt lgkmcnt(0)
    s_add_u32 m0, s37, 81920
    s_add_u32 s45, s55, 6144
    s_and_b32 s45, s45, 0x1fff
    s_add_u32 s45, s45, 16384
    s_lshl_b32 s45, s45, 2
    buffer_load_dwordx4 v44, s[12:15], s45 offen offset:0 sc1 lds
    buffer_load_dwordx4 v45, s[12:15], s45 offen offset:1024 sc1 lds
    buffer_load_dwordx4 v44, s[12:15], s45 offen offset:2048 sc1 lds
    buffer_load_dwordx4 v45, s[12:15], s45 offen offset:3072 sc1 lds
    s_waitcnt vmcnt(47)
    v_mfma_f32_16x16x32_bf16 v[64:67], a[80:83], v[208:211], v[64:67]
    buffer_load_dwordx4 v[192:195], v8, s[16:19], s44 offen sc1
    s_waitcnt vmcnt(47)
    v_mfma_f32_16x16x32_bf16 v[68:71], a[80:83], v[212:215], v[68:71]
    s_waitcnt vmcnt(46)
    v_mfma_f32_16x16x32_bf16 v[72:75], a[80:83], v[216:219], v[72:75]
    s_waitcnt vmcnt(45)
    v_mfma_f32_16x16x32_bf16 v[76:79], a[80:83], v[220:223], v[76:79]
    ds_read_b64_tr_b16 a[80:81], v12 offset:32768
    ds_read_b64_tr_b16 a[82:83], v12 offset:34816
    v_mfma_f32_16x16x32_bf16 v[80:83], a[84:87], v[208:211], v[80:83]
    buffer_load_dwordx4 v[196:199], v9, s[16:19], s44 offen sc1
    v_mfma_f32_16x16x32_bf16 v[84:87], a[84:87], v[212:215], v[84:87]
    v_mfma_f32_16x16x32_bf16 v[88:91], a[84:87], v[216:219], v[88:91]
    v_mfma_f32_16x16x32_bf16 v[92:95], a[84:87], v[220:223], v[92:95]
    ds_read_b64_tr_b16 a[84:85], v13 offset:32768
    ds_read_b64_tr_b16 a[86:87], v13 offset:34816
    v_mfma_f32_16x16x32_bf16 v[96:99], a[88:91], v[208:211], v[96:99]
    buffer_load_dwordx4 v[200:203], v10, s[16:19], s44 offen sc1
    v_mfma_f32_16x16x32_bf16 v[100:103], a[88:91], v[212:215], v[100:103]
    v_mfma_f32_16x16x32_bf16 v[104:107], a[88:91], v[216:219], v[104:107]
    v_mfma_f32_16x16x32_bf16 v[108:111], a[88:91], v[220:223], v[108:111]
    ds_read_b64_tr_b16 a[88:89], v14 offset:32768
    ds_read_b64_tr_b16 a[90:91], v14 offset:34816
    v_mfma_f32_16x16x32_bf16 v[112:115], a[92:95], v[208:211], v[112:115]
    buffer_load_dwordx4 v[204:207], v11, s[16:19], s44 offen sc1
    v_mfma_f32_16x16x32_bf16 v[116:119], a[92:95], v[212:215], v[116:119]
    v_mfma_f32_16x16x32_bf16 v[120:123], a[92:95], v[216:219], v[120:123]
    v_mfma_f32_16x16x32_bf16 v[124:127], a[92:95], v[220:223], v[124:127]
    ds_read_b64_tr_b16 a[92:93], v15 offset:32768
    ds_read_b64_tr_b16 a[94:95], v15 offset:34816
    s_add_u32 s44, s55, 7168
    s_and_b32 s44, s44, 0x1fff
    s_add_u32 s44, s44, 0
    s_waitcnt lgkmcnt(0)
    s_add_u32 m0, s37, 98304
    s_add_u32 s45, s55, 7168
    s_and_b32 s45, s45, 0x1fff
    s_add_u32 s45, s45, 16384
    s_lshl_b32 s45, s45, 2
    buffer_load_dwordx4 v44, s[12:15], s45 offen offset:0 sc1 lds
    buffer_load_dwordx4 v45, s[12:15], s45 offen offset:1024 sc1 lds
    buffer_load_dwordx4 v44, s[12:15], s45 offen offset:2048 sc1 lds
    buffer_load_dwordx4 v45, s[12:15], s45 offen offset:3072 sc1 lds
    s_waitcnt vmcnt(51)
    v_mfma_f32_16x16x32_bf16 v[64:67], a[96:99], v[224:227], v[64:67]
    buffer_load_dwordx4 v[208:211], v8, s[16:19], s44 offen sc1
    s_waitcnt vmcnt(51)
    v_mfma_f32_16x16x32_bf16 v[68:71], a[96:99], v[228:231], v[68:71]
    s_waitcnt vmcnt(50)
    v_mfma_f32_16x16x32_bf16 v[72:75], a[96:99], v[232:235], v[72:75]
    s_waitcnt vmcnt(49)
    v_mfma_f32_16x16x32_bf16 v[76:79], a[96:99], v[236:239], v[76:79]
    ds_read_b64_tr_b16 a[96:97], v4 offset:49152
    ds_read_b64_tr_b16 a[98:99], v4 offset:51200
    v_mfma_f32_16x16x32_bf16 v[80:83], a[100:103], v[224:227], v[80:83]
    buffer_load_dwordx4 v[212:215], v9, s[16:19], s44 offen sc1
    v_mfma_f32_16x16x32_bf16 v[84:87], a[100:103], v[228:231], v[84:87]
    v_mfma_f32_16x16x32_bf16 v[88:91], a[100:103], v[232:235], v[88:91]
    v_mfma_f32_16x16x32_bf16 v[92:95], a[100:103], v[236:239], v[92:95]
    ds_read_b64_tr_b16 a[100:101], v5 offset:49152
    ds_read_b64_tr_b16 a[102:103], v5 offset:51200
    v_mfma_f32_16x16x32_bf16 v[96:99], a[104:107], v[224:227], v[96:99]
    buffer_load_dwordx4 v[216:219], v10, s[16:19], s44 offen sc1
    v_mfma_f32_16x16x32_bf16 v[100:103], a[104:107], v[228:231], v[100:103]
    v_mfma_f32_16x16x32_bf16 v[104:107], a[104:107], v[232:235], v[104:107]
    v_mfma_f32_16x16x32_bf16 v[108:111], a[104:107], v[236:239], v[108:111]
    ds_read_b64_tr_b16 a[104:105], v6 offset:49152
    ds_read_b64_tr_b16 a[106:107], v6 offset:51200
    v_mfma_f32_16x16x32_bf16 v[112:115], a[108:111], v[224:227], v[112:115]
    buffer_load_dwordx4 v[220:223], v11, s[16:19], s44 offen sc1
    v_mfma_f32_16x16x32_bf16 v[116:119], a[108:111], v[228:231], v[116:119]
    v_mfma_f32_16x16x32_bf16 v[120:123], a[108:111], v[232:235], v[120:123]
    v_mfma_f32_16x16x32_bf16 v[124:127], a[108:111], v[236:239], v[124:127]
    ds_read_b64_tr_b16 a[108:109], v7 offset:49152
    ds_read_b64_tr_b16 a[110:111], v7 offset:51200
    s_add_u32 s44, s55, 0
    s_and_b32 s44, s44, 0x1fff
    s_add_u32 s44, s44, 8192
    s_waitcnt lgkmcnt(0)
    s_add_u32 m0, s37, 49152
    s_mov_b32 s45, 98304
    buffer_load_dwordx4 v44, s[12:15], s45 offen offset:0 sc1 lds
    buffer_load_dwordx4 v45, s[12:15], s45 offen offset:1024 sc1 lds
    buffer_load_dwordx4 v44, s[12:15], s45 offen offset:2048 sc1 lds
    buffer_load_dwordx4 v45, s[12:15], s45 offen offset:3072 sc1 lds
    s_waitcnt vmcnt(55)
    v_mfma_f32_16x16x32_bf16 v[64:67], a[112:115], v[240:243], v[64:67]
    buffer_load_dwordx4 v[224:227], v8, s[16:19], s44 offen sc1
    s_waitcnt vmcnt(55)
    v_mfma_f32_16x16x32_bf16 v[68:71], a[112:115], v[244:247], v[68:71]
    s_waitcnt vmcnt(54)
    v_mfma_f32_16x16x32_bf16 v[72:75], a[112:115], v[248:251], v[72:75]
    s_waitcnt vmcnt(53)
    v_mfma_f32_16x16x32_bf16 v[76:79], a[112:115], v[252:255], v[76:79]
    ds_read_b64_tr_b16 a[112:113], v12 offset:49152
    ds_read_b64_tr_b16 a[114:115], v12 offset:51200
    v_mfma_f32_16x16x32_bf16 v[80:83], a[116:119], v[240:243], v[80:83]
    buffer_load_dwordx4 v[228:231], v9, s[16:19], s44 offen sc1
    v_mfma_f32_16x16x32_bf16 v[84:87], a[116:119], v[244:247], v[84:87]
    v_mfma_f32_16x16x32_bf16 v[88:91], a[116:119], v[248:251], v[88:91]
    v_mfma_f32_16x16x32_bf16 v[92:95], a[116:119], v[252:255], v[92:95]
    ds_read_b64_tr_b16 a[116:117], v13 offset:49152
    ds_read_b64_tr_b16 a[118:119], v13 offset:51200
    v_mfma_f32_16x16x32_bf16 v[96:99], a[120:123], v[240:243], v[96:99]
    buffer_load_dwordx4 v[232:235], v10, s[16:19], s44 offen sc1
    v_mfma_f32_16x16x32_bf16 v[100:103], a[120:123], v[244:247], v[100:103]
    v_mfma_f32_16x16x32_bf16 v[104:107], a[120:123], v[248:251], v[104:107]
    v_mfma_f32_16x16x32_bf16 v[108:111], a[120:123], v[252:255], v[108:111]
    ds_read_b64_tr_b16 a[120:121], v14 offset:49152
    ds_read_b64_tr_b16 a[122:123], v14 offset:51200
    v_mfma_f32_16x16x32_bf16 v[112:115], a[124:127], v[240:243], v[112:115]
    buffer_load_dwordx4 v[236:239], v11, s[16:19], s44 offen sc1
    v_mfma_f32_16x16x32_bf16 v[116:119], a[124:127], v[244:247], v[116:119]
    v_mfma_f32_16x16x32_bf16 v[120:123], a[124:127], v[248:251], v[120:123]
    v_mfma_f32_16x16x32_bf16 v[124:127], a[124:127], v[252:255], v[124:127]
    ds_read_b64_tr_b16 a[124:125], v15 offset:49152
    ds_read_b64_tr_b16 a[126:127], v15 offset:51200
    s_add_u32 s44, s55, 1024
    s_and_b32 s44, s44, 0x1fff
    s_add_u32 s44, s44, 8192
    s_waitcnt lgkmcnt(0)
    s_add_u32 m0, s37, 114688
    s_mov_b32 s45, 102400
    buffer_load_dwordx4 v44, s[12:15], s45 offen offset:0 sc1 lds
    buffer_load_dwordx4 v45, s[12:15], s45 offen offset:1024 sc1 lds
    buffer_load_dwordx4 v44, s[12:15], s45 offen offset:2048 sc1 lds
    buffer_load_dwordx4 v45, s[12:15], s45 offen offset:3072 sc1 lds
    s_waitcnt vmcnt(56)
    s_waitcnt vmcnt(55)
    v_mfma_f32_16x16x32_bf16 v[64:67], a[128:131], v[128:131], v[64:67]
    buffer_load_dwordx4 v[240:243], v8, s[16:19], s44 offen sc1
    s_waitcnt vmcnt(55)
    v_mfma_f32_16x16x32_bf16 v[68:71], a[128:131], v[132:135], v[68:71]
    s_waitcnt vmcnt(54)
    v_mfma_f32_16x16x32_bf16 v[72:75], a[128:131], v[136:139], v[72:75]
    s_waitcnt vmcnt(53)
    v_mfma_f32_16x16x32_bf16 v[76:79], a[128:131], v[140:143], v[76:79]
    ds_read_b64_tr_b16 a[128:129], v4 offset:0
    ds_read_b64_tr_b16 a[130:131], v4 offset:2048
    v_mfma_f32_16x16x32_bf16 v[80:83], a[132:135], v[128:131], v[80:83]
    buffer_load_dwordx4 v[244:247], v9, s[16:19], s44 offen sc1
    v_mfma_f32_16x16x32_bf16 v[84:87], a[132:135], v[132:135], v[84:87]
    v_mfma_f32_16x16x32_bf16 v[88:91], a[132:135], v[136:139], v[88:91]
    v_mfma_f32_16x16x32_bf16 v[92:95], a[132:135], v[140:143], v[92:95]
    ds_read_b64_tr_b16 a[132:133], v5 offset:0
    ds_read_b64_tr_b16 a[134:135], v5 offset:2048
    v_mfma_f32_16x16x32_bf16 v[96:99], a[136:139], v[128:131], v[96:99]
    buffer_load_dwordx4 v[248:251], v10, s[16:19], s44 offen sc1
    v_mfma_f32_16x16x32_bf16 v[100:103], a[136:139], v[132:135], v[100:103]
    v_mfma_f32_16x16x32_bf16 v[104:107], a[136:139], v[136:139], v[104:107]
    v_mfma_f32_16x16x32_bf16 v[108:111], a[136:139], v[140:143], v[108:111]
    ds_read_b64_tr_b16 a[136:137], v6 offset:0
    ds_read_b64_tr_b16 a[138:139], v6 offset:2048
    v_mfma_f32_16x16x32_bf16 v[112:115], a[140:143], v[128:131], v[112:115]
    buffer_load_dwordx4 v[252:255], v11, s[16:19], s44 offen sc1
    v_mfma_f32_16x16x32_bf16 v[116:119], a[140:143], v[132:135], v[116:119]
    v_mfma_f32_16x16x32_bf16 v[120:123], a[140:143], v[136:139], v[120:123]
    v_mfma_f32_16x16x32_bf16 v[124:127], a[140:143], v[140:143], v[124:127]
    ds_read_b64_tr_b16 a[140:141], v7 offset:0
    ds_read_b64_tr_b16 a[142:143], v7 offset:2048
    s_add_u32 s44, s55, 2048
    s_and_b32 s44, s44, 0x1fff
    s_add_u32 s44, s44, 8192
    s_waitcnt vmcnt(52)
    s_waitcnt vmcnt(51)
    v_mfma_f32_16x16x32_bf16 v[64:67], a[144:147], v[144:147], v[64:67]
    buffer_load_dwordx4 v[128:131], v8, s[16:19], s44 offen sc1
    s_waitcnt vmcnt(51)
    v_mfma_f32_16x16x32_bf16 v[68:71], a[144:147], v[148:151], v[68:71]
    s_waitcnt vmcnt(50)
    v_mfma_f32_16x16x32_bf16 v[72:75], a[144:147], v[152:155], v[72:75]
    s_waitcnt vmcnt(49)
    v_mfma_f32_16x16x32_bf16 v[76:79], a[144:147], v[156:159], v[76:79]
    ds_read_b64_tr_b16 a[144:145], v4 offset:16384
    ds_read_b64_tr_b16 a[146:147], v4 offset:18432
    v_mfma_f32_16x16x32_bf16 v[80:83], a[148:151], v[144:147], v[80:83]
    buffer_load_dwordx4 v[132:135], v9, s[16:19], s44 offen sc1
    v_mfma_f32_16x16x32_bf16 v[84:87], a[148:151], v[148:151], v[84:87]
    v_mfma_f32_16x16x32_bf16 v[88:91], a[148:151], v[152:155], v[88:91]
    v_mfma_f32_16x16x32_bf16 v[92:95], a[148:151], v[156:159], v[92:95]
    ds_read_b64_tr_b16 a[148:149], v5 offset:16384
    ds_read_b64_tr_b16 a[150:151], v5 offset:18432
    v_mfma_f32_16x16x32_bf16 v[96:99], a[152:155], v[144:147], v[96:99]
    buffer_load_dwordx4 v[136:139], v10, s[16:19], s44 offen sc1
    v_mfma_f32_16x16x32_bf16 v[100:103], a[152:155], v[148:151], v[100:103]
    v_mfma_f32_16x16x32_bf16 v[104:107], a[152:155], v[152:155], v[104:107]
    v_mfma_f32_16x16x32_bf16 v[108:111], a[152:155], v[156:159], v[108:111]
    ds_read_b64_tr_b16 a[152:153], v6 offset:16384
    ds_read_b64_tr_b16 a[154:155], v6 offset:18432
    v_mfma_f32_16x16x32_bf16 v[112:115], a[156:159], v[144:147], v[112:115]
    buffer_load_dwordx4 v[140:143], v11, s[16:19], s44 offen sc1
    v_mfma_f32_16x16x32_bf16 v[116:119], a[156:159], v[148:151], v[116:119]
    v_mfma_f32_16x16x32_bf16 v[120:123], a[156:159], v[152:155], v[120:123]
    v_mfma_f32_16x16x32_bf16 v[124:127], a[156:159], v[156:159], v[124:127]
    ds_read_b64_tr_b16 a[156:157], v7 offset:16384
    ds_read_b64_tr_b16 a[158:159], v7 offset:18432
    s_add_u32 s44, s55, 3072
    s_and_b32 s44, s44, 0x1fff
    s_add_u32 s44, s44, 8192
    s_waitcnt vmcnt(48)
    s_waitcnt vmcnt(47)
    v_mfma_f32_16x16x32_bf16 v[64:67], a[160:163], v[160:163], v[64:67]
    buffer_load_dwordx4 v[144:147], v8, s[16:19], s44 offen sc1
    s_waitcnt vmcnt(47)
    v_mfma_f32_16x16x32_bf16 v[68:71], a[160:163], v[164:167], v[68:71]
    s_waitcnt vmcnt(46)
    v_mfma_f32_16x16x32_bf16 v[72:75], a[160:163], v[168:171], v[72:75]
    s_waitcnt vmcnt(45)
    v_mfma_f32_16x16x32_bf16 v[76:79], a[160:163], v[172:175], v[76:79]
    ds_read_b64_tr_b16 a[160:161], v4 offset:32768
    ds_read_b64_tr_b16 a[162:163], v4 offset:34816
    v_mfma_f32_16x16x32_bf16 v[80:83], a[164:167], v[160:163], v[80:83]
    buffer_load_dwordx4 v[148:151], v9, s[16:19], s44 offen sc1
    v_mfma_f32_16x16x32_bf16 v[84:87], a[164:167], v[164:167], v[84:87]
    v_mfma_f32_16x16x32_bf16 v[88:91], a[164:167], v[168:171], v[88:91]
    v_mfma_f32_16x16x32_bf16 v[92:95], a[164:167], v[172:175], v[92:95]
    ds_read_b64_tr_b16 a[164:165], v5 offset:32768
    ds_read_b64_tr_b16 a[166:167], v5 offset:34816
    v_mfma_f32_16x16x32_bf16 v[96:99], a[168:171], v[160:163], v[96:99]
    buffer_load_dwordx4 v[152:155], v10, s[16:19], s44 offen sc1
    v_mfma_f32_16x16x32_bf16 v[100:103], a[168:171], v[164:167], v[100:103]
    v_mfma_f32_16x16x32_bf16 v[104:107], a[168:171], v[168:171], v[104:107]
    v_mfma_f32_16x16x32_bf16 v[108:111], a[168:171], v[172:175], v[108:111]
    ds_read_b64_tr_b16 a[168:169], v6 offset:32768
    ds_read_b64_tr_b16 a[170:171], v6 offset:34816
    v_mfma_f32_16x16x32_bf16 v[112:115], a[172:175], v[160:163], v[112:115]
    buffer_load_dwordx4 v[156:159], v11, s[16:19], s44 offen sc1
    v_mfma_f32_16x16x32_bf16 v[116:119], a[172:175], v[164:167], v[116:119]
    v_mfma_f32_16x16x32_bf16 v[120:123], a[172:175], v[168:171], v[120:123]
    v_mfma_f32_16x16x32_bf16 v[124:127], a[172:175], v[172:175], v[124:127]
    ds_read_b64_tr_b16 a[172:173], v7 offset:32768
    ds_read_b64_tr_b16 a[174:175], v7 offset:34816
    s_add_u32 s44, s55, 4096
    s_and_b32 s44, s44, 0x1fff
    s_add_u32 s44, s44, 8192
    s_waitcnt vmcnt(44)
    s_waitcnt vmcnt(43)
    v_mfma_f32_16x16x32_bf16 v[64:67], a[176:179], v[176:179], v[64:67]
    buffer_load_dwordx4 v[160:163], v8, s[16:19], s44 offen sc1
    s_waitcnt vmcnt(43)
    v_mfma_f32_16x16x32_bf16 v[68:71], a[176:179], v[180:183], v[68:71]
    s_waitcnt vmcnt(42)
    v_mfma_f32_16x16x32_bf16 v[72:75], a[176:179], v[184:187], v[72:75]
    s_waitcnt vmcnt(41)
    v_mfma_f32_16x16x32_bf16 v[76:79], a[176:179], v[188:191], v[76:79]
    ds_read_b64_tr_b16 a[176:177], v12 offset:0
    ds_read_b64_tr_b16 a[178:179], v12 offset:2048
    v_mfma_f32_16x16x32_bf16 v[80:83], a[180:183], v[176:179], v[80:83]
    buffer_load_dwordx4 v[164:167], v9, s[16:19], s44 offen sc1
    v_mfma_f32_16x16x32_bf16 v[84:87], a[180:183], v[180:183], v[84:87]
    v_mfma_f32_16x16x32_bf16 v[88:91], a[180:183], v[184:187], v[88:91]
    v_mfma_f32_16x16x32_bf16 v[92:95], a[180:183], v[188:191], v[92:95]
    ds_read_b64_tr_b16 a[180:181], v13 offset:0
    ds_read_b64_tr_b16 a[182:183], v13 offset:2048
    v_mfma_f32_16x16x32_bf16 v[96:99], a[184:187], v[176:179], v[96:99]
    buffer_load_dwordx4 v[168:171], v10, s[16:19], s44 offen sc1
    v_mfma_f32_16x16x32_bf16 v[100:103], a[184:187], v[180:183], v[100:103]
    v_mfma_f32_16x16x32_bf16 v[104:107], a[184:187], v[184:187], v[104:107]
    v_mfma_f32_16x16x32_bf16 v[108:111], a[184:187], v[188:191], v[108:111]
    ds_read_b64_tr_b16 a[184:185], v14 offset:0
    ds_read_b64_tr_b16 a[186:187], v14 offset:2048
    v_mfma_f32_16x16x32_bf16 v[112:115], a[188:191], v[176:179], v[112:115]
    buffer_load_dwordx4 v[172:175], v11, s[16:19], s44 offen sc1
    v_mfma_f32_16x16x32_bf16 v[116:119], a[188:191], v[180:183], v[116:119]
    v_mfma_f32_16x16x32_bf16 v[120:123], a[188:191], v[184:187], v[120:123]
    v_mfma_f32_16x16x32_bf16 v[124:127], a[188:191], v[188:191], v[124:127]
    ds_read_b64_tr_b16 a[188:189], v15 offset:0
    ds_read_b64_tr_b16 a[190:191], v15 offset:2048
    s_add_u32 s44, s55, 5120
    s_and_b32 s44, s44, 0x1fff
    s_add_u32 s44, s44, 8192
    s_waitcnt vmcnt(40)
    s_waitcnt vmcnt(39)
    v_mfma_f32_16x16x32_bf16 v[64:67], a[192:195], v[192:195], v[64:67]
    buffer_load_dwordx4 v[176:179], v8, s[16:19], s44 offen sc1
    s_waitcnt vmcnt(39)
    v_mfma_f32_16x16x32_bf16 v[68:71], a[192:195], v[196:199], v[68:71]
    s_waitcnt vmcnt(38)
    v_mfma_f32_16x16x32_bf16 v[72:75], a[192:195], v[200:203], v[72:75]
    s_waitcnt vmcnt(37)
    v_mfma_f32_16x16x32_bf16 v[76:79], a[192:195], v[204:207], v[76:79]
    ds_read_b64_tr_b16 a[192:193], v12 offset:16384
    ds_read_b64_tr_b16 a[194:195], v12 offset:18432
    v_mfma_f32_16x16x32_bf16 v[80:83], a[196:199], v[192:195], v[80:83]
    buffer_load_dwordx4 v[180:183], v9, s[16:19], s44 offen sc1
    v_mfma_f32_16x16x32_bf16 v[84:87], a[196:199], v[196:199], v[84:87]
    v_mfma_f32_16x16x32_bf16 v[88:91], a[196:199], v[200:203], v[88:91]
    v_mfma_f32_16x16x32_bf16 v[92:95], a[196:199], v[204:207], v[92:95]
    ds_read_b64_tr_b16 a[196:197], v13 offset:16384
    ds_read_b64_tr_b16 a[198:199], v13 offset:18432
    v_mfma_f32_16x16x32_bf16 v[96:99], a[200:203], v[192:195], v[96:99]
    buffer_load_dwordx4 v[184:187], v10, s[16:19], s44 offen sc1
    v_mfma_f32_16x16x32_bf16 v[100:103], a[200:203], v[196:199], v[100:103]
    v_mfma_f32_16x16x32_bf16 v[104:107], a[200:203], v[200:203], v[104:107]
    v_mfma_f32_16x16x32_bf16 v[108:111], a[200:203], v[204:207], v[108:111]
    ds_read_b64_tr_b16 a[200:201], v14 offset:16384
    ds_read_b64_tr_b16 a[202:203], v14 offset:18432
    v_mfma_f32_16x16x32_bf16 v[112:115], a[204:207], v[192:195], v[112:115]
    buffer_load_dwordx4 v[188:191], v11, s[16:19], s44 offen sc1
    v_mfma_f32_16x16x32_bf16 v[116:119], a[204:207], v[196:199], v[116:119]
    v_mfma_f32_16x16x32_bf16 v[120:123], a[204:207], v[200:203], v[120:123]
    v_mfma_f32_16x16x32_bf16 v[124:127], a[204:207], v[204:207], v[124:127]
    ds_read_b64_tr_b16 a[204:205], v15 offset:16384
    ds_read_b64_tr_b16 a[206:207], v15 offset:18432
    s_add_u32 s44, s55, 6144
    s_and_b32 s44, s44, 0x1fff
    s_add_u32 s44, s44, 8192
    s_waitcnt vmcnt(36)
    s_waitcnt vmcnt(35)
    v_mfma_f32_16x16x32_bf16 v[64:67], a[208:211], v[208:211], v[64:67]
    buffer_load_dwordx4 v[192:195], v8, s[16:19], s44 offen sc1
    s_waitcnt vmcnt(35)
    v_mfma_f32_16x16x32_bf16 v[68:71], a[208:211], v[212:215], v[68:71]
    s_waitcnt vmcnt(34)
    v_mfma_f32_16x16x32_bf16 v[72:75], a[208:211], v[216:219], v[72:75]
    s_waitcnt vmcnt(33)
    v_mfma_f32_16x16x32_bf16 v[76:79], a[208:211], v[220:223], v[76:79]
    ds_read_b64_tr_b16 a[208:209], v12 offset:32768
    ds_read_b64_tr_b16 a[210:211], v12 offset:34816
    v_mfma_f32_16x16x32_bf16 v[80:83], a[212:215], v[208:211], v[80:83]
    buffer_load_dwordx4 v[196:199], v9, s[16:19], s44 offen sc1
    v_mfma_f32_16x16x32_bf16 v[84:87], a[212:215], v[212:215], v[84:87]
    v_mfma_f32_16x16x32_bf16 v[88:91], a[212:215], v[216:219], v[88:91]
    v_mfma_f32_16x16x32_bf16 v[92:95], a[212:215], v[220:223], v[92:95]
    ds_read_b64_tr_b16 a[212:213], v13 offset:32768
    ds_read_b64_tr_b16 a[214:215], v13 offset:34816
    v_mfma_f32_16x16x32_bf16 v[96:99], a[216:219], v[208:211], v[96:99]
    buffer_load_dwordx4 v[200:203], v10, s[16:19], s44 offen sc1
    v_mfma_f32_16x16x32_bf16 v[100:103], a[216:219], v[212:215], v[100:103]
    v_mfma_f32_16x16x32_bf16 v[104:107], a[216:219], v[216:219], v[104:107]
    v_mfma_f32_16x16x32_bf16 v[108:111], a[216:219], v[220:223], v[108:111]
    ds_read_b64_tr_b16 a[216:217], v14 offset:32768
    ds_read_b64_tr_b16 a[218:219], v14 offset:34816
    v_mfma_f32_16x16x32_bf16 v[112:115], a[220:223], v[208:211], v[112:115]
    buffer_load_dwordx4 v[204:207], v11, s[16:19], s44 offen sc1
    v_mfma_f32_16x16x32_bf16 v[116:119], a[220:223], v[212:215], v[116:119]
    v_mfma_f32_16x16x32_bf16 v[120:123], a[220:223], v[216:219], v[120:123]
    v_mfma_f32_16x16x32_bf16 v[124:127], a[220:223], v[220:223], v[124:127]
    ds_read_b64_tr_b16 a[220:221], v15 offset:32768
    ds_read_b64_tr_b16 a[222:223], v15 offset:34816
    s_add_u32 s44, s55, 7168
    s_and_b32 s44, s44, 0x1fff
    s_add_u32 s44, s44, 8192
    s_waitcnt vmcnt(32)
    s_waitcnt vmcnt(31)
    v_mfma_f32_16x16x32_bf16 v[64:67], a[224:227], v[224:227], v[64:67]
    buffer_load_dwordx4 v[208:211], v8, s[16:19], s44 offen sc1
    s_waitcnt vmcnt(31)
    v_mfma_f32_16x16x32_bf16 v[68:71], a[224:227], v[228:231], v[68:71]
    s_waitcnt vmcnt(30)
    v_mfma_f32_16x16x32_bf16 v[72:75], a[224:227], v[232:235], v[72:75]
    s_waitcnt vmcnt(29)
    v_mfma_f32_16x16x32_bf16 v[76:79], a[224:227], v[236:239], v[76:79]
    ds_read_b64_tr_b16 a[224:225], v4 offset:49152
    ds_read_b64_tr_b16 a[226:227], v4 offset:51200
    v_mfma_f32_16x16x32_bf16 v[80:83], a[228:231], v[224:227], v[80:83]
    buffer_load_dwordx4 v[212:215], v9, s[16:19], s44 offen sc1
    v_mfma_f32_16x16x32_bf16 v[84:87], a[228:231], v[228:231], v[84:87]
    v_mfma_f32_16x16x32_bf16 v[88:91], a[228:231], v[232:235], v[88:91]
    v_mfma_f32_16x16x32_bf16 v[92:95], a[228:231], v[236:239], v[92:95]
    ds_read_b64_tr_b16 a[228:229], v5 offset:49152
    ds_read_b64_tr_b16 a[230:231], v5 offset:51200
    v_mfma_f32_16x16x32_bf16 v[96:99], a[232:235], v[224:227], v[96:99]
    buffer_load_dwordx4 v[216:219], v10, s[16:19], s44 offen sc1
    v_mfma_f32_16x16x32_bf16 v[100:103], a[232:235], v[228:231], v[100:103]
    v_mfma_f32_16x16x32_bf16 v[104:107], a[232:235], v[232:235], v[104:107]
    v_mfma_f32_16x16x32_bf16 v[108:111], a[232:235], v[236:239], v[108:111]
    ds_read_b64_tr_b16 a[232:233], v6 offset:49152
    ds_read_b64_tr_b16 a[234:235], v6 offset:51200
    v_mfma_f32_16x16x32_bf16 v[112:115], a[236:239], v[224:227], v[112:115]
    buffer_load_dwordx4 v[220:223], v11, s[16:19], s44 offen sc1
    v_mfma_f32_16x16x32_bf16 v[116:119], a[236:239], v[228:231], v[116:119]
    v_mfma_f32_16x16x32_bf16 v[120:123], a[236:239], v[232:235], v[120:123]
    v_mfma_f32_16x16x32_bf16 v[124:127], a[236:239], v[236:239], v[124:127]
    ds_read_b64_tr_b16 a[236:237], v7 offset:49152
    ds_read_b64_tr_b16 a[238:239], v7 offset:51200
    s_add_u32 s44, s55, 0
    s_and_b32 s44, s44, 0x1fff
    s_add_u32 s44, s44, 16384
    s_waitcnt vmcnt(28)
    s_waitcnt vmcnt(27)
    v_mfma_f32_16x16x32_bf16 v[64:67], a[240:243], v[240:243], v[64:67]
    buffer_load_dwordx4 v[224:227], v8, s[16:19], s44 offen sc1
    s_waitcnt vmcnt(27)
    v_mfma_f32_16x16x32_bf16 v[68:71], a[240:243], v[244:247], v[68:71]
    s_waitcnt vmcnt(26)
    v_mfma_f32_16x16x32_bf16 v[72:75], a[240:243], v[248:251], v[72:75]
    s_waitcnt vmcnt(25)
    v_mfma_f32_16x16x32_bf16 v[76:79], a[240:243], v[252:255], v[76:79]
    ds_read_b64_tr_b16 a[240:241], v12 offset:49152
    ds_read_b64_tr_b16 a[242:243], v12 offset:51200
    v_mfma_f32_16x16x32_bf16 v[80:83], a[244:247], v[240:243], v[80:83]
    buffer_load_dwordx4 v[228:231], v9, s[16:19], s44 offen sc1
    v_mfma_f32_16x16x32_bf16 v[84:87], a[244:247], v[244:247], v[84:87]
    v_mfma_f32_16x16x32_bf16 v[88:91], a[244:247], v[248:251], v[88:91]
    v_mfma_f32_16x16x32_bf16 v[92:95], a[244:247], v[252:255], v[92:95]
    ds_read_b64_tr_b16 a[244:245], v13 offset:49152
    ds_read_b64_tr_b16 a[246:247], v13 offset:51200
    v_mfma_f32_16x16x32_bf16 v[96:99], a[248:251], v[240:243], v[96:99]
    buffer_load_dwordx4 v[232:235], v10, s[16:19], s44 offen sc1
    v_mfma_f32_16x16x32_bf16 v[100:103], a[248:251], v[244:247], v[100:103]
    v_mfma_f32_16x16x32_bf16 v[104:107], a[248:251], v[248:251], v[104:107]
    v_mfma_f32_16x16x32_bf16 v[108:111], a[248:251], v[252:255], v[108:111]
    ds_read_b64_tr_b16 a[248:249], v14 offset:49152
    ds_read_b64_tr_b16 a[250:251], v14 offset:51200
    v_mfma_f32_16x16x32_bf16 v[112:115], a[252:255], v[240:243], v[112:115]
    buffer_load_dwordx4 v[236:239], v11, s[16:19], s44 offen sc1
    v_mfma_f32_16x16x32_bf16 v[116:119], a[252:255], v[244:247], v[116:119]
    v_mfma_f32_16x16x32_bf16 v[120:123], a[252:255], v[248:251], v[120:123]
    v_mfma_f32_16x16x32_bf16 v[124:127], a[252:255], v[252:255], v[124:127]
    ds_read_b64_tr_b16 a[252:253], v15 offset:49152
    ds_read_b64_tr_b16 a[254:255], v15 offset:51200
    s_add_u32 s44, s55, 1024
    s_and_b32 s44, s44, 0x1fff
    s_add_u32 s44, s44, 16384
    s_waitcnt vmcnt(27)
    v_mfma_f32_16x16x32_bf16 v[64:67], a[0:3], v[128:131], v[64:67]
    buffer_load_dwordx4 v[240:243], v8, s[16:19], s44 offen sc1
    s_waitcnt vmcnt(27)
    v_mfma_f32_16x16x32_bf16 v[68:71], a[0:3], v[132:135], v[68:71]
    s_waitcnt vmcnt(26)
    v_mfma_f32_16x16x32_bf16 v[72:75], a[0:3], v[136:139], v[72:75]
    s_waitcnt vmcnt(25)
    v_mfma_f32_16x16x32_bf16 v[76:79], a[0:3], v[140:143], v[76:79]
    v_mfma_f32_16x16x32_bf16 v[80:83], a[4:7], v[128:131], v[80:83]
    buffer_load_dwordx4 v[244:247], v9, s[16:19], s44 offen sc1
    v_mfma_f32_16x16x32_bf16 v[84:87], a[4:7], v[132:135], v[84:87]
    v_mfma_f32_16x16x32_bf16 v[88:91], a[4:7], v[136:139], v[88:91]
    v_mfma_f32_16x16x32_bf16 v[92:95], a[4:7], v[140:143], v[92:95]
    v_mfma_f32_16x16x32_bf16 v[96:99], a[8:11], v[128:131], v[96:99]
    buffer_load_dwordx4 v[248:251], v10, s[16:19], s44 offen sc1
    v_mfma_f32_16x16x32_bf16 v[100:103], a[8:11], v[132:135], v[100:103]
    v_mfma_f32_16x16x32_bf16 v[104:107], a[8:11], v[136:139], v[104:107]
    v_mfma_f32_16x16x32_bf16 v[108:111], a[8:11], v[140:143], v[108:111]
    v_mfma_f32_16x16x32_bf16 v[112:115], a[12:15], v[128:131], v[112:115]
    buffer_load_dwordx4 v[252:255], v11, s[16:19], s44 offen sc1
    v_mfma_f32_16x16x32_bf16 v[116:119], a[12:15], v[132:135], v[116:119]
    v_mfma_f32_16x16x32_bf16 v[120:123], a[12:15], v[136:139], v[120:123]
    v_mfma_f32_16x16x32_bf16 v[124:127], a[12:15], v[140:143], v[124:127]
    s_add_u32 s44, s55, 2048
    s_and_b32 s44, s44, 0x1fff
    s_add_u32 s44, s44, 16384
    s_waitcnt vmcnt(27)
    v_mfma_f32_16x16x32_bf16 v[64:67], a[16:19], v[144:147], v[64:67]
    buffer_load_dwordx4 v[128:131], v8, s[16:19], s44 offen sc1
    s_waitcnt vmcnt(27)
    v_mfma_f32_16x16x32_bf16 v[68:71], a[16:19], v[148:151], v[68:71]
    s_waitcnt vmcnt(26)
    v_mfma_f32_16x16x32_bf16 v[72:75], a[16:19], v[152:155], v[72:75]
    s_waitcnt vmcnt(25)
    v_mfma_f32_16x16x32_bf16 v[76:79], a[16:19], v[156:159], v[76:79]
    v_mfma_f32_16x16x32_bf16 v[80:83], a[20:23], v[144:147], v[80:83]
    buffer_load_dwordx4 v[132:135], v9, s[16:19], s44 offen sc1
    v_mfma_f32_16x16x32_bf16 v[84:87], a[20:23], v[148:151], v[84:87]
    v_mfma_f32_16x16x32_bf16 v[88:91], a[20:23], v[152:155], v[88:91]
    v_mfma_f32_16x16x32_bf16 v[92:95], a[20:23], v[156:159], v[92:95]
    v_mfma_f32_16x16x32_bf16 v[96:99], a[24:27], v[144:147], v[96:99]
    buffer_load_dwordx4 v[136:139], v10, s[16:19], s44 offen sc1
    v_mfma_f32_16x16x32_bf16 v[100:103], a[24:27], v[148:151], v[100:103]
    v_mfma_f32_16x16x32_bf16 v[104:107], a[24:27], v[152:155], v[104:107]
    v_mfma_f32_16x16x32_bf16 v[108:111], a[24:27], v[156:159], v[108:111]
    v_mfma_f32_16x16x32_bf16 v[112:115], a[28:31], v[144:147], v[112:115]
    buffer_load_dwordx4 v[140:143], v11, s[16:19], s44 offen sc1
    v_mfma_f32_16x16x32_bf16 v[116:119], a[28:31], v[148:151], v[116:119]
    v_mfma_f32_16x16x32_bf16 v[120:123], a[28:31], v[152:155], v[120:123]
    v_mfma_f32_16x16x32_bf16 v[124:127], a[28:31], v[156:159], v[124:127]
    s_add_u32 s44, s55, 3072
    s_and_b32 s44, s44, 0x1fff
    s_add_u32 s44, s44, 16384
    s_barrier
    s_waitcnt vmcnt(27)
    v_mfma_f32_16x16x32_bf16 v[64:67], a[32:35], v[160:163], v[64:67]
    buffer_load_dwordx4 v[144:147], v8, s[16:19], s44 offen sc1
    s_waitcnt vmcnt(27)
    v_mfma_f32_16x16x32_bf16 v[68:71], a[32:35], v[164:167], v[68:71]
    s_waitcnt vmcnt(26)
    v_mfma_f32_16x16x32_bf16 v[72:75], a[32:35], v[168:171], v[72:75]
    s_waitcnt vmcnt(25)
    v_mfma_f32_16x16x32_bf16 v[76:79], a[32:35], v[172:175], v[76:79]
    v_mfma_f32_16x16x32_bf16 v[80:83], a[36:39], v[160:163], v[80:83]
    buffer_load_dwordx4 v[148:151], v9, s[16:19], s44 offen sc1
    v_mfma_f32_16x16x32_bf16 v[84:87], a[36:39], v[164:167], v[84:87]
    v_mfma_f32_16x16x32_bf16 v[88:91], a[36:39], v[168:171], v[88:91]
    v_mfma_f32_16x16x32_bf16 v[92:95], a[36:39], v[172:175], v[92:95]
    v_mfma_f32_16x16x32_bf16 v[96:99], a[40:43], v[160:163], v[96:99]
    buffer_load_dwordx4 v[152:155], v10, s[16:19], s44 offen sc1
    v_mfma_f32_16x16x32_bf16 v[100:103], a[40:43], v[164:167], v[100:103]
    v_mfma_f32_16x16x32_bf16 v[104:107], a[40:43], v[168:171], v[104:107]
    v_mfma_f32_16x16x32_bf16 v[108:111], a[40:43], v[172:175], v[108:111]
    v_mfma_f32_16x16x32_bf16 v[112:115], a[44:47], v[160:163], v[112:115]
    buffer_load_dwordx4 v[156:159], v11, s[16:19], s44 offen sc1
    v_mfma_f32_16x16x32_bf16 v[116:119], a[44:47], v[164:167], v[116:119]
    v_mfma_f32_16x16x32_bf16 v[120:123], a[44:47], v[168:171], v[120:123]
    v_mfma_f32_16x16x32_bf16 v[124:127], a[44:47], v[172:175], v[124:127]
    s_add_u32 s44, s55, 4096
    s_and_b32 s44, s44, 0x1fff
    s_add_u32 s44, s44, 16384
    s_waitcnt vmcnt(27)
    v_mfma_f32_16x16x32_bf16 v[64:67], a[48:51], v[176:179], v[64:67]
    buffer_load_dwordx4 v[160:163], v8, s[16:19], s44 offen sc1
    s_waitcnt vmcnt(27)
    v_mfma_f32_16x16x32_bf16 v[68:71], a[48:51], v[180:183], v[68:71]
    s_waitcnt vmcnt(26)
    v_mfma_f32_16x16x32_bf16 v[72:75], a[48:51], v[184:187], v[72:75]
    s_waitcnt vmcnt(25)
    v_mfma_f32_16x16x32_bf16 v[76:79], a[48:51], v[188:191], v[76:79]
    v_mfma_f32_16x16x32_bf16 v[80:83], a[52:55], v[176:179], v[80:83]
    buffer_load_dwordx4 v[164:167], v9, s[16:19], s44 offen sc1
    v_mfma_f32_16x16x32_bf16 v[84:87], a[52:55], v[180:183], v[84:87]
    v_mfma_f32_16x16x32_bf16 v[88:91], a[52:55], v[184:187], v[88:91]
    v_mfma_f32_16x16x32_bf16 v[92:95], a[52:55], v[188:191], v[92:95]
    v_mfma_f32_16x16x32_bf16 v[96:99], a[56:59], v[176:179], v[96:99]
    buffer_load_dwordx4 v[168:171], v10, s[16:19], s44 offen sc1
    v_mfma_f32_16x16x32_bf16 v[100:103], a[56:59], v[180:183], v[100:103]
    v_mfma_f32_16x16x32_bf16 v[104:107], a[56:59], v[184:187], v[104:107]
    v_mfma_f32_16x16x32_bf16 v[108:111], a[56:59], v[188:191], v[108:111]
    v_mfma_f32_16x16x32_bf16 v[112:115], a[60:63], v[176:179], v[112:115]
    buffer_load_dwordx4 v[172:175], v11, s[16:19], s44 offen sc1
    v_mfma_f32_16x16x32_bf16 v[116:119], a[60:63], v[180:183], v[116:119]
    v_mfma_f32_16x16x32_bf16 v[120:123], a[60:63], v[184:187], v[120:123]
    v_mfma_f32_16x16x32_bf16 v[124:127], a[60:63], v[188:191], v[124:127]
    s_add_u32 s44, s55, 5120
    s_and_b32 s44, s44, 0x1fff
    s_add_u32 s44, s44, 16384
    s_waitcnt vmcnt(27)
    v_mfma_f32_16x16x32_bf16 v[64:67], a[64:67], v[192:195], v[64:67]
    buffer_load_dwordx4 v[176:179], v8, s[16:19], s44 offen sc1
    s_waitcnt vmcnt(27)
    v_mfma_f32_16x16x32_bf16 v[68:71], a[64:67], v[196:199], v[68:71]
    s_waitcnt vmcnt(26)
    v_mfma_f32_16x16x32_bf16 v[72:75], a[64:67], v[200:203], v[72:75]
    s_waitcnt vmcnt(25)
    v_mfma_f32_16x16x32_bf16 v[76:79], a[64:67], v[204:207], v[76:79]
    v_mfma_f32_16x16x32_bf16 v[80:83], a[68:71], v[192:195], v[80:83]
    buffer_load_dwordx4 v[180:183], v9, s[16:19], s44 offen sc1
    v_mfma_f32_16x16x32_bf16 v[84:87], a[68:71], v[196:199], v[84:87]
    v_mfma_f32_16x16x32_bf16 v[88:91], a[68:71], v[200:203], v[88:91]
    v_mfma_f32_16x16x32_bf16 v[92:95], a[68:71], v[204:207], v[92:95]
    v_mfma_f32_16x16x32_bf16 v[96:99], a[72:75], v[192:195], v[96:99]
    buffer_load_dwordx4 v[184:187], v10, s[16:19], s44 offen sc1
    v_mfma_f32_16x16x32_bf16 v[100:103], a[72:75], v[196:199], v[100:103]
    v_mfma_f32_16x16x32_bf16 v[104:107], a[72:75], v[200:203], v[104:107]
    v_mfma_f32_16x16x32_bf16 v[108:111], a[72:75], v[204:207], v[108:111]
    v_mfma_f32_16x16x32_bf16 v[112:115], a[76:79], v[192:195], v[112:115]
    buffer_load_dwordx4 v[188:191], v11, s[16:19], s44 offen sc1
    v_mfma_f32_16x16x32_bf16 v[116:119], a[76:79], v[196:199], v[116:119]
    v_mfma_f32_16x16x32_bf16 v[120:123], a[76:79], v[200:203], v[120:123]
    v_mfma_f32_16x16x32_bf16 v[124:127], a[76:79], v[204:207], v[124:127]
    s_add_u32 s44, s55, 6144
    s_and_b32 s44, s44, 0x1fff
    s_add_u32 s44, s44, 16384
    s_waitcnt vmcnt(27)
    v_mfma_f32_16x16x32_bf16 v[64:67], a[80:83], v[208:211], v[64:67]
    buffer_load_dwordx4 v[192:195], v8, s[16:19], s44 offen sc1
    s_waitcnt vmcnt(27)
    v_mfma_f32_16x16x32_bf16 v[68:71], a[80:83], v[212:215], v[68:71]
    s_waitcnt vmcnt(26)
    v_mfma_f32_16x16x32_bf16 v[72:75], a[80:83], v[216:219], v[72:75]
    s_waitcnt vmcnt(25)
    v_mfma_f32_16x16x32_bf16 v[76:79], a[80:83], v[220:223], v[76:79]
    v_mfma_f32_16x16x32_bf16 v[80:83], a[84:87], v[208:211], v[80:83]
    buffer_load_dwordx4 v[196:199], v9, s[16:19], s44 offen sc1
    v_mfma_f32_16x16x32_bf16 v[84:87], a[84:87], v[212:215], v[84:87]
    v_mfma_f32_16x16x32_bf16 v[88:91], a[84:87], v[216:219], v[88:91]
    v_mfma_f32_16x16x32_bf16 v[92:95], a[84:87], v[220:223], v[92:95]
    v_mfma_f32_16x16x32_bf16 v[96:99], a[88:91], v[208:211], v[96:99]
    buffer_load_dwordx4 v[200:203], v10, s[16:19], s44 offen sc1
    v_mfma_f32_16x16x32_bf16 v[100:103], a[88:91], v[212:215], v[100:103]
    v_mfma_f32_16x16x32_bf16 v[104:107], a[88:91], v[216:219], v[104:107]
    v_mfma_f32_16x16x32_bf16 v[108:111], a[88:91], v[220:223], v[108:111]
    v_mfma_f32_16x16x32_bf16 v[112:115], a[92:95], v[208:211], v[112:115]
    buffer_load_dwordx4 v[204:207], v11, s[16:19], s44 offen sc1
    v_mfma_f32_16x16x32_bf16 v[116:119], a[92:95], v[212:215], v[116:119]
    v_mfma_f32_16x16x32_bf16 v[120:123], a[92:95], v[216:219], v[120:123]
    v_mfma_f32_16x16x32_bf16 v[124:127], a[92:95], v[220:223], v[124:127]
    s_add_u32 s44, s55, 7168
    s_and_b32 s44, s44, 0x1fff
    s_add_u32 s44, s44, 16384
    s_waitcnt vmcnt(27)
    v_mfma_f32_16x16x32_bf16 v[64:67], a[96:99], v[224:227], v[64:67]
    buffer_load_dwordx4 v[208:211], v8, s[16:19], s44 offen sc1
    s_waitcnt vmcnt(27)
    v_mfma_f32_16x16x32_bf16 v[68:71], a[96:99], v[228:231], v[68:71]
    s_waitcnt vmcnt(26)
    v_mfma_f32_16x16x32_bf16 v[72:75], a[96:99], v[232:235], v[72:75]
    s_waitcnt vmcnt(25)
    v_mfma_f32_16x16x32_bf16 v[76:79], a[96:99], v[236:239], v[76:79]
    v_mfma_f32_16x16x32_bf16 v[80:83], a[100:103], v[224:227], v[80:83]
    buffer_load_dwordx4 v[212:215], v9, s[16:19], s44 offen sc1
    v_mfma_f32_16x16x32_bf16 v[84:87], a[100:103], v[228:231], v[84:87]
    v_mfma_f32_16x16x32_bf16 v[88:91], a[100:103], v[232:235], v[88:91]
    v_mfma_f32_16x16x32_bf16 v[92:95], a[100:103], v[236:239], v[92:95]
    v_mfma_f32_16x16x32_bf16 v[96:99], a[104:107], v[224:227], v[96:99]
    buffer_load_dwordx4 v[216:219], v10, s[16:19], s44 offen sc1
    v_mfma_f32_16x16x32_bf16 v[100:103], a[104:107], v[228:231], v[100:103]
    v_mfma_f32_16x16x32_bf16 v[104:107], a[104:107], v[232:235], v[104:107]
    v_mfma_f32_16x16x32_bf16 v[108:111], a[104:107], v[236:239], v[108:111]
    v_mfma_f32_16x16x32_bf16 v[112:115], a[108:111], v[224:227], v[112:115]
    buffer_load_dwordx4 v[220:223], v11, s[16:19], s44 offen sc1
    v_mfma_f32_16x16x32_bf16 v[116:119], a[108:111], v[228:231], v[116:119]
    v_mfma_f32_16x16x32_bf16 v[120:123], a[108:111], v[232:235], v[120:123]
    v_mfma_f32_16x16x32_bf16 v[124:127], a[108:111], v[236:239], v[124:127]
    s_mov_b32 s44, 24576
    s_waitcnt vmcnt(27)
    v_mfma_f32_16x16x32_bf16 v[64:67], a[112:115], v[240:243], v[64:67]
    buffer_load_dwordx4 v[224:227], v8, s[16:19], s44 offen sc1
    s_waitcnt vmcnt(27)
    v_mfma_f32_16x16x32_bf16 v[68:71], a[112:115], v[244:247], v[68:71]
    s_waitcnt vmcnt(26)
    v_mfma_f32_16x16x32_bf16 v[72:75], a[112:115], v[248:251], v[72:75]
    s_waitcnt vmcnt(25)
    v_mfma_f32_16x16x32_bf16 v[76:79], a[112:115], v[252:255], v[76:79]
    v_mfma_f32_16x16x32_bf16 v[80:83], a[116:119], v[240:243], v[80:83]
    buffer_load_dwordx4 v[228:231], v9, s[16:19], s44 offen sc1
    v_mfma_f32_16x16x32_bf16 v[84:87], a[116:119], v[244:247], v[84:87]
    v_mfma_f32_16x16x32_bf16 v[88:91], a[116:119], v[248:251], v[88:91]
    v_mfma_f32_16x16x32_bf16 v[92:95], a[116:119], v[252:255], v[92:95]
    v_mfma_f32_16x16x32_bf16 v[96:99], a[120:123], v[240:243], v[96:99]
    buffer_load_dwordx4 v[232:235], v10, s[16:19], s44 offen sc1
    v_mfma_f32_16x16x32_bf16 v[100:103], a[120:123], v[244:247], v[100:103]
    v_mfma_f32_16x16x32_bf16 v[104:107], a[120:123], v[248:251], v[104:107]
    v_mfma_f32_16x16x32_bf16 v[108:111], a[120:123], v[252:255], v[108:111]
    v_mfma_f32_16x16x32_bf16 v[112:115], a[124:127], v[240:243], v[112:115]
    buffer_load_dwordx4 v[236:239], v11, s[16:19], s44 offen sc1
    v_mfma_f32_16x16x32_bf16 v[116:119], a[124:127], v[244:247], v[116:119]
    v_mfma_f32_16x16x32_bf16 v[120:123], a[124:127], v[248:251], v[120:123]
    v_mfma_f32_16x16x32_bf16 v[124:127], a[124:127], v[252:255], v[124:127]
    s_mov_b32 s44, 25600
    s_waitcnt vmcnt(27) lgkmcnt(15)
    v_mfma_f32_16x16x32_bf16 v[64:67], a[128:131], v[128:131], v[64:67]
    buffer_load_dwordx4 v[240:243], v8, s[16:19], s44 offen sc1
    s_waitcnt vmcnt(27)
    v_mfma_f32_16x16x32_bf16 v[68:71], a[128:131], v[132:135], v[68:71]
    s_waitcnt vmcnt(26)
    v_mfma_f32_16x16x32_bf16 v[72:75], a[128:131], v[136:139], v[72:75]
    ds_read_b64 v[52:53], v2 offset:4096
    s_waitcnt vmcnt(25)
    v_mfma_f32_16x16x32_bf16 v[76:79], a[128:131], v[140:143], v[76:79]
    v_mfma_f32_16x16x32_bf16 v[80:83], a[132:135], v[128:131], v[80:83]
    buffer_load_dwordx4 v[244:247], v9, s[16:19], s44 offen sc1
    v_mfma_f32_16x16x32_bf16 v[84:87], a[132:135], v[132:135], v[84:87]
    v_mfma_f32_16x16x32_bf16 v[88:91], a[132:135], v[136:139], v[88:91]
    ds_read_b64 v[54:55], v2 offset:2048
    v_mfma_f32_16x16x32_bf16 v[92:95], a[132:135], v[140:143], v[92:95]
    v_mfma_f32_16x16x32_bf16 v[96:99], a[136:139], v[128:131], v[96:99]
    buffer_load_dwordx4 v[248:251], v10, s[16:19], s44 offen sc1
    v_mfma_f32_16x16x32_bf16 v[100:103], a[136:139], v[132:135], v[100:103]
    v_mfma_f32_16x16x32_bf16 v[104:107], a[136:139], v[136:139], v[104:107]
    ds_read_b64 v[56:57], v2 offset:6144
    v_mfma_f32_16x16x32_bf16 v[108:111], a[136:139], v[140:143], v[108:111]
    v_mfma_f32_16x16x32_bf16 v[112:115], a[140:143], v[128:131], v[112:115]
    buffer_load_dwordx4 v[252:255], v11, s[16:19], s44 offen sc1
    v_mfma_f32_16x16x32_bf16 v[116:119], a[140:143], v[132:135], v[116:119]
    v_mfma_f32_16x16x32_bf16 v[120:123], a[140:143], v[136:139], v[120:123]
    ds_read_b32 v58, v3
    v_mfma_f32_16x16x32_bf16 v[124:127], a[140:143], v[140:143], v[124:127]
    s_waitcnt vmcnt(27)
    v_mfma_f32_16x16x32_bf16 v[64:67], a[144:147], v[144:147], v[64:67]
    s_waitcnt vmcnt(26)
    v_mfma_f32_16x16x32_bf16 v[68:71], a[144:147], v[148:151], v[68:71]
    s_waitcnt vmcnt(25)
    v_mfma_f32_16x16x32_bf16 v[72:75], a[144:147], v[152:155], v[72:75]
    ds_read_b128 v[128:131], v50 offset:0
    s_waitcnt vmcnt(24)
    v_mfma_f32_16x16x32_bf16 v[76:79], a[144:147], v[156:159], v[76:79]
    v_mfma_f32_16x16x32_bf16 v[80:83], a[148:151], v[144:147], v[80:83]
    v_mfma_f32_16x16x32_bf16 v[84:87], a[148:151], v[148:151], v[84:87]
    v_mfma_f32_16x16x32_bf16 v[88:91], a[148:151], v[152:155], v[88:91]
    ds_read_b128 v[132:135], v50 offset:16
    v_mfma_f32_16x16x32_bf16 v[92:95], a[148:151], v[156:159], v[92:95]
    v_mfma_f32_16x16x32_bf16 v[96:99], a[152:155], v[144:147], v[96:99]
    v_mfma_f32_16x16x32_bf16 v[100:103], a[152:155], v[148:151], v[100:103]
    v_mfma_f32_16x16x32_bf16 v[104:107], a[152:155], v[152:155], v[104:107]
    ds_read_b128 v[136:139], v50 offset:128
    v_mfma_f32_16x16x32_bf16 v[108:111], a[152:155], v[156:159], v[108:111]
    v_mfma_f32_16x16x32_bf16 v[112:115], a[156:159], v[144:147], v[112:115]
    v_mfma_f32_16x16x32_bf16 v[116:119], a[156:159], v[148:151], v[116:119]
    v_mfma_f32_16x16x32_bf16 v[120:123], a[156:159], v[152:155], v[120:123]
    ds_read_b128 v[140:143], v50 offset:144
    v_mfma_f32_16x16x32_bf16 v[124:127], a[156:159], v[156:159], v[124:127]
    s_waitcnt vmcnt(23)
    v_mfma_f32_16x16x32_bf16 v[64:67], a[160:163], v[160:163], v[64:67]
    s_waitcnt vmcnt(22)
    v_mfma_f32_16x16x32_bf16 v[68:71], a[160:163], v[164:167], v[68:71]
    s_waitcnt vmcnt(21)
    v_mfma_f32_16x16x32_bf16 v[72:75], a[160:163], v[168:171], v[72:75]
    ds_read_b128 v[144:147], v50 offset:4096
    s_waitcnt vmcnt(20)
    v_mfma_f32_16x16x32_bf16 v[76:79], a[160:163], v[172:175], v[76:79]
    v_mfma_f32_16x16x32_bf16 v[80:83], a[164:167], v[160:163], v[80:83]
    v_mfma_f32_16x16x32_bf16 v[84:87], a[164:167], v[164:167], v[84:87]
    v_mfma_f32_16x16x32_bf16 v[88:91], a[164:167], v[168:171], v[88:91]
    ds_read_b128 v[148:151], v50 offset:4112
    v_mfma_f32_16x16x32_bf16 v[92:95], a[164:167], v[172:175], v[92:95]
    v_mfma_f32_16x16x32_bf16 v[96:99], a[168:171], v[160:163], v[96:99]
    v_mfma_f32_16x16x32_bf16 v[100:103], a[168:171], v[164:167], v[100:103]
    v_mfma_f32_16x16x32_bf16 v[104:107], a[168:171], v[168:171], v[104:107]
    ds_read_b128 v[152:155], v50 offset:4224
    v_mfma_f32_16x16x32_bf16 v[108:111], a[168:171], v[172:175], v[108:111]
    v_mfma_f32_16x16x32_bf16 v[112:115], a[172:175], v[160:163], v[112:115]
    v_mfma_f32_16x16x32_bf16 v[116:119], a[172:175], v[164:167], v[116:119]
    v_mfma_f32_16x16x32_bf16 v[120:123], a[172:175], v[168:171], v[120:123]
    ds_read_b128 v[156:159], v50 offset:4240
    v_mfma_f32_16x16x32_bf16 v[124:127], a[172:175], v[172:175], v[124:127]
    s_waitcnt vmcnt(19)
    v_mfma_f32_16x16x32_bf16 v[64:67], a[176:179], v[176:179], v[64:67]
    s_waitcnt vmcnt(18)
    v_mfma_f32_16x16x32_bf16 v[68:71], a[176:179], v[180:183], v[68:71]
    s_waitcnt vmcnt(17)
    v_mfma_f32_16x16x32_bf16 v[72:75], a[176:179], v[184:187], v[72:75]
    ds_read_b128 v[160:163], v50 offset:2048
    s_waitcnt vmcnt(16)
    v_mfma_f32_16x16x32_bf16 v[76:79], a[176:179], v[188:191], v[76:79]
    v_mfma_f32_16x16x32_bf16 v[80:83], a[180:183], v[176:179], v[80:83]
    v_mfma_f32_16x16x32_bf16 v[84:87], a[180:183], v[180:183], v[84:87]
    v_mfma_f32_16x16x32_bf16 v[88:91], a[180:183], v[184:187], v[88:91]
    ds_read_b128 v[164:167], v50 offset:2064
    v_mfma_f32_16x16x32_bf16 v[92:95], a[180:183], v[188:191], v[92:95]
    v_mfma_f32_16x16x32_bf16 v[96:99], a[184:187], v[176:179], v[96:99]
    v_mfma_f32_16x16x32_bf16 v[100:103], a[184:187], v[180:183], v[100:103]
    v_mfma_f32_16x16x32_bf16 v[104:107], a[184:187], v[184:187], v[104:107]
    ds_read_b128 v[168:171], v50 offset:2176
    v_mfma_f32_16x16x32_bf16 v[108:111], a[184:187], v[188:191], v[108:111]
    v_mfma_f32_16x16x32_bf16 v[112:115], a[188:191], v[176:179], v[112:115]
    v_mfma_f32_16x16x32_bf16 v[116:119], a[188:191], v[180:183], v[116:119]
    v_mfma_f32_16x16x32_bf16 v[120:123], a[188:191], v[184:187], v[120:123]
    ds_read_b128 v[172:175], v50 offset:2192
    v_mfma_f32_16x16x32_bf16 v[124:127], a[188:191], v[188:191], v[124:127]
    s_waitcnt vmcnt(15)
    v_mfma_f32_16x16x32_bf16 v[64:67], a[192:195], v[192:195], v[64:67]
    s_waitcnt vmcnt(14)
    v_mfma_f32_16x16x32_bf16 v[68:71], a[192:195], v[196:199], v[68:71]
    s_waitcnt vmcnt(13)
    v_mfma_f32_16x16x32_bf16 v[72:75], a[192:195], v[200:203], v[72:75]
    ds_read_b128 v[176:179], v50 offset:6144
    s_waitcnt vmcnt(12)
    v_mfma_f32_16x16x32_bf16 v[76:79], a[192:195], v[204:207], v[76:79]
    v_mfma_f32_16x16x32_bf16 v[80:83], a[196:199], v[192:195], v[80:83]
    v_mfma_f32_16x16x32_bf16 v[84:87], a[196:199], v[196:199], v[84:87]
    v_mfma_f32_16x16x32_bf16 v[88:91], a[196:199], v[200:203], v[88:91]
    ds_read_b128 v[180:183], v50 offset:6160
    v_mfma_f32_16x16x32_bf16 v[92:95], a[196:199], v[204:207], v[92:95]
    v_mfma_f32_16x16x32_bf16 v[96:99], a[200:203], v[192:195], v[96:99]
    v_mfma_f32_16x16x32_bf16 v[100:103], a[200:203], v[196:199], v[100:103]
    v_mfma_f32_16x16x32_bf16 v[104:107], a[200:203], v[200:203], v[104:107]
    ds_read_b128 v[184:187], v50 offset:6272
    v_mfma_f32_16x16x32_bf16 v[108:111], a[200:203], v[204:207], v[108:111]
    v_mfma_f32_16x16x32_bf16 v[112:115], a[204:207], v[192:195], v[112:115]
    v_mfma_f32_16x16x32_bf16 v[116:119], a[204:207], v[196:199], v[116:119]
    v_mfma_f32_16x16x32_bf16 v[120:123], a[204:207], v[200:203], v[120:123]
    ds_read_b128 v[188:191], v50 offset:6288
    v_mfma_f32_16x16x32_bf16 v[124:127], a[204:207], v[204:207], v[124:127]
    s_waitcnt vmcnt(11)
    v_mfma_f32_16x16x32_bf16 v[64:67], a[208:211], v[208:211], v[64:67]
    s_waitcnt vmcnt(10)
    v_mfma_f32_16x16x32_bf16 v[68:71], a[208:211], v[212:215], v[68:71]
    s_waitcnt vmcnt(9)
    v_mfma_f32_16x16x32_bf16 v[72:75], a[208:211], v[216:219], v[72:75]
    ds_read_b128 v[192:195], v32
    s_waitcnt vmcnt(8)
    v_mfma_f32_16x16x32_bf16 v[76:79], a[208:211], v[220:223], v[76:79]
    v_mfma_f32_16x16x32_bf16 v[80:83], a[212:215], v[208:211], v[80:83]
    v_mfma_f32_16x16x32_bf16 v[84:87], a[212:215], v[212:215], v[84:87]
    v_mfma_f32_16x16x32_bf16 v[88:91], a[212:215], v[216:219], v[88:91]
    ds_read_b128 v[196:199], v32 offset:64
    v_mfma_f32_16x16x32_bf16 v[92:95], a[212:215], v[220:223], v[92:95]
    v_mfma_f32_16x16x32_bf16 v[96:99], a[216:219], v[208:211], v[96:99]
    v_mfma_f32_16x16x32_bf16 v[100:103], a[216:219], v[212:215], v[100:103]
    v_mfma_f32_16x16x32_bf16 v[104:107], a[216:219], v[216:219], v[104:107]
    ds_read_b128 v[200:203], v51
    v_mfma_f32_16x16x32_bf16 v[108:111], a[216:219], v[220:223], v[108:111]
    v_mfma_f32_16x16x32_bf16 v[112:115], a[220:223], v[208:211], v[112:115]
    v_mfma_f32_16x16x32_bf16 v[116:119], a[220:223], v[212:215], v[116:119]
    v_mfma_f32_16x16x32_bf16 v[120:123], a[220:223], v[216:219], v[120:123]
    ds_read_b128 v[204:207], v51 offset:64
    v_mfma_f32_16x16x32_bf16 v[124:127], a[220:223], v[220:223], v[124:127]
    s_waitcnt vmcnt(7) lgkmcnt(15)
    v_mfma_f32_16x16x32_bf16 v[64:67], a[224:227], v[224:227], v[64:67]
    s_waitcnt lgkmcnt(1)
    v_lshlrev_b32 v4, 16, v200
    v_and_b32 v5, 0xffff0000, v200
    s_waitcnt vmcnt(6)
    v_mfma_f32_16x16x32_bf16 v[68:71], a[224:227], v[228:231], v[68:71]
    v_mul_f32 v208, v144, v4
    v_mul_f32 v209, v145, v5
    s_waitcnt vmcnt(5)
    v_mfma_f32_16x16x32_bf16 v[72:75], a[224:227], v[232:235], v[72:75]
    v_lshlrev_b32 v4, 16, v201
    v_and_b32 v5, 0xffff0000, v201
    s_waitcnt vmcnt(4)
    v_mfma_f32_16x16x32_bf16 v[76:79], a[224:227], v[236:239], v[76:79]
    v_mul_f32 v210, v146, v4
    v_mul_f32 v211, v147, v5
    v_mfma_f32_16x16x32_bf16 v[80:83], a[228:231], v[224:227], v[80:83]
    v_lshlrev_b32 v4, 16, v202
    v_and_b32 v5, 0xffff0000, v202
    v_mfma_f32_16x16x32_bf16 v[84:87], a[228:231], v[228:231], v[84:87]
    v_mul_f32 v212, v148, v4
    v_mul_f32 v213, v149, v5
    v_mfma_f32_16x16x32_bf16 v[88:91], a[228:231], v[232:235], v[88:91]
    v_lshlrev_b32 v4, 16, v203
    v_and_b32 v5, 0xffff0000, v203
    v_mfma_f32_16x16x32_bf16 v[92:95], a[228:231], v[236:239], v[92:95]
    v_mul_f32 v214, v150, v4
    v_mul_f32 v215, v151, v5
    v_mfma_f32_16x16x32_bf16 v[96:99], a[232:235], v[224:227], v[96:99]
    s_waitcnt lgkmcnt(0)
    v_lshlrev_b32 v4, 16, v204
    v_and_b32 v5, 0xffff0000, v204
    v_mfma_f32_16x16x32_bf16 v[100:103], a[232:235], v[228:231], v[100:103]
    v_mul_f32 v216, v152, v4
    v_mul_f32 v217, v153, v5
    v_mfma_f32_16x16x32_bf16 v[104:107], a[232:235], v[232:235], v[104:107]
    v_lshlrev_b32 v4, 16, v205
    v_and_b32 v5, 0xffff0000, v205
    v_mfma_f32_16x16x32_bf16 v[108:111], a[232:235], v[236:239], v[108:111]
    v_mul_f32 v218, v154, v4
    v_mul_f32 v219, v155, v5
    v_mfma_f32_16x16x32_bf16 v[112:115], a[236:239], v[224:227], v[112:115]
    v_lshlrev_b32 v4, 16, v206
    v_and_b32 v5, 0xffff0000, v206
    v_mfma_f32_16x16x32_bf16 v[116:119], a[236:239], v[228:231], v[116:119]
    v_mul_f32 v220, v156, v4
    v_mul_f32 v221, v157, v5
    v_mfma_f32_16x16x32_bf16 v[120:123], a[236:239], v[232:235], v[120:123]
    v_lshlrev_b32 v4, 16, v207
    v_and_b32 v5, 0xffff0000, v207
    v_mfma_f32_16x16x32_bf16 v[124:127], a[236:239], v[236:239], v[124:127]
    v_mul_f32 v222, v158, v4
    v_mul_f32 v223, v159, v5
    s_waitcnt vmcnt(3)
    v_mfma_f32_16x16x32_bf16 v[64:67], a[240:243], v[240:243], v[64:67]
    s_waitcnt vmcnt(2)
    v_mfma_f32_16x16x32_bf16 v[68:71], a[240:243], v[244:247], v[68:71]
    s_waitcnt vmcnt(1)
    v_mfma_f32_16x16x32_bf16 v[72:75], a[240:243], v[248:251], v[72:75]
    s_waitcnt vmcnt(0)
    v_mfma_f32_16x16x32_bf16 v[76:79], a[240:243], v[252:255], v[76:79]
    v_mfma_f32_16x16x32_bf16 v[80:83], a[244:247], v[240:243], v[80:83]
    v_mfma_f32_16x16x32_bf16 v[84:87], a[244:247], v[244:247], v[84:87]
    v_mfma_f32_16x16x32_bf16 v[88:91], a[244:247], v[248:251], v[88:91]
    v_mfma_f32_16x16x32_bf16 v[92:95], a[244:247], v[252:255], v[92:95]
    v_mfma_f32_16x16x32_bf16 v[96:99], a[248:251], v[240:243], v[96:99]
    v_mfma_f32_16x16x32_bf16 v[100:103], a[248:251], v[244:247], v[100:103]
    v_mfma_f32_16x16x32_bf16 v[104:107], a[248:251], v[248:251], v[104:107]
    v_mfma_f32_16x16x32_bf16 v[108:111], a[248:251], v[252:255], v[108:111]
    v_mfma_f32_16x16x32_bf16 v[112:115], a[252:255], v[240:243], v[112:115]
    v_mfma_f32_16x16x32_bf16 v[116:119], a[252:255], v[244:247], v[116:119]
    v_mfma_f32_16x16x32_bf16 v[120:123], a[252:255], v[248:251], v[120:123]
    v_mfma_f32_16x16x32_bf16 v[124:127], a[252:255], v[252:255], v[124:127]
    s_lshl_b32 s37, s36, 15
    v_and_b32 v1, 15, v0
    v_mul_u32_u24 v1, 272, v1
    v_lshrrev_b32 v2, 4, v0
    v_lshl_add_u32 v1, v2, 4, v1
    v_add_u32 v1, s37, v1
    ds_write_b128 v1, v[64:67] offset:0
    ds_write_b128 v1, v[68:71] offset:4352
    ds_write_b128 v1, v[72:75] offset:8704
    ds_write_b128 v1, v[76:79] offset:13056
    ds_write_b128 v1, v[80:83] offset:64
    ds_write_b128 v1, v[84:87] offset:4416
    ds_write_b128 v1, v[88:91] offset:8768
    ds_write_b128 v1, v[92:95] offset:13120
    ds_write_b128 v1, v[96:99] offset:128
    ds_write_b128 v1, v[100:103] offset:4480
    ds_write_b128 v1, v[104:107] offset:8832
    ds_write_b128 v1, v[108:111] offset:13184
    ds_write_b128 v1, v[112:115] offset:192
    ds_write_b128 v1, v[116:119] offset:4544
    ds_write_b128 v1, v[120:123] offset:8896
    ds_write_b128 v1, v[124:127] offset:13248
    v_mul_u32_u24 v1, 272, v46
    v_lshl_add_u32 v1, v48, 5, v1
    v_add_u32 v2, 0x10000, v1
    s_mov_b32 s52, 0x3b000000
    s_mov_b32 s53, 0x3727c5ac
    s_mov_b32 s54, 0xffff0000
    s_waitcnt lgkmcnt(0)
    s_barrier
    ds_read_b128 v[64:67], v1 offset:0
    ds_read_b128 v[68:71], v1 offset:16
    ds_read_b128 v[72:75], v1 offset:128
    ds_read_b128 v[76:79], v1 offset:144
    ds_read_b128 v[80:83], v1 offset:32768
    ds_read_b128 v[84:87], v1 offset:32784
    ds_read_b128 v[88:91], v1 offset:32896
    ds_read_b128 v[92:95], v1 offset:32912
    ds_read_b128 v[96:99], v2 offset:0
    ds_read_b128 v[100:103], v2 offset:16
    ds_read_b128 v[104:107], v2 offset:128
    ds_read_b128 v[108:111], v2 offset:144
    ds_read_b128 v[112:115], v2 offset:32768
    ds_read_b128 v[116:119], v2 offset:32784
    ds_read_b128 v[120:123], v2 offset:32896
    ds_read_b128 v[124:127], v2 offset:32912
    s_waitcnt lgkmcnt(11)
    v_add_f32 v64, v64, v80
    s_waitcnt lgkmcnt(3)
    v_add_f32 v96, v96, v112
    v_add_f32 v65, v65, v81
    v_add_f32 v97, v97, v113
    v_add_f32 v66, v66, v82
    v_add_f32 v98, v98, v114
    v_add_f32 v67, v67, v83
    v_add_f32 v99, v99, v115
    v_add_f32 v68, v68, v84
    s_waitcnt lgkmcnt(2)
    v_add_f32 v100, v100, v116
    v_add_f32 v69, v69, v85
    v_add_f32 v101, v101, v117
    v_add_f32 v70, v70, v86
    v_add_f32 v102, v102, v118
    v_add_f32 v71, v71, v87
    v_add_f32 v103, v103, v119
    v_add_f32 v72, v72, v88
    s_waitcnt lgkmcnt(1)
    v_add_f32 v104, v104, v120
    v_add_f32 v73, v73, v89
    v_add_f32 v105, v105, v121
    v_add_f32 v74, v74, v90
    v_add_f32 v106, v106, v122
    v_add_f32 v75, v75, v91
    v_add_f32 v107, v107, v123
    v_add_f32 v76, v76, v92
    s_waitcnt lgkmcnt(0)
    v_add_f32 v108, v108, v124
    v_add_f32 v77, v77, v93
    v_add_f32 v109, v109, v125
    v_add_f32 v78, v78, v94
    v_add_f32 v110, v110, v126
    v_add_f32 v79, v79, v95
    v_add_f32 v111, v111, v127
    v_add_f32 v64, v64, v96
    v_add_f32 v65, v65, v97
    v_add_f32 v66, v66, v98
    v_add_f32 v67, v67, v99
    v_add_f32 v68, v68, v100
    v_add_f32 v69, v69, v101
    v_add_f32 v70, v70, v102
    v_add_f32 v71, v71, v103
    v_add_f32 v72, v72, v104
    v_add_f32 v73, v73, v105
    v_add_f32 v74, v74, v106
    v_add_f32 v75, v75, v107
    v_add_f32 v76, v76, v108
    v_add_f32 v77, v77, v109
    v_add_f32 v78, v78, v110
    v_add_f32 v79, v79, v111
    v_mov_b32 v6, 0
    v_mov_b32 v7, 0
    v_mov_b32 v8, 0
    v_cvt_pk_bf16_f32 v64, v64, v65
    v_lshlrev_b32 v4, 16, v64
    v_and_b32 v5, 0xffff0000, v64
    v_mul_f32 v4, v4, v128
    v_mul_f32 v5, v5, v129
    v_cvt_pk_bf16_f32 v64, v4, v5
    v_lshlrev_b32 v4, 16, v64
    v_and_b32 v5, 0xffff0000, v64
    v_lshlrev_b32 v64, 16, v192
    v_and_b32 v65, 0xffff0000, v192
    v_add_f32 v4, v4, v64
    v_add_f32 v5, v5, v65
    v_cvt_pk_bf16_f32 v80, v4, v5
    v_lshlrev_b32 v224, 16, v80
    v_and_b32 v225, 0xffff0000, v80
    v_add_f32 v6, v6, v224
    v_fmac_f32 v7, v224, v224
    v_fmac_f32 v8, v224, v208
    v_add_f32 v6, v6, v225
    v_fmac_f32 v7, v225, v225
    v_fmac_f32 v8, v225, v209
    v_cvt_pk_bf16_f32 v66, v66, v67
    v_lshlrev_b32 v4, 16, v66
    v_and_b32 v5, 0xffff0000, v66
    v_mul_f32 v4, v4, v130
    v_mul_f32 v5, v5, v131
    v_cvt_pk_bf16_f32 v66, v4, v5
    v_lshlrev_b32 v4, 16, v66
    v_and_b32 v5, 0xffff0000, v66
    v_lshlrev_b32 v66, 16, v193
    v_and_b32 v67, 0xffff0000, v193
    v_add_f32 v4, v4, v66
    v_add_f32 v5, v5, v67
    v_cvt_pk_bf16_f32 v81, v4, v5
    v_lshlrev_b32 v226, 16, v81
    v_and_b32 v227, 0xffff0000, v81
    v_add_f32 v6, v6, v226
    v_fmac_f32 v7, v226, v226
    v_fmac_f32 v8, v226, v210
    v_add_f32 v6, v6, v227
    v_fmac_f32 v7, v227, v227
    v_fmac_f32 v8, v227, v211
    v_cvt_pk_bf16_f32 v68, v68, v69
    v_lshlrev_b32 v4, 16, v68
    v_and_b32 v5, 0xffff0000, v68
    v_mul_f32 v4, v4, v132
    v_mul_f32 v5, v5, v133
    v_cvt_pk_bf16_f32 v68, v4, v5
    v_lshlrev_b32 v4, 16, v68
    v_and_b32 v5, 0xffff0000, v68
    v_lshlrev_b32 v68, 16, v194
    v_and_b32 v69, 0xffff0000, v194
    v_add_f32 v4, v4, v68
    v_add_f32 v5, v5, v69
    v_cvt_pk_bf16_f32 v82, v4, v5
    v_lshlrev_b32 v228, 16, v82
    v_and_b32 v229, 0xffff0000, v82
    v_add_f32 v6, v6, v228
    v_fmac_f32 v7, v228, v228
    v_fmac_f32 v8, v228, v212
    v_add_f32 v6, v6, v229
    v_fmac_f32 v7, v229, v229
    v_fmac_f32 v8, v229, v213
    v_cvt_pk_bf16_f32 v70, v70, v71
    v_lshlrev_b32 v4, 16, v70
    v_and_b32 v5, 0xffff0000, v70
    v_mul_f32 v4, v4, v134
    v_mul_f32 v5, v5, v135
    v_cvt_pk_bf16_f32 v70, v4, v5
    v_lshlrev_b32 v4, 16, v70
    v_and_b32 v5, 0xffff0000, v70
    v_lshlrev_b32 v70, 16, v195
    v_and_b32 v71, 0xffff0000, v195
    v_add_f32 v4, v4, v70
    v_add_f32 v5, v5, v71
    v_cvt_pk_bf16_f32 v83, v4, v5
    v_lshlrev_b32 v230, 16, v83
    v_and_b32 v231, 0xffff0000, v83
    v_add_f32 v6, v6, v230
    v_fmac_f32 v7, v230, v230
    v_fmac_f32 v8, v230, v214
    buffer_store_dwordx4 v[80:83], v49, s[24:27], s46 offen sc1
    v_add_f32 v6, v6, v231
    v_fmac_f32 v7, v231, v231
    v_fmac_f32 v8, v231, v215
    v_cvt_pk_bf16_f32 v72, v72, v73
    v_lshlrev_b32 v4, 16, v72
    v_and_b32 v5, 0xffff0000, v72
    v_mul_f32 v4, v4, v136
    v_mul_f32 v5, v5, v137
    v_cvt_pk_bf16_f32 v72, v4, v5
    v_lshlrev_b32 v4, 16, v72
    v_and_b32 v5, 0xffff0000, v72
    v_lshlrev_b32 v72, 16, v196
    v_and_b32 v73, 0xffff0000, v196
    v_add_f32 v4, v4, v72
    v_add_f32 v5, v5, v73
    v_cvt_pk_bf16_f32 v84, v4, v5
    v_lshlrev_b32 v232, 16, v84
    v_and_b32 v233, 0xffff0000, v84
    v_add_f32 v6, v6, v232
    v_fmac_f32 v7, v232, v232
    v_fmac_f32 v8, v232, v216
    v_add_f32 v6, v6, v233
    v_fmac_f32 v7, v233, v233
    v_fmac_f32 v8, v233, v217
    v_cvt_pk_bf16_f32 v74, v74, v75
    v_lshlrev_b32 v4, 16, v74
    v_and_b32 v5, 0xffff0000, v74
    v_mul_f32 v4, v4, v138
    v_mul_f32 v5, v5, v139
    v_cvt_pk_bf16_f32 v74, v4, v5
    v_lshlrev_b32 v4, 16, v74
    v_and_b32 v5, 0xffff0000, v74
    v_lshlrev_b32 v74, 16, v197
    v_and_b32 v75, 0xffff0000, v197
    v_add_f32 v4, v4, v74
    v_add_f32 v5, v5, v75
    v_cvt_pk_bf16_f32 v85, v4, v5
    v_lshlrev_b32 v234, 16, v85
    v_and_b32 v235, 0xffff0000, v85
    v_add_f32 v6, v6, v234
    v_fmac_f32 v7, v234, v234
    v_fmac_f32 v8, v234, v218
    v_add_f32 v6, v6, v235
    v_fmac_f32 v7, v235, v235
    v_fmac_f32 v8, v235, v219
    v_cvt_pk_bf16_f32 v76, v76, v77
    v_lshlrev_b32 v4, 16, v76
    v_and_b32 v5, 0xffff0000, v76
    v_mul_f32 v4, v4, v140
    v_mul_f32 v5, v5, v141
    v_cvt_pk_bf16_f32 v76, v4, v5
    v_lshlrev_b32 v4, 16, v76
    v_and_b32 v5, 0xffff0000, v76
    v_lshlrev_b32 v76, 16, v198
    v_and_b32 v77, 0xffff0000, v198
    v_add_f32 v4, v4, v76
    v_add_f32 v5, v5, v77
    v_cvt_pk_bf16_f32 v86, v4, v5
    v_lshlrev_b32 v236, 16, v86
    v_and_b32 v237, 0xffff0000, v86
    v_add_f32 v6, v6, v236
    v_fmac_f32 v7, v236, v236
    v_fmac_f32 v8, v236, v220
    v_add_f32 v6, v6, v237
    v_fmac_f32 v7, v237, v237
    v_fmac_f32 v8, v237, v221
    v_cvt_pk_bf16_f32 v78, v78, v79
    v_lshlrev_b32 v4, 16, v78
    v_and_b32 v5, 0xffff0000, v78
    v_mul_f32 v4, v4, v142
    v_mul_f32 v5, v5, v143
    v_cvt_pk_bf16_f32 v78, v4, v5
    v_lshlrev_b32 v4, 16, v78
    v_and_b32 v5, 0xffff0000, v78
    v_lshlrev_b32 v78, 16, v199
    v_and_b32 v79, 0xffff0000, v199
    v_add_f32 v4, v4, v78
    v_add_f32 v5, v5, v79
    v_cvt_pk_bf16_f32 v87, v4, v5
    v_lshlrev_b32 v238, 16, v87
    v_and_b32 v239, 0xffff0000, v87
    v_add_f32 v6, v6, v238
    v_fmac_f32 v7, v238, v238
    v_fmac_f32 v8, v238, v222
    buffer_store_dwordx4 v[84:87], v49, s[24:27], s46 offen offset:64 sc1
    v_add_f32 v6, v6, v239
    v_fmac_f32 v7, v239, v239
    v_fmac_f32 v8, v239, v223
    v_add_f32_dpp v6, v6, v6 quad_perm:[1,0,3,2] row_mask:0xf bank_mask:0xf
    v_add_f32_dpp v7, v7, v7 quad_perm:[1,0,3,2] row_mask:0xf bank_mask:0xf
    v_add_f32_dpp v8, v8, v8 quad_perm:[1,0,3,2] row_mask:0xf bank_mask:0xf
    v_add_f32_dpp v6, v6, v6 quad_perm:[2,3,0,1] row_mask:0xf bank_mask:0xf
    v_add_f32_dpp v7, v7, v7 quad_perm:[2,3,0,1] row_mask:0xf bank_mask:0xf
    v_add_f32_dpp v8, v8, v8 quad_perm:[2,3,0,1] row_mask:0xf bank_mask:0xf
    v_cmp_eq_u32 vcc, 1, v48
    s_nop 1
    v_cndmask_b32 v6, v6, v7, vcc
    v_cmp_eq_u32 vcc, 2, v48
    s_nop 1
    v_cndmask_b32 v6, v6, v8, vcc
    v_lshlrev_b32 v1, 13, v48
    v_lshl_add_u32 v1, v46, 2, v1
    s_lshl_b32 s47, s38, 8
    s_add_u32 s47, s47, 16384
    v_cmp_gt_u32 vcc, 3, v48
    s_and_saveexec_b64 s[50:51], vcc
    buffer_atomic_add_f32 v6, v1, s[32:35], s47 offen
    s_mov_b64 exec, s[50:51]
    v_add_f32_dpp v58, v58, v58 row_ror:8 row_mask:0xf bank_mask:0xf
    s_nop 1
    v_add_f32_dpp v58, v58, v58 row_ror:4 row_mask:0xf bank_mask:0xf
    s_nop 1
    v_add_f32_dpp v58, v58, v58 row_ror:2 row_mask:0xf bank_mask:0xf
    s_nop 1
    v_add_f32_dpp v58, v58, v58 row_ror:1 row_mask:0xf bank_mask:0xf
    s_nop 0
    v_readlane_b32 s71, v58, 0
    v_readlane_b32 s48, v58, 16
    v_lshlrev_b32 v10, 5, v34
    v_lshlrev_b32 v11, 2, v46
    v_mul_u32_u24 v35, 7168, v34
    s_mov_b32 s12, s64
    s_mov_b32 s13, s65
    s_mov_b32 s14, 1835008
    s_mov_b32 s15, 0x20000
    s_mov_b32 s16, s66
    s_mov_b32 s17, s67
    s_mov_b32 s18, 1835008
    s_mov_b32 s19, 0x20000
    s_cmp_eq_u32 s36, 0
    s_cbranch_scc1 L4_w0
    buffer_load_dwordx4 v[16:19], v35, s[12:15], s3 offen offset:0
    buffer_load_dwordx4 v[20:23], v35, s[12:15], s3 offen offset:3584
    buffer_load_dwordx4 v[24:27], v35, s[16:19], s3 offen offset:0
    buffer_load_dwordx4 v[28:31], v35, s[16:19], s3 offen offset:3584
    s_waitcnt vmcnt(4)
    s_branch L4_w1
L4_w0:
    s_waitcnt vmcnt(0)
L4_w1:
    s_barrier
    s_mov_b32 s51, 0
    s_cmp_lg_u32 s36, 0
    s_cbranch_scc1 L4_ns
    s_mov_b64 exec, 1
    s_lshl_b32 s42, s40, 7
    s_add_u32 s42, s42, 46080
    v_mov_b32 v4, 1
    buffer_atomic_add v4, v40, s[32:35], s42 offen sc0
    s_lshl_b32 s44, s40, 10
    s_add_u32 s42, s44, 16384
    s_add_u32 s45, s42, 8192
    s_add_u32 s49, s42, 16384
    s_waitcnt vmcnt(0)
    v_readfirstlane_b32 s43, v4
    s_mov_b64 exec, -1
    s_cmp_eq_u32 s43, 31
    s_cbranch_scc1 L4_last
    buffer_load_dwordx4 v[16:19], v35, s[12:15], s3 offen offset:0
    buffer_load_dwordx4 v[20:23], v35, s[12:15], s3 offen offset:3584
    buffer_load_dwordx4 v[24:27], v35, s[16:19], s3 offen offset:0
    buffer_load_dwordx4 v[28:31], v35, s[16:19], s3 offen offset:3584
    s_branch L4_nl
L4_last:
    s_mov_b32 s51, 1
    buffer_load_dwordx4 v[64:67], v47, s[32:35], s42 offen sc1
    buffer_load_dwordx4 v[68:71], v47, s[32:35], s45 offen sc1
    buffer_load_dwordx4 v[72:75], v47, s[32:35], s49 offen sc1
    s_lshr_b32 s44, s44, 2
    v_lshlrev_b32 v1, 2, v0
    v_add_u32 v1, s44, v1
    v_mov_b32 v2, s71
    s_waitcnt vmcnt(2)
    v_mul_f32 v104, s52, v64
    v_mul_f32 v105, s52, v65
    v_mul_f32 v106, s52, v66
    v_mul_f32 v107, s52, v67
    v_mul_f32 v120, v104, v104
    v_mul_f32 v121, v105, v105
    v_mul_f32 v122, v106, v106
    v_mul_f32 v123, v107, v107
    v_cvt_pk_bf16_f32 v104, v104, v104
    v_cvt_pk_bf16_f32 v105, v105, v105
    v_cvt_pk_bf16_f32 v106, v106, v106
    v_cvt_pk_bf16_f32 v107, v107, v107
    v_and_b32 v104, s54, v104
    v_and_b32 v105, s54, v105
    v_and_b32 v106, s54, v106
    v_and_b32 v107, s54, v107
    s_waitcnt vmcnt(1)
    v_fma_f32 v112, v68, s52, -v120
    v_fma_f32 v113, v69, s52, -v121
    v_fma_f32 v114, v70, s52, -v122
    v_fma_f32 v115, v71, s52, -v123
    v_max_f32 v112, 0, v112
    v_max_f32 v113, 0, v113
    v_max_f32 v114, 0, v114
    v_max_f32 v115, 0, v115
    v_cvt_pk_bf16_f32 v112, v112, v112
    v_cvt_pk_bf16_f32 v113, v113, v113
    v_cvt_pk_bf16_f32 v114, v114, v114
    v_cvt_pk_bf16_f32 v115, v115, v115
    v_and_b32 v112, s54, v112
    v_and_b32 v113, s54, v113
    v_and_b32 v114, s54, v114
    v_and_b32 v115, s54, v115
    v_add_f32 v112, s53, v112
    v_add_f32 v113, s53, v113
    v_add_f32 v114, s53, v114
    v_add_f32 v115, s53, v115
    v_cvt_pk_bf16_f32 v112, v112, v112
    v_cvt_pk_bf16_f32 v113, v113, v113
    v_cvt_pk_bf16_f32 v114, v114, v114
    v_cvt_pk_bf16_f32 v115, v115, v115
    v_and_b32 v112, s54, v112
    v_and_b32 v113, s54, v113
    v_and_b32 v114, s54, v114
    v_and_b32 v115, s54, v115
    v_sqrt_f32 v112, v112
    v_sqrt_f32 v113, v113
    v_sqrt_f32 v114, v114
    v_sqrt_f32 v115, v115
    v_cvt_pk_bf16_f32 v112, v112, v112
    v_cvt_pk_bf16_f32 v113, v113, v113
    v_cvt_pk_bf16_f32 v114, v114, v114
    v_cvt_pk_bf16_f32 v115, v115, v115
    v_and_b32 v112, s54, v112
    v_and_b32 v113, s54, v113
    v_and_b32 v114, s54, v114
    v_and_b32 v115, s54, v115
    v_rcp_f32 v112, v112
    v_rcp_f32 v113, v113
    v_rcp_f32 v114, v114
    v_rcp_f32 v115, v115
    s_waitcnt vmcnt(0)
    v_fma_f32 v120, -v104, s48, v72
    v_fma_f32 v121, -v105, s48, v73
    v_fma_f32 v122, -v106, s48, v74
    v_fma_f32 v123, -v107, s48, v75
    v_fma_f32 v120, v120, v112, v2
    v_fma_f32 v121, v121, v113, v2
    v_fma_f32 v122, v122, v114, v2
    v_fma_f32 v123, v123, v115, v2
    v_ashrrev_i32 v104, 31, v120
    v_ashrrev_i32 v105, 31, v121
    v_ashrrev_i32 v106, 31, v122
    v_ashrrev_i32 v107, 31, v123
    v_sub_u32 v112, 2047, v1
    v_sub_u32 v113, 2046, v1
    v_sub_u32 v114, 2045, v1
    v_sub_u32 v115, 2044, v1
    s_mov_b32 s42, 0x80000000
    s_mov_b32 s43, 0xfffff800
    v_bitop3_b32 v120, v120, v104, s42 bitop3:0x1e
    v_bitop3_b32 v121, v121, v105, s42 bitop3:0x1e
    v_bitop3_b32 v122, v122, v106, s42 bitop3:0x1e
    v_bitop3_b32 v123, v123, v107, s42 bitop3:0x1e
    v_bfi_b32 v120, s43, v120, v112
    v_bfi_b32 v121, s43, v121, v113
    v_bfi_b32 v122, s43, v122, v114
    v_bfi_b32 v123, s43, v123, v115
    v_max3_u32 v8, v120, v121, v122
    v_max3_u32 v8, v8, v123, 1
    s_nop 1
    v_max_u32_dpp v8, v8, v8 row_ror:8 row_mask:0xf bank_mask:0xf
    s_nop 1
    v_max_u32_dpp v8, v8, v8 row_ror:4 row_mask:0xf bank_mask:0xf
    s_nop 1
    v_max_u32_dpp v8, v8, v8 row_ror:2 row_mask:0xf bank_mask:0xf
    s_nop 1
    v_max_u32_dpp v8, v8, v8 row_ror:1 row_mask:0xf bank_mask:0xf
    v_mov_b32 v9, v8
    s_nop 1
    v_permlane16_swap_b32 v9, v8
    v_max_u32 v8, v9, v8
    v_mov_b32 v9, v8
    s_nop 1
    v_permlane32_swap_b32 v9, v8
    v_max_u32 v8, v9, v8
    s_lshl_b32 s42, s40, 2
    s_add_u32 s42, s42, 41984
    v_lshlrev_b32 v9, 7, v0
    s_mov_b64 exec, 255
    buffer_store_dword v8, v9, s[32:35], s42 offen sc1
    s_mov_b64 exec, -1
L4_nl:
    v_and_b32 v9, 7, v0
    v_lshlrev_b32 v9, 2, v9
    s_and_b32 s42, s2, 7
    s_lshl_b32 s42, s42, 7
    s_add_u32 s42, s42, 41984
    s_mov_b32 s70, 0
L4_poll:
    buffer_load_dword v8, v9, s[32:35], s42 offen sc1
    s_waitcnt vmcnt(0)
    v_cmp_eq_u32 vcc, 0, v8
    s_add_u32 s70, s70, 1
    s_cmp_gt_u32 s70, 0x8000
    s_cbranch_scc1 L4_px
    s_cbranch_vccz L4_px
    s_sleep 1
    s_branch L4_poll
L4_px:
    v_max_u32_dpp v8, v8, v8 row_ror:8 row_mask:0xf bank_mask:0xf
    s_nop 1
    v_max_u32_dpp v8, v8, v8 row_ror:4 row_mask:0xf bank_mask:0xf
    s_nop 1
    v_max_u32_dpp v8, v8, v8 row_ror:2 row_mask:0xf bank_mask:0xf
    s_nop 1
    v_max_u32_dpp v8, v8, v8 row_ror:1 row_mask:0xf bank_mask:0xf
    ds_write_b32 v40, v8
    s_waitcnt lgkmcnt(0)
L4_ns:
    s_barrier
    ds_read_b32 v4, v40
    s_add_u32 s43, s47, 8192
    s_waitcnt lgkmcnt(0)
    v_readfirstlane_b32 s49, v4
    s_and_b32 s50, s49, 0x7ff
    s_sub_u32 s50, 2047, s50
    v_lshlrev_b32 v1, 2, v34
    s_lshl_b32 s42, s50, 10
    buffer_load_dword v62, v1, s[24:27], s42 offen sc1
    s_lshl_b32 s42, s50, 2
    s_add_u32 s42, s42, 16384
    s_add_u32 s43, s42, 8192
    buffer_load_dword v63, v40, s[32:35], s42 offen sc1
    buffer_load_dword v59, v40, s[32:35], s43 offen sc1
    s_add_u32 s43, s47, 8192
    buffer_load_dword v60, v11, s[32:35], s47 offen sc1
    buffer_load_dword v61, v11, s[32:35], s43 offen sc1
    s_cmp_eq_u32 s51, 0
    s_cbranch_scc1 L4_gu
    s_waitcnt vmcnt(8)
    buffer_load_dwordx4 v[16:19], v35, s[12:15], s3 offen offset:0
    s_waitcnt vmcnt(8)
    buffer_load_dwordx4 v[20:23], v35, s[12:15], s3 offen offset:3584
    s_waitcnt vmcnt(8)
    buffer_load_dwordx4 v[24:27], v35, s[16:19], s3 offen offset:0
    s_waitcnt vmcnt(8)
    buffer_load_dwordx4 v[28:31], v35, s[16:19], s3 offen offset:3584
L4_gu:
    v_add_u32 v3, 147456, v1
    ds_read_b32 v96, v3 offset:0
    ds_read_b32 v97, v3 offset:1024
    ds_read_b32 v98, v3 offset:2048
    ds_read_b32 v99, v3 offset:3072
    ds_read_b32 v100, v3 offset:4096
    ds_read_b32 v101, v3 offset:5120
    ds_read_b32 v102, v3 offset:6144
    ds_read_b32 v103, v3 offset:7168
    s_cmp_lt_u32 s2, 224
    s_cbranch_scc1 L4_mlp
    s_mov_b32 s20, s62
    s_mov_b32 s21, s63
    s_mov_b32 s22, 2097152
    s_mov_b32 s23, 0x20000
    s_waitcnt vmcnt(1)
    v_mul_f32 v4, s52, v60
    v_mul_f32 v6, v4, v4
    s_waitcnt vmcnt(0)
    v_fma_f32 v5, v61, s52, -v6
    v_max_f32 v5, 0, v5
    v_cvt_pk_bf16_f32 v5, v5, v5
    v_and_b32 v5, 0xffff0000, v5
    v_add_f32 v5, s53, v5
    v_cvt_pk_bf16_f32 v5, v5, v5
    v_and_b32 v5, 0xffff0000, v5
    v_sqrt_f32 v5, v5
    s_nop 0
    v_cvt_pk_bf16_f32 v5, v5, v5
    v_and_b32 v5, 0xffff0000, v5
    v_rcp_f32 v5, v5
    v_cvt_pk_bf16_f32 v4, v4, v4
    v_and_b32 v4, 0xffff0000, v4
    v_sub_f32 v6, v224, v4
    v_sub_f32 v7, v225, v4
    v_cvt_pk_bf16_f32 v6, v6, v7
    v_and_b32 v7, s54, v6
    v_lshlrev_b32 v6, 16, v6
    v_mul_f32 v6, v6, v5
    v_mul_f32 v7, v7, v5
    v_cvt_pk_bf16_f32 v6, v6, v7
    v_and_b32 v7, s54, v6
    v_lshlrev_b32 v6, 16, v6
    v_mul_f32 v6, v6, v144
    v_mul_f32 v7, v7, v145
    v_cvt_pk_bf16_f32 v6, v6, v7
    v_and_b32 v7, s54, v6
    v_lshlrev_b32 v6, 16, v6
    v_add_f32 v6, v6, v160
    v_add_f32 v7, v7, v161
    v_cvt_pk_bf16_f32 v6, v6, v7
    v_and_b32 v7, s54, v6
    v_lshlrev_b32 v6, 16, v6
    v_mul_f32 v6, v6, v176
    v_mul_f32 v7, v7, v177
    v_cvt_pk_bf16_f32 v6, v6, v7
    v_and_b32 v7, s54, v6
    v_lshlrev_b32 v6, 16, v6
    v_add_f32 v6, v6, v224
    v_add_f32 v7, v7, v225
    v_cvt_pk_bf16_f32 v64, v6, v7
    v_sub_f32 v6, v226, v4
    v_sub_f32 v7, v227, v4
    v_cvt_pk_bf16_f32 v6, v6, v7
    v_and_b32 v7, s54, v6
    v_lshlrev_b32 v6, 16, v6
    v_mul_f32 v6, v6, v5
    v_mul_f32 v7, v7, v5
    v_cvt_pk_bf16_f32 v6, v6, v7
    v_and_b32 v7, s54, v6
    v_lshlrev_b32 v6, 16, v6
    v_mul_f32 v6, v6, v146
    v_mul_f32 v7, v7, v147
    v_cvt_pk_bf16_f32 v6, v6, v7
    v_and_b32 v7, s54, v6
    v_lshlrev_b32 v6, 16, v6
    v_add_f32 v6, v6, v162
    v_add_f32 v7, v7, v163
    v_cvt_pk_bf16_f32 v6, v6, v7
    v_and_b32 v7, s54, v6
    v_lshlrev_b32 v6, 16, v6
    v_mul_f32 v6, v6, v178
    v_mul_f32 v7, v7, v179
    v_cvt_pk_bf16_f32 v6, v6, v7
    v_and_b32 v7, s54, v6
    v_lshlrev_b32 v6, 16, v6
    v_add_f32 v6, v6, v226
    v_add_f32 v7, v7, v227
    v_cvt_pk_bf16_f32 v65, v6, v7
    v_sub_f32 v6, v228, v4
    v_sub_f32 v7, v229, v4
    v_cvt_pk_bf16_f32 v6, v6, v7
    v_and_b32 v7, s54, v6
    v_lshlrev_b32 v6, 16, v6
    v_mul_f32 v6, v6, v5
    v_mul_f32 v7, v7, v5
    v_cvt_pk_bf16_f32 v6, v6, v7
    v_and_b32 v7, s54, v6
    v_lshlrev_b32 v6, 16, v6
    v_mul_f32 v6, v6, v148
    v_mul_f32 v7, v7, v149
    v_cvt_pk_bf16_f32 v6, v6, v7
    v_and_b32 v7, s54, v6
    v_lshlrev_b32 v6, 16, v6
    v_add_f32 v6, v6, v164
    v_add_f32 v7, v7, v165
    v_cvt_pk_bf16_f32 v6, v6, v7
    v_and_b32 v7, s54, v6
    v_lshlrev_b32 v6, 16, v6
    v_mul_f32 v6, v6, v180
    v_mul_f32 v7, v7, v181
    v_cvt_pk_bf16_f32 v6, v6, v7
    v_and_b32 v7, s54, v6
    v_lshlrev_b32 v6, 16, v6
    v_add_f32 v6, v6, v228
    v_add_f32 v7, v7, v229
    v_cvt_pk_bf16_f32 v66, v6, v7
    v_sub_f32 v6, v230, v4
    v_sub_f32 v7, v231, v4
    v_cvt_pk_bf16_f32 v6, v6, v7
    v_and_b32 v7, s54, v6
    v_lshlrev_b32 v6, 16, v6
    v_mul_f32 v6, v6, v5
    v_mul_f32 v7, v7, v5
    v_cvt_pk_bf16_f32 v6, v6, v7
    v_and_b32 v7, s54, v6
    v_lshlrev_b32 v6, 16, v6
    v_mul_f32 v6, v6, v150
    v_mul_f32 v7, v7, v151
    v_cvt_pk_bf16_f32 v6, v6, v7
    v_and_b32 v7, s54, v6
    v_lshlrev_b32 v6, 16, v6
    v_add_f32 v6, v6, v166
    v_add_f32 v7, v7, v167
    v_cvt_pk_bf16_f32 v6, v6, v7
    v_and_b32 v7, s54, v6
    v_lshlrev_b32 v6, 16, v6
    v_mul_f32 v6, v6, v182
    v_mul_f32 v7, v7, v183
    v_cvt_pk_bf16_f32 v6, v6, v7
    v_and_b32 v7, s54, v6
    v_lshlrev_b32 v6, 16, v6
    v_add_f32 v6, v6, v230
    v_add_f32 v7, v7, v231
    v_cvt_pk_bf16_f32 v67, v6, v7
    v_sub_f32 v6, v232, v4
    v_sub_f32 v7, v233, v4
    v_cvt_pk_bf16_f32 v6, v6, v7
    v_and_b32 v7, s54, v6
    v_lshlrev_b32 v6, 16, v6
    v_mul_f32 v6, v6, v5
    v_mul_f32 v7, v7, v5
    v_cvt_pk_bf16_f32 v6, v6, v7
    v_and_b32 v7, s54, v6
    v_lshlrev_b32 v6, 16, v6
    v_mul_f32 v6, v6, v152
    v_mul_f32 v7, v7, v153
    v_cvt_pk_bf16_f32 v6, v6, v7
    v_and_b32 v7, s54, v6
    v_lshlrev_b32 v6, 16, v6
    v_add_f32 v6, v6, v168
    v_add_f32 v7, v7, v169
    v_cvt_pk_bf16_f32 v6, v6, v7
    v_and_b32 v7, s54, v6
    v_lshlrev_b32 v6, 16, v6
    v_mul_f32 v6, v6, v184
    v_mul_f32 v7, v7, v185
    v_cvt_pk_bf16_f32 v6, v6, v7
    v_and_b32 v7, s54, v6
    v_lshlrev_b32 v6, 16, v6
    v_add_f32 v6, v6, v232
    v_add_f32 v7, v7, v233
    v_cvt_pk_bf16_f32 v68, v6, v7
    v_sub_f32 v6, v234, v4
    v_sub_f32 v7, v235, v4
    v_cvt_pk_bf16_f32 v6, v6, v7
    v_and_b32 v7, s54, v6
    v_lshlrev_b32 v6, 16, v6
    v_mul_f32 v6, v6, v5
    v_mul_f32 v7, v7, v5
    v_cvt_pk_bf16_f32 v6, v6, v7
    v_and_b32 v7, s54, v6
    v_lshlrev_b32 v6, 16, v6
    v_mul_f32 v6, v6, v154
    v_mul_f32 v7, v7, v155
    v_cvt_pk_bf16_f32 v6, v6, v7
    v_and_b32 v7, s54, v6
    v_lshlrev_b32 v6, 16, v6
    v_add_f32 v6, v6, v170
    v_add_f32 v7, v7, v171
    v_cvt_pk_bf16_f32 v6, v6, v7
    v_and_b32 v7, s54, v6
    v_lshlrev_b32 v6, 16, v6
    v_mul_f32 v6, v6, v186
    v_mul_f32 v7, v7, v187
    v_cvt_pk_bf16_f32 v6, v6, v7
    v_and_b32 v7, s54, v6
    v_lshlrev_b32 v6, 16, v6
    v_add_f32 v6, v6, v234
    v_add_f32 v7, v7, v235
    v_cvt_pk_bf16_f32 v69, v6, v7
    v_sub_f32 v6, v236, v4
    v_sub_f32 v7, v237, v4
    v_cvt_pk_bf16_f32 v6, v6, v7
    v_and_b32 v7, s54, v6
    v_lshlrev_b32 v6, 16, v6
    v_mul_f32 v6, v6, v5
    v_mul_f32 v7, v7, v5
    v_cvt_pk_bf16_f32 v6, v6, v7
    v_and_b32 v7, s54, v6
    v_lshlrev_b32 v6, 16, v6
    v_mul_f32 v6, v6, v156
    v_mul_f32 v7, v7, v157
    v_cvt_pk_bf16_f32 v6, v6, v7
    v_and_b32 v7, s54, v6
    v_lshlrev_b32 v6, 16, v6
    v_add_f32 v6, v6, v172
    v_add_f32 v7, v7, v173
    v_cvt_pk_bf16_f32 v6, v6, v7
    v_and_b32 v7, s54, v6
    v_lshlrev_b32 v6, 16, v6
    v_mul_f32 v6, v6, v188
    v_mul_f32 v7, v7, v189
    v_cvt_pk_bf16_f32 v6, v6, v7
    v_and_b32 v7, s54, v6
    v_lshlrev_b32 v6, 16, v6
    v_add_f32 v6, v6, v236
    v_add_f32 v7, v7, v237
    v_cvt_pk_bf16_f32 v70, v6, v7
    v_sub_f32 v6, v238, v4
    v_sub_f32 v7, v239, v4
    v_cvt_pk_bf16_f32 v6, v6, v7
    v_and_b32 v7, s54, v6
    v_lshlrev_b32 v6, 16, v6
    v_mul_f32 v6, v6, v5
    v_mul_f32 v7, v7, v5
    v_cvt_pk_bf16_f32 v6, v6, v7
    v_and_b32 v7, s54, v6
    v_lshlrev_b32 v6, 16, v6
    v_mul_f32 v6, v6, v158
    v_mul_f32 v7, v7, v159
    v_cvt_pk_bf16_f32 v6, v6, v7
    v_and_b32 v7, s54, v6
    v_lshlrev_b32 v6, 16, v6
    v_add_f32 v6, v6, v174
    v_add_f32 v7, v7, v175
    v_cvt_pk_bf16_f32 v6, v6, v7
    v_and_b32 v7, s54, v6
    v_lshlrev_b32 v6, 16, v6
    v_mul_f32 v6, v6, v190
    v_mul_f32 v7, v7, v191
    v_cvt_pk_bf16_f32 v6, v6, v7
    v_and_b32 v7, s54, v6
    v_lshlrev_b32 v6, 16, v6
    v_add_f32 v6, v6, v238
    v_add_f32 v7, v7, v239
    v_cvt_pk_bf16_f32 v71, v6, v7
    s_lshl_b32 s42, s38, 6
    s_sub_u32 s42, s50, s42
    v_cmp_ne_u32 vcc, s42, v46
    s_and_saveexec_b64 s[44:45], vcc
    buffer_store_dwordx4 v[64:67], v49, s[20:23], s46 offen
    buffer_store_dwordx4 v[68:71], v49, s[20:23], s46 offen offset:64
    s_mov_b64 exec, s[44:45]
    s_cmp_lg_u32 s2, 255
    s_cbranch_scc1 L2_fin
    v_mul_f32 v4, s52, v63
    v_mul_f32 v6, v4, v4
    v_fma_f32 v5, v59, s52, -v6
    v_max_f32 v5, 0, v5
    v_cvt_pk_bf16_f32 v5, v5, v5
    v_and_b32 v5, 0xffff0000, v5
    v_add_f32 v5, s53, v5
    v_cvt_pk_bf16_f32 v5, v5, v5
    v_and_b32 v5, 0xffff0000, v5
    v_sqrt_f32 v5, v5
    s_nop 0
    v_cvt_pk_bf16_f32 v5, v5, v5
    v_and_b32 v5, 0xffff0000, v5
    v_rcp_f32 v5, v5
    v_cvt_pk_bf16_f32 v4, v4, v4
    v_and_b32 v4, 0xffff0000, v4
    v_lshlrev_b32 v72, 16, v62
    v_and_b32 v73, 0xffff0000, v62
    v_sub_f32 v74, v72, v4
    v_sub_f32 v75, v73, v4
    v_cvt_pk_bf16_f32 v74, v74, v75
    v_and_b32 v75, s54, v74
    v_lshlrev_b32 v74, 16, v74
    v_mul_f32 v74, v74, v5
    v_mul_f32 v75, v75, v5
    v_cvt_pk_bf16_f32 v74, v74, v75
    v_and_b32 v75, s54, v74
    v_lshlrev_b32 v74, 16, v74
    v_mul_f32 v74, v74, v52
    v_mul_f32 v75, v75, v53
    v_cvt_pk_bf16_f32 v74, v74, v75
    v_and_b32 v75, s54, v74
    v_lshlrev_b32 v74, 16, v74
    v_add_f32 v74, v74, v54
    v_add_f32 v75, v75, v55
    v_cvt_pk_bf16_f32 v74, v74, v75
    v_and_b32 v75, s54, v74
    v_lshlrev_b32 v74, 16, v74
    s_and_b32 s44, s49, 0xfffff800
    s_ashr_i32 s45, s44, 31
    s_not_b32 s45, s45
    s_or_b32 s45, s45, 0x80000000
    s_xor_b32 s44, s44, s45
    v_mov_b32 v78, s44
    v_cvt_pk_bf16_f32 v78, v78, v78
    v_and_b32 v78, 0xffff0000, v78
    v_mul_f32 v78, 0xbfb8aa3b, v78
    v_exp_f32 v78, v78
    s_nop 0
    v_add_f32 v78, 1.0, v78
    v_rcp_f32 v78, v78
    s_nop 0
    v_cvt_pk_bf16_f32 v78, v78, v78
    v_and_b32 v78, 0xffff0000, v78
    v_lshlrev_b32 v9, 6, v0
    s_mul_i32 s42, s36, 3584
    s_add_u32 s42, s42, 83968
    s_mov_b32 s70, 0
    s_mov_b32 exec_hi, 0xffffff
L5_poll:
    buffer_load_dword v3, v9, s[32:35], s42 offen sc1
    s_waitcnt vmcnt(0)
    v_cmp_ne_u32 vcc, 1, v3
    s_add_u32 s70, s70, 1
    s_cmp_gt_u32 s70, 0x8000
    s_cbranch_scc1 L5_px
    s_cbranch_vccnz L5_poll
L5_px:
    s_mov_b64 exec, -1
    s_barrier
    s_mov_b32 s42, 51200
    buffer_load_dword v80, v1, s[32:35], s42 offen sc1
    buffer_load_dword v81, v1, s[32:35], s42 offen offset:1024 sc1
    s_mov_b32 s42, 53248
    buffer_load_dword v82, v1, s[32:35], s42 offen sc1
    buffer_load_dword v83, v1, s[32:35], s42 offen offset:1024 sc1
    s_mov_b32 s42, 55296
    buffer_load_dword v84, v1, s[32:35], s42 offen sc1
    buffer_load_dword v85, v1, s[32:35], s42 offen offset:1024 sc1
    s_mov_b32 s42, 57344
    buffer_load_dword v86, v1, s[32:35], s42 offen sc1
    buffer_load_dword v87, v1, s[32:35], s42 offen offset:1024 sc1
    s_mov_b32 s42, 59392
    buffer_load_dword v88, v1, s[32:35], s42 offen sc1
    buffer_load_dword v89, v1, s[32:35], s42 offen offset:1024 sc1
    s_mov_b32 s42, 61440
    buffer_load_dword v90, v1, s[32:35], s42 offen sc1
    buffer_load_dword v91, v1, s[32:35], s42 offen offset:1024 sc1
    s_mov_b32 s42, 63488
    buffer_load_dword v92, v1, s[32:35], s42 offen sc1
    buffer_load_dword v93, v1, s[32:35], s42 offen offset:1024 sc1
    s_mov_b32 s42, 65536
    buffer_load_dword v94, v1, s[32:35], s42 offen sc1
    buffer_load_dword v95, v1, s[32:35], s42 offen offset:1024 sc1
    s_mov_b32 s42, 67584
    s_waitcnt lgkmcnt(7)
    buffer_load_dword v96, v1, s[32:35], s42 offen sc1
    s_waitcnt lgkmcnt(6)
    buffer_load_dword v97, v1, s[32:35], s42 offen offset:1024 sc1
    s_mov_b32 s42, 69632
    s_waitcnt lgkmcnt(5)
    buffer_load_dword v98, v1, s[32:35], s42 offen sc1
    s_waitcnt lgkmcnt(4)
    buffer_load_dword v99, v1, s[32:35], s42 offen offset:1024 sc1
    s_mov_b32 s42, 71680
    s_waitcnt lgkmcnt(3)
    buffer_load_dword v100, v1, s[32:35], s42 offen sc1
    s_waitcnt lgkmcnt(2)
    buffer_load_dword v101, v1, s[32:35], s42 offen offset:1024 sc1
    s_mov_b32 s42, 73728
    s_waitcnt lgkmcnt(1)
    buffer_load_dword v102, v1, s[32:35], s42 offen sc1
    s_waitcnt lgkmcnt(0)
    buffer_load_dword v103, v1, s[32:35], s42 offen offset:1024 sc1
    s_mov_b32 s42, 75776
    buffer_load_dword v104, v1, s[32:35], s42 offen sc1
    buffer_load_dword v105, v1, s[32:35], s42 offen offset:1024 sc1
    s_mov_b32 s42, 77824
    buffer_load_dword v106, v1, s[32:35], s42 offen sc1
    buffer_load_dword v107, v1, s[32:35], s42 offen offset:1024 sc1
    s_mov_b32 s42, 79872
    buffer_load_dword v108, v1, s[32:35], s42 offen sc1
    buffer_load_dword v109, v1, s[32:35], s42 offen offset:1024 sc1
    s_mov_b32 s42, 81920
    buffer_load_dword v110, v1, s[32:35], s42 offen sc1
    buffer_load_dword v111, v1, s[32:35], s42 offen offset:1024 sc1
    s_waitcnt vmcnt(15)
    v_add_f32 v80, v80, v96
    s_waitcnt vmcnt(14)
    v_add_f32 v81, v81, v97
    s_waitcnt vmcnt(13)
    v_add_f32 v82, v82, v98
    s_waitcnt vmcnt(12)
    v_add_f32 v83, v83, v99
    s_waitcnt vmcnt(11)
    v_add_f32 v84, v84, v100
    s_waitcnt vmcnt(10)
    v_add_f32 v85, v85, v101
    s_waitcnt vmcnt(9)
    v_add_f32 v86, v86, v102
    s_waitcnt vmcnt(8)
    v_add_f32 v87, v87, v103
    s_waitcnt vmcnt(7)
    v_add_f32 v88, v88, v104
    s_waitcnt vmcnt(6)
    v_add_f32 v89, v89, v105
    s_waitcnt vmcnt(5)
    v_add_f32 v90, v90, v106
    s_waitcnt vmcnt(4)
    v_add_f32 v91, v91, v107
    s_waitcnt vmcnt(3)
    v_add_f32 v92, v92, v108
    s_waitcnt vmcnt(2)
    v_add_f32 v93, v93, v109
    s_waitcnt vmcnt(1)
    v_add_f32 v94, v94, v110
    s_waitcnt vmcnt(0)
    v_add_f32 v95, v95, v111
    v_add_f32 v80, v80, v88
    v_add_f32 v81, v81, v89
    v_add_f32 v82, v82, v90
    v_add_f32 v83, v83, v91
    v_add_f32 v84, v84, v92
    v_add_f32 v85, v85, v93
    v_add_f32 v86, v86, v94
    v_add_f32 v87, v87, v95
    v_add_f32 v80, v80, v84
    v_add_f32 v81, v81, v85
    v_add_f32 v82, v82, v86
    v_add_f32 v83, v83, v87
    v_add_f32 v80, v80, v82
    v_add_f32 v81, v81, v83
    v_cvt_pk_bf16_f32 v80, v80, v81
    v_and_b32 v81, s54, v80
    v_lshlrev_b32 v80, 16, v80
    v_mul_f32 v80, v80, v78
    v_mul_f32 v81, v81, v78
    v_cvt_pk_bf16_f32 v80, v80, v81
    v_and_b32 v81, s54, v80
    v_lshlrev_b32 v80, 16, v80
    v_add_f32 v80, v80, v74
    v_add_f32 v81, v81, v75
    v_cvt_pk_bf16_f32 v80, v80, v81
    v_and_b32 v81, s54, v80
    v_lshlrev_b32 v80, 16, v80
    v_mul_f32 v80, v80, v56
    v_mul_f32 v81, v81, v57
    v_cvt_pk_bf16_f32 v80, v80, v81
    v_and_b32 v81, s54, v80
    v_lshlrev_b32 v80, 16, v80
    v_add_f32 v80, v80, v72
    v_add_f32 v81, v81, v73
    v_cvt_pk_bf16_f32 v80, v80, v81
    s_lshl_b32 s42, s50, 10
    buffer_store_dword v80, v1, s[20:23], s42 offen
    s_branch L2_fin
L4_mlp:
    s_waitcnt vmcnt(3)
    v_lshlrev_b32 v104, 16, v16
    v_and_b32 v105, 0xffff0000, v16
    v_lshlrev_b32 v106, 16, v17
    v_and_b32 v107, 0xffff0000, v17
    v_lshlrev_b32 v108, 16, v18
    v_and_b32 v109, 0xffff0000, v18
    v_lshlrev_b32 v110, 16, v19
    v_and_b32 v111, 0xffff0000, v19
    s_waitcnt vmcnt(2)
    v_lshlrev_b32 v112, 16, v20
    v_and_b32 v113, 0xffff0000, v20
    v_lshlrev_b32 v114, 16, v21
    v_and_b32 v115, 0xffff0000, v21
    v_lshlrev_b32 v116, 16, v22
    v_and_b32 v117, 0xffff0000, v22
    v_lshlrev_b32 v118, 16, v23
    v_and_b32 v119, 0xffff0000, v23
    s_waitcnt vmcnt(1)
    v_lshlrev_b32 v120, 16, v24
    v_and_b32 v121, 0xffff0000, v24
    v_lshlrev_b32 v122, 16, v25
    v_and_b32 v123, 0xffff0000, v25
    v_lshlrev_b32 v124, 16, v26
    v_and_b32 v125, 0xffff0000, v26
    v_lshlrev_b32 v126, 16, v27
    v_and_b32 v127, 0xffff0000, v27
    s_waitcnt vmcnt(0)
    v_lshlrev_b32 v64, 16, v28
    v_and_b32 v65, 0xffff0000, v28
    v_lshlrev_b32 v66, 16, v29
    v_and_b32 v67, 0xffff0000, v29
    v_lshlrev_b32 v68, 16, v30
    v_and_b32 v69, 0xffff0000, v30
    v_lshlrev_b32 v70, 16, v31
    v_and_b32 v71, 0xffff0000, v31
    s_waitcnt lgkmcnt(7)
    v_lshlrev_b32 v240, 16, v96
    v_and_b32 v241, 0xffff0000, v96
    s_waitcnt lgkmcnt(6)
    v_lshlrev_b32 v242, 16, v97
    v_and_b32 v243, 0xffff0000, v97
    s_waitcnt lgkmcnt(5)
    v_lshlrev_b32 v244, 16, v98
    v_and_b32 v245, 0xffff0000, v98
    s_waitcnt lgkmcnt(4)
    v_lshlrev_b32 v246, 16, v99
    v_and_b32 v247, 0xffff0000, v99
    s_waitcnt lgkmcnt(3)
    v_lshlrev_b32 v248, 16, v100
    v_and_b32 v249, 0xffff0000, v100
    s_waitcnt lgkmcnt(2)
    v_lshlrev_b32 v250, 16, v101
    v_and_b32 v251, 0xffff0000, v101
    s_waitcnt lgkmcnt(1)
    v_lshlrev_b32 v252, 16, v102
    v_and_b32 v253, 0xffff0000, v102
    s_waitcnt lgkmcnt(0)
    v_lshlrev_b32 v254, 16, v103
    v_and_b32 v255, 0xffff0000, v103
    v_mul_f32 v4, s52, v63
    v_mul_f32 v6, v4, v4
    v_fma_f32 v5, v59, s52, -v6
    v_max_f32 v5, 0, v5
    v_cvt_pk_bf16_f32 v5, v5, v5
    v_and_b32 v5, 0xffff0000, v5
    v_add_f32 v5, s53, v5
    v_cvt_pk_bf16_f32 v5, v5, v5
    v_and_b32 v5, 0xffff0000, v5
    v_sqrt_f32 v5, v5
    s_nop 0
    v_cvt_pk_bf16_f32 v5, v5, v5
    v_and_b32 v5, 0xffff0000, v5
    v_rcp_f32 v5, v5
    v_cvt_pk_bf16_f32 v4, v4, v4
    v_and_b32 v4, 0xffff0000, v4
    v_lshlrev_b32 v72, 16, v62
    v_and_b32 v73, 0xffff0000, v62
    v_sub_f32 v74, v72, v4
    v_sub_f32 v75, v73, v4
    v_cvt_pk_bf16_f32 v74, v74, v75
    v_and_b32 v75, s54, v74
    v_lshlrev_b32 v74, 16, v74
    v_mul_f32 v74, v74, v5
    v_mul_f32 v75, v75, v5
    v_cvt_pk_bf16_f32 v74, v74, v75
    v_and_b32 v75, s54, v74
    v_lshlrev_b32 v74, 16, v74
    v_mul_f32 v74, v74, v52
    v_mul_f32 v75, v75, v53
    v_cvt_pk_bf16_f32 v74, v74, v75
    v_and_b32 v75, s54, v74
    v_lshlrev_b32 v74, 16, v74
    v_add_f32 v74, v74, v54
    v_add_f32 v75, v75, v55
    v_cvt_pk_bf16_f32 v74, v74, v75
    v_and_b32 v75, s54, v74
    v_lshlrev_b32 v74, 16, v74
    v_mul_f32 v80, v74, v104
    v_mul_f32 v82, v74, v105
    v_fmac_f32 v80, v75, v112
    v_fmac_f32 v82, v75, v113
    v_mul_f32 v84, v74, v106
    v_mul_f32 v86, v74, v107
    v_fmac_f32 v84, v75, v114
    v_fmac_f32 v86, v75, v115
    v_mul_f32 v88, v74, v108
    v_mul_f32 v90, v74, v109
    v_fmac_f32 v88, v75, v116
    v_fmac_f32 v90, v75, v117
    v_mul_f32 v92, v74, v110
    v_mul_f32 v94, v74, v111
    v_fmac_f32 v92, v75, v118
    v_fmac_f32 v94, v75, v119
    v_mul_f32 v81, v74, v120
    v_mul_f32 v83, v74, v121
    v_fmac_f32 v81, v75, v64
    v_fmac_f32 v83, v75, v65
    v_mul_f32 v85, v74, v122
    v_mul_f32 v87, v74, v123
    v_fmac_f32 v85, v75, v66
    v_fmac_f32 v87, v75, v67
    v_mul_f32 v89, v74, v124
    v_mul_f32 v91, v74, v125
    v_fmac_f32 v89, v75, v68
    v_fmac_f32 v91, v75, v69
    v_mul_f32 v93, v74, v126
    v_mul_f32 v95, v74, v127
    v_fmac_f32 v93, v75, v70
    v_fmac_f32 v95, v75, v71
    v_add_f32_dpp v80, v80, v80 row_ror:8 row_mask:0xf bank_mask:0xf
    v_add_f32_dpp v81, v81, v81 row_ror:8 row_mask:0xf bank_mask:0xf
    v_add_f32_dpp v82, v82, v82 row_ror:8 row_mask:0xf bank_mask:0xf
    v_add_f32_dpp v83, v83, v83 row_ror:8 row_mask:0xf bank_mask:0xf
    v_add_f32_dpp v84, v84, v84 row_ror:8 row_mask:0xf bank_mask:0xf
    v_add_f32_dpp v85, v85, v85 row_ror:8 row_mask:0xf bank_mask:0xf
    v_add_f32_dpp v86, v86, v86 row_ror:8 row_mask:0xf bank_mask:0xf
    v_add_f32_dpp v87, v87, v87 row_ror:8 row_mask:0xf bank_mask:0xf
    v_add_f32_dpp v88, v88, v88 row_ror:8 row_mask:0xf bank_mask:0xf
    v_add_f32_dpp v89, v89, v89 row_ror:8 row_mask:0xf bank_mask:0xf
    v_add_f32_dpp v90, v90, v90 row_ror:8 row_mask:0xf bank_mask:0xf
    v_add_f32_dpp v91, v91, v91 row_ror:8 row_mask:0xf bank_mask:0xf
    v_add_f32_dpp v92, v92, v92 row_ror:8 row_mask:0xf bank_mask:0xf
    v_add_f32_dpp v93, v93, v93 row_ror:8 row_mask:0xf bank_mask:0xf
    v_add_f32_dpp v94, v94, v94 row_ror:8 row_mask:0xf bank_mask:0xf
    v_add_f32_dpp v95, v95, v95 row_ror:8 row_mask:0xf bank_mask:0xf
    v_add_f32_dpp v80, v80, v80 row_ror:4 row_mask:0xf bank_mask:0xf
    v_add_f32_dpp v81, v81, v81 row_ror:4 row_mask:0xf bank_mask:0xf
    v_add_f32_dpp v82, v82, v82 row_ror:4 row_mask:0xf bank_mask:0xf
    v_add_f32_dpp v83, v83, v83 row_ror:4 row_mask:0xf bank_mask:0xf
    v_add_f32_dpp v84, v84, v84 row_ror:4 row_mask:0xf bank_mask:0xf
    v_add_f32_dpp v85, v85, v85 row_ror:4 row_mask:0xf bank_mask:0xf
    v_add_f32_dpp v86, v86, v86 row_ror:4 row_mask:0xf bank_mask:0xf
    v_add_f32_dpp v87, v87, v87 row_ror:4 row_mask:0xf bank_mask:0xf
    v_add_f32_dpp v88, v88, v88 row_ror:4 row_mask:0xf bank_mask:0xf
    v_add_f32_dpp v89, v89, v89 row_ror:4 row_mask:0xf bank_mask:0xf
    v_add_f32_dpp v90, v90, v90 row_ror:4 row_mask:0xf bank_mask:0xf
    v_add_f32_dpp v91, v91, v91 row_ror:4 row_mask:0xf bank_mask:0xf
    v_add_f32_dpp v92, v92, v92 row_ror:4 row_mask:0xf bank_mask:0xf
    v_add_f32_dpp v93, v93, v93 row_ror:4 row_mask:0xf bank_mask:0xf
    v_add_f32_dpp v94, v94, v94 row_ror:4 row_mask:0xf bank_mask:0xf
    v_add_f32_dpp v95, v95, v95 row_ror:4 row_mask:0xf bank_mask:0xf
    v_add_f32_dpp v80, v80, v80 row_ror:2 row_mask:0xf bank_mask:0xf
    v_add_f32_dpp v81, v81, v81 row_ror:2 row_mask:0xf bank_mask:0xf
    v_add_f32_dpp v82, v82, v82 row_ror:2 row_mask:0xf bank_mask:0xf
    v_add_f32_dpp v83, v83, v83 row_ror:2 row_mask:0xf bank_mask:0xf
    v_add_f32_dpp v84, v84, v84 row_ror:2 row_mask:0xf bank_mask:0xf
    v_add_f32_dpp v85, v85, v85 row_ror:2 row_mask:0xf bank_mask:0xf
    v_add_f32_dpp v86, v86, v86 row_ror:2 row_mask:0xf bank_mask:0xf
    v_add_f32_dpp v87, v87, v87 row_ror:2 row_mask:0xf bank_mask:0xf
    v_add_f32_dpp v88, v88, v88 row_ror:2 row_mask:0xf bank_mask:0xf
    v_add_f32_dpp v89, v89, v89 row_ror:2 row_mask:0xf bank_mask:0xf
    v_add_f32_dpp v90, v90, v90 row_ror:2 row_mask:0xf bank_mask:0xf
    v_add_f32_dpp v91, v91, v91 row_ror:2 row_mask:0xf bank_mask:0xf
    v_add_f32_dpp v92, v92, v92 row_ror:2 row_mask:0xf bank_mask:0xf
    v_add_f32_dpp v93, v93, v93 row_ror:2 row_mask:0xf bank_mask:0xf
    v_add_f32_dpp v94, v94, v94 row_ror:2 row_mask:0xf bank_mask:0xf
    v_add_f32_dpp v95, v95, v95 row_ror:2 row_mask:0xf bank_mask:0xf
    v_add_f32_dpp v80, v80, v80 row_ror:1 row_mask:0xf bank_mask:0xf
    v_add_f32_dpp v81, v81, v81 row_ror:1 row_mask:0xf bank_mask:0xf
    v_add_f32_dpp v82, v82, v82 row_ror:1 row_mask:0xf bank_mask:0xf
    v_add_f32_dpp v83, v83, v83 row_ror:1 row_mask:0xf bank_mask:0xf
    v_add_f32_dpp v84, v84, v84 row_ror:1 row_mask:0xf bank_mask:0xf
    v_add_f32_dpp v85, v85, v85 row_ror:1 row_mask:0xf bank_mask:0xf
    v_add_f32_dpp v86, v86, v86 row_ror:1 row_mask:0xf bank_mask:0xf
    v_add_f32_dpp v87, v87, v87 row_ror:1 row_mask:0xf bank_mask:0xf
    v_add_f32_dpp v88, v88, v88 row_ror:1 row_mask:0xf bank_mask:0xf
    v_add_f32_dpp v89, v89, v89 row_ror:1 row_mask:0xf bank_mask:0xf
    v_add_f32_dpp v90, v90, v90 row_ror:1 row_mask:0xf bank_mask:0xf
    v_add_f32_dpp v91, v91, v91 row_ror:1 row_mask:0xf bank_mask:0xf
    v_add_f32_dpp v92, v92, v92 row_ror:1 row_mask:0xf bank_mask:0xf
    v_add_f32_dpp v93, v93, v93 row_ror:1 row_mask:0xf bank_mask:0xf
    v_add_f32_dpp v94, v94, v94 row_ror:1 row_mask:0xf bank_mask:0xf
    v_add_f32_dpp v95, v95, v95 row_ror:1 row_mask:0xf bank_mask:0xf
    v_lshrrev_b32 v4, 4, v34
    v_lshlrev_b32 v5, 6, v4
    v_and_b32 v6, 15, v0
    v_cmp_eq_u32 vcc, 0, v6
    s_and_saveexec_b64 s[44:45], vcc
    ds_write_b128 v5, v[80:83] offset:64
    ds_write_b128 v5, v[84:87] offset:80
    ds_write_b128 v5, v[88:91] offset:96
    ds_write_b128 v5, v[92:95] offset:112
    s_mov_b64 exec, s[44:45]
    v_lshlrev_b32 v6, 6, v6
    v_lshl_add_u32 v6, v4, 2, v6
    s_waitcnt lgkmcnt(0)
    s_barrier
    ds_read_b32 v8, v6 offset:64
    s_waitcnt lgkmcnt(0)
    v_add_f32_dpp v8, v8, v8 row_ror:8 row_mask:0xf bank_mask:0xf
    s_nop 1
    v_add_f32_dpp v8, v8, v8 row_ror:4 row_mask:0xf bank_mask:0xf
    s_nop 1
    v_add_f32_dpp v8, v8, v8 row_ror:2 row_mask:0xf bank_mask:0xf
    s_nop 1
    v_add_f32_dpp v8, v8, v8 row_ror:1 row_mask:0xf bank_mask:0xf
    v_cvt_pk_bf16_f32 v8, v8, v8
    v_and_b32 v8, 0xffff0000, v8
    v_mov_b32 v9, v8
    s_nop 1
    v_permlane16_swap_b32 v8, v9
    v_mul_f32 v10, 0xbfb8aa3b, v8
    v_exp_f32 v10, v10
    s_nop 0
    v_add_f32 v10, 1.0, v10
    v_rcp_f32 v10, v10
    s_nop 0
    v_mul_f32 v8, v8, v10
    v_cvt_pk_bf16_f32 v8, v8, v8
    v_and_b32 v8, 0xffff0000, v8
    v_mul_f32 v8, v8, v9
    v_cvt_pk_bf16_f32 v8, v8, v8
    v_and_b32 v8, 0xffff0000, v8
    v_lshrrev_b32 v4, 5, v34
    v_lshlrev_b32 v4, 2, v4
    v_and_b32 v6, 31, v0
    v_cmp_eq_u32 vcc, 0, v6
    s_and_saveexec_b64 s[44:45], vcc
    ds_write_b32 v4, v8 offset:2048
    s_mov_b64 exec, s[44:45]
    s_waitcnt lgkmcnt(0)
    s_barrier
    ds_read_b128 v[80:83], v40 offset:2048
    ds_read_b128 v[84:87], v40 offset:2064
    s_waitcnt lgkmcnt(1)
    v_mul_f32 v76, v80, v240
    v_mul_f32 v77, v80, v241
    v_fmac_f32 v76, v81, v242
    v_fmac_f32 v77, v81, v243
    v_fmac_f32 v76, v82, v244
    v_fmac_f32 v77, v82, v245
    v_fmac_f32 v76, v83, v246
    v_fmac_f32 v77, v83, v247
    s_waitcnt lgkmcnt(0)
    v_fmac_f32 v76, v84, v248
    v_fmac_f32 v77, v84, v249
    v_fmac_f32 v76, v85, v250
    v_fmac_f32 v77, v85, v251
    v_fmac_f32 v76, v86, v252
    v_fmac_f32 v77, v86, v253
    v_fmac_f32 v76, v87, v254
    v_fmac_f32 v77, v87, v255
    s_and_b32 s43, s2, 15
    s_lshl_b32 s42, s43, 11
    s_add_u32 s42, s42, 51200
    buffer_atomic_add_f32 v76, v1, s[32:35], s42 offen
    buffer_atomic_add_f32 v77, v1, s[32:35], s42 offen offset:1024
    s_mov_b32 s20, s62
    s_mov_b32 s21, s63
    s_mov_b32 s22, 2097152
    s_mov_b32 s23, 0x20000
    v_mul_f32 v4, s52, v60
    v_mul_f32 v6, v4, v4
    v_fma_f32 v5, v61, s52, -v6
    v_max_f32 v5, 0, v5
    v_cvt_pk_bf16_f32 v5, v5, v5
    v_and_b32 v5, 0xffff0000, v5
    v_add_f32 v5, s53, v5
    v_cvt_pk_bf16_f32 v5, v5, v5
    v_and_b32 v5, 0xffff0000, v5
    v_sqrt_f32 v5, v5
    s_nop 0
    v_cvt_pk_bf16_f32 v5, v5, v5
    v_and_b32 v5, 0xffff0000, v5
    v_rcp_f32 v5, v5
    v_cvt_pk_bf16_f32 v4, v4, v4
    v_and_b32 v4, 0xffff0000, v4
    v_sub_f32 v6, v224, v4
    v_sub_f32 v7, v225, v4
    v_cvt_pk_bf16_f32 v6, v6, v7
    v_and_b32 v7, s54, v6
    v_lshlrev_b32 v6, 16, v6
    v_mul_f32 v6, v6, v5
    v_mul_f32 v7, v7, v5
    v_cvt_pk_bf16_f32 v6, v6, v7
    v_and_b32 v7, s54, v6
    v_lshlrev_b32 v6, 16, v6
    v_mul_f32 v6, v6, v144
    v_mul_f32 v7, v7, v145
    v_cvt_pk_bf16_f32 v6, v6, v7
    v_and_b32 v7, s54, v6
    v_lshlrev_b32 v6, 16, v6
    v_add_f32 v6, v6, v160
    v_add_f32 v7, v7, v161
    v_cvt_pk_bf16_f32 v6, v6, v7
    v_and_b32 v7, s54, v6
    v_lshlrev_b32 v6, 16, v6
    v_mul_f32 v6, v6, v176
    v_mul_f32 v7, v7, v177
    v_cvt_pk_bf16_f32 v6, v6, v7
    v_and_b32 v7, s54, v6
    v_lshlrev_b32 v6, 16, v6
    v_add_f32 v6, v6, v224
    v_add_f32 v7, v7, v225
    v_cvt_pk_bf16_f32 v64, v6, v7
    v_sub_f32 v6, v226, v4
    v_sub_f32 v7, v227, v4
    v_cvt_pk_bf16_f32 v6, v6, v7
    v_and_b32 v7, s54, v6
    v_lshlrev_b32 v6, 16, v6
    v_mul_f32 v6, v6, v5
    v_mul_f32 v7, v7, v5
    v_cvt_pk_bf16_f32 v6, v6, v7
    v_and_b32 v7, s54, v6
    v_lshlrev_b32 v6, 16, v6
    v_mul_f32 v6, v6, v146
    v_mul_f32 v7, v7, v147
    v_cvt_pk_bf16_f32 v6, v6, v7
    v_and_b32 v7, s54, v6
    v_lshlrev_b32 v6, 16, v6
    v_add_f32 v6, v6, v162
    v_add_f32 v7, v7, v163
    v_cvt_pk_bf16_f32 v6, v6, v7
    v_and_b32 v7, s54, v6
    v_lshlrev_b32 v6, 16, v6
    v_mul_f32 v6, v6, v178
    v_mul_f32 v7, v7, v179
    v_cvt_pk_bf16_f32 v6, v6, v7
    v_and_b32 v7, s54, v6
    v_lshlrev_b32 v6, 16, v6
    v_add_f32 v6, v6, v226
    v_add_f32 v7, v7, v227
    v_cvt_pk_bf16_f32 v65, v6, v7
    v_sub_f32 v6, v228, v4
    v_sub_f32 v7, v229, v4
    v_cvt_pk_bf16_f32 v6, v6, v7
    v_and_b32 v7, s54, v6
    v_lshlrev_b32 v6, 16, v6
    v_mul_f32 v6, v6, v5
    v_mul_f32 v7, v7, v5
    v_cvt_pk_bf16_f32 v6, v6, v7
    v_and_b32 v7, s54, v6
    v_lshlrev_b32 v6, 16, v6
    v_mul_f32 v6, v6, v148
    v_mul_f32 v7, v7, v149
    v_cvt_pk_bf16_f32 v6, v6, v7
    v_and_b32 v7, s54, v6
    v_lshlrev_b32 v6, 16, v6
    v_add_f32 v6, v6, v164
    v_add_f32 v7, v7, v165
    v_cvt_pk_bf16_f32 v6, v6, v7
    v_and_b32 v7, s54, v6
    v_lshlrev_b32 v6, 16, v6
    v_mul_f32 v6, v6, v180
    v_mul_f32 v7, v7, v181
    v_cvt_pk_bf16_f32 v6, v6, v7
    v_and_b32 v7, s54, v6
    v_lshlrev_b32 v6, 16, v6
    v_add_f32 v6, v6, v228
    v_add_f32 v7, v7, v229
    v_cvt_pk_bf16_f32 v66, v6, v7
    v_sub_f32 v6, v230, v4
    v_sub_f32 v7, v231, v4
    v_cvt_pk_bf16_f32 v6, v6, v7
    v_and_b32 v7, s54, v6
    v_lshlrev_b32 v6, 16, v6
    v_mul_f32 v6, v6, v5
    v_mul_f32 v7, v7, v5
    v_cvt_pk_bf16_f32 v6, v6, v7
    v_and_b32 v7, s54, v6
    v_lshlrev_b32 v6, 16, v6
    v_mul_f32 v6, v6, v150
    v_mul_f32 v7, v7, v151
    v_cvt_pk_bf16_f32 v6, v6, v7
    v_and_b32 v7, s54, v6
    v_lshlrev_b32 v6, 16, v6
    v_add_f32 v6, v6, v166
    v_add_f32 v7, v7, v167
    v_cvt_pk_bf16_f32 v6, v6, v7
    v_and_b32 v7, s54, v6
    v_lshlrev_b32 v6, 16, v6
    v_mul_f32 v6, v6, v182
    v_mul_f32 v7, v7, v183
    v_cvt_pk_bf16_f32 v6, v6, v7
    v_and_b32 v7, s54, v6
    v_lshlrev_b32 v6, 16, v6
    v_add_f32 v6, v6, v230
    v_add_f32 v7, v7, v231
    v_cvt_pk_bf16_f32 v67, v6, v7
    v_sub_f32 v6, v232, v4
    v_sub_f32 v7, v233, v4
    v_cvt_pk_bf16_f32 v6, v6, v7
    v_and_b32 v7, s54, v6
    v_lshlrev_b32 v6, 16, v6
    v_mul_f32 v6, v6, v5
    v_mul_f32 v7, v7, v5
    v_cvt_pk_bf16_f32 v6, v6, v7
    v_and_b32 v7, s54, v6
    v_lshlrev_b32 v6, 16, v6
    v_mul_f32 v6, v6, v152
    v_mul_f32 v7, v7, v153
    v_cvt_pk_bf16_f32 v6, v6, v7
    v_and_b32 v7, s54, v6
    v_lshlrev_b32 v6, 16, v6
    v_add_f32 v6, v6, v168
    v_add_f32 v7, v7, v169
    v_cvt_pk_bf16_f32 v6, v6, v7
    v_and_b32 v7, s54, v6
    v_lshlrev_b32 v6, 16, v6
    v_mul_f32 v6, v6, v184
    v_mul_f32 v7, v7, v185
    v_cvt_pk_bf16_f32 v6, v6, v7
    v_and_b32 v7, s54, v6
    v_lshlrev_b32 v6, 16, v6
    v_add_f32 v6, v6, v232
    v_add_f32 v7, v7, v233
    v_cvt_pk_bf16_f32 v68, v6, v7
    v_sub_f32 v6, v234, v4
    v_sub_f32 v7, v235, v4
    v_cvt_pk_bf16_f32 v6, v6, v7
    v_and_b32 v7, s54, v6
    v_lshlrev_b32 v6, 16, v6
    v_mul_f32 v6, v6, v5
    v_mul_f32 v7, v7, v5
    v_cvt_pk_bf16_f32 v6, v6, v7
    v_and_b32 v7, s54, v6
    v_lshlrev_b32 v6, 16, v6
    v_mul_f32 v6, v6, v154
    v_mul_f32 v7, v7, v155
    v_cvt_pk_bf16_f32 v6, v6, v7
    v_and_b32 v7, s54, v6
    v_lshlrev_b32 v6, 16, v6
    v_add_f32 v6, v6, v170
    v_add_f32 v7, v7, v171
    v_cvt_pk_bf16_f32 v6, v6, v7
    v_and_b32 v7, s54, v6
    v_lshlrev_b32 v6, 16, v6
    v_mul_f32 v6, v6, v186
    v_mul_f32 v7, v7, v187
    v_cvt_pk_bf16_f32 v6, v6, v7
    v_and_b32 v7, s54, v6
    v_lshlrev_b32 v6, 16, v6
    v_add_f32 v6, v6, v234
    v_add_f32 v7, v7, v235
    v_cvt_pk_bf16_f32 v69, v6, v7
    v_sub_f32 v6, v236, v4
    v_sub_f32 v7, v237, v4
    v_cvt_pk_bf16_f32 v6, v6, v7
    v_and_b32 v7, s54, v6
    v_lshlrev_b32 v6, 16, v6
    v_mul_f32 v6, v6, v5
    v_mul_f32 v7, v7, v5
    v_cvt_pk_bf16_f32 v6, v6, v7
    v_and_b32 v7, s54, v6
    v_lshlrev_b32 v6, 16, v6
    v_mul_f32 v6, v6, v156
    v_mul_f32 v7, v7, v157
    v_cvt_pk_bf16_f32 v6, v6, v7
    v_and_b32 v7, s54, v6
    v_lshlrev_b32 v6, 16, v6
    v_add_f32 v6, v6, v172
    v_add_f32 v7, v7, v173
    v_cvt_pk_bf16_f32 v6, v6, v7
    v_and_b32 v7, s54, v6
    v_lshlrev_b32 v6, 16, v6
    v_mul_f32 v6, v6, v188
    v_mul_f32 v7, v7, v189
    v_cvt_pk_bf16_f32 v6, v6, v7
    v_and_b32 v7, s54, v6
    v_lshlrev_b32 v6, 16, v6
    v_add_f32 v6, v6, v236
    v_add_f32 v7, v7, v237
    v_cvt_pk_bf16_f32 v70, v6, v7
    v_sub_f32 v6, v238, v4
    v_sub_f32 v7, v239, v4
    v_cvt_pk_bf16_f32 v6, v6, v7
    v_and_b32 v7, s54, v6
    v_lshlrev_b32 v6, 16, v6
    v_mul_f32 v6, v6, v5
    v_mul_f32 v7, v7, v5
    v_cvt_pk_bf16_f32 v6, v6, v7
    v_and_b32 v7, s54, v6
    v_lshlrev_b32 v6, 16, v6
    v_mul_f32 v6, v6, v158
    v_mul_f32 v7, v7, v159
    v_cvt_pk_bf16_f32 v6, v6, v7
    v_and_b32 v7, s54, v6
    v_lshlrev_b32 v6, 16, v6
    v_add_f32 v6, v6, v174
    v_add_f32 v7, v7, v175
    v_cvt_pk_bf16_f32 v6, v6, v7
    v_and_b32 v7, s54, v6
    v_lshlrev_b32 v6, 16, v6
    v_mul_f32 v6, v6, v190
    v_mul_f32 v7, v7, v191
    v_cvt_pk_bf16_f32 v6, v6, v7
    v_and_b32 v7, s54, v6
    v_lshlrev_b32 v6, 16, v6
    v_add_f32 v6, v6, v238
    v_add_f32 v7, v7, v239
    v_cvt_pk_bf16_f32 v71, v6, v7
    s_lshl_b32 s42, s38, 6
    s_sub_u32 s42, s50, s42
    v_cmp_ne_u32 vcc, s42, v46
    s_and_saveexec_b64 s[44:45], vcc
    buffer_store_dwordx4 v[64:67], v49, s[20:23], s46 offen
    buffer_store_dwordx4 v[68:71], v49, s[20:23], s46 offen offset:64
    s_mov_b64 exec, s[44:45]
    s_waitcnt vmcnt(2)
    s_barrier
    s_cmp_lg_u32 s36, 0
    s_cbranch_scc1 L2_fin
    s_mov_b64 exec, 1
    s_lshl_b32 s42, s2, 6
    s_add_u32 s42, s42, 83968
    buffer_store_dword v33, v40, s[32:35], s42 offen sc1
    s_mov_b64 exec, -1
L2_fin:
L2_end:
    s_endpgm
L2_slow:
    s_load_dwordx4 s[4:7], s[0:1], 8
    s_waitcnt vmcnt(0) lgkmcnt(0)
    s_lshl_b32 s42, s38, 19
    s_add_u32 s12, s4, s42
    s_addc_u32 s13, s5, 0
    s_mov_b32 s14, 524288
    s_mov_b32 s15, 0x20000
    s_add_u32 s16, s6, s42
    s_addc_u32 s17, s7, 0
    s_mov_b32 s18, 524288
    s_mov_b32 s19, 0x20000
    s_sub_u32 s43, s37, 65536
    v_add_u32 v36, s43, v36
    v_add_u32 v37, s43, v37
    v_add_u32 v38, s43, v38
    v_add_u32 v39, s43, v39
    v_add_u32 v40, s43, v40
    v_add_u32 v41, s43, v41
    v_add_u32 v42, s43, v42
    v_add_u32 v43, s43, v43
    v_and_b32 v2, 15, v0
    v_lshrrev_b32 v3, 4, v0
    v_lshlrev_b32 v2, 8, v2
    v_lshl_add_u32 v2, v3, 4, v2
    v_add_u32 v3, 4096, v2
    v_mfma_f32_32x32x16_bf16 v[128:143], a[212:215], a[212:215], 0
    v_mfma_f32_32x32x16_bf16 v[144:159], a[212:215], a[212:215], 0
    v_mfma_f32_32x32x16_bf16 v[160:175], a[212:215], a[212:215], 0
    v_mfma_f32_32x32x16_bf16 v[176:191], a[212:215], a[212:215], 0
    v_mfma_f32_32x32x16_bf16 v[192:207], a[212:215], a[212:215], 0
    v_mfma_f32_32x32x16_bf16 v[208:223], a[212:215], a[212:215], 0
    v_mfma_f32_32x32x16_bf16 v[224:239], a[212:215], a[212:215], 0
    v_mfma_f32_32x32x16_bf16 v[240:255], a[212:215], a[212:215], 0
    v_mfma_f32_32x32x16_bf16 a[192:207], a[212:215], a[212:215], 0
    v_mov_b32 v48, 0xff800000
    v_mov_b32 v49, 0xff800000
    v_mov_b32 v50, 0xff800000
    v_mov_b32 v51, 0xff800000
    s_mov_b32 s44, 0
L2_sloop:
    buffer_load_dwordx4 a[64:67], v2, s[12:15], s44 offen offset:0
    buffer_load_dwordx4 a[68:71], v2, s[12:15], s44 offen offset:64
    buffer_load_dwordx4 a[72:75], v2, s[12:15], s44 offen offset:128
    buffer_load_dwordx4 a[76:79], v2, s[12:15], s44 offen offset:192
    buffer_load_dwordx4 a[80:83], v3, s[12:15], s44 offen offset:0
    buffer_load_dwordx4 a[84:87], v3, s[12:15], s44 offen offset:64
    buffer_load_dwordx4 a[88:91], v3, s[12:15], s44 offen offset:128
    buffer_load_dwordx4 a[92:95], v3, s[12:15], s44 offen offset:192
    s_add_u32 m0, s37, 0
    s_add_u32 s40, s44, 0
    buffer_load_dwordx4 v44, s[16:19], s40 offen offset:0 sc1 lds
    buffer_load_dwordx4 v45, s[16:19], s40 offen offset:1024 sc1 lds
    buffer_load_dwordx4 v44, s[16:19], s40 offen offset:2048 sc1 lds
    buffer_load_dwordx4 v45, s[16:19], s40 offen offset:3072 sc1 lds
    s_add_u32 m0, s37, 16384
    s_add_u32 s40, s44, 4096
    buffer_load_dwordx4 v44, s[16:19], s40 offen offset:0 sc1 lds
    buffer_load_dwordx4 v45, s[16:19], s40 offen offset:1024 sc1 lds
    buffer_load_dwordx4 v44, s[16:19], s40 offen offset:2048 sc1 lds
    buffer_load_dwordx4 v45, s[16:19], s40 offen offset:3072 sc1 lds
    s_waitcnt vmcnt(0)
    ds_read_b64_tr_b16 a[128:129], v36 offset:0
    ds_read_b64_tr_b16 a[130:131], v36 offset:16384
    ds_read_b64_tr_b16 a[132:133], v37 offset:0
    ds_read_b64_tr_b16 a[134:135], v37 offset:16384
    ds_read_b64_tr_b16 a[136:137], v38 offset:0
    ds_read_b64_tr_b16 a[138:139], v38 offset:16384
    ds_read_b64_tr_b16 a[140:141], v39 offset:0
    ds_read_b64_tr_b16 a[142:143], v39 offset:16384
    ds_read_b64_tr_b16 a[144:145], v40 offset:0
    ds_read_b64_tr_b16 a[146:147], v40 offset:16384
    ds_read_b64_tr_b16 a[148:149], v41 offset:0
    ds_read_b64_tr_b16 a[150:151], v41 offset:16384
    ds_read_b64_tr_b16 a[152:153], v42 offset:0
    ds_read_b64_tr_b16 a[154:155], v42 offset:16384
    ds_read_b64_tr_b16 a[156:157], v43 offset:0
    ds_read_b64_tr_b16 a[158:159], v43 offset:16384
    v_mfma_f32_16x16x32_bf16 v[64:67], a[64:67], a[0:3], 0
    v_mfma_f32_16x16x32_bf16 v[68:71], a[64:67], a[16:19], 0
    v_mfma_f32_16x16x32_bf16 v[72:75], a[64:67], a[32:35], 0
    v_mfma_f32_16x16x32_bf16 v[76:79], a[64:67], a[48:51], 0
    v_mfma_f32_16x16x32_bf16 v[64:67], a[68:71], a[4:7], v[64:67]
    v_mfma_f32_16x16x32_bf16 v[68:71], a[68:71], a[20:23], v[68:71]
    v_mfma_f32_16x16x32_bf16 v[72:75], a[68:71], a[36:39], v[72:75]
    v_mfma_f32_16x16x32_bf16 v[76:79], a[68:71], a[52:55], v[76:79]
    v_mfma_f32_16x16x32_bf16 v[64:67], a[72:75], a[8:11], v[64:67]
    v_mfma_f32_16x16x32_bf16 v[68:71], a[72:75], a[24:27], v[68:71]
    v_mfma_f32_16x16x32_bf16 v[72:75], a[72:75], a[40:43], v[72:75]
    v_mfma_f32_16x16x32_bf16 v[76:79], a[72:75], a[56:59], v[76:79]
    v_mfma_f32_16x16x32_bf16 v[64:67], a[76:79], a[12:15], v[64:67]
    v_mfma_f32_16x16x32_bf16 v[68:71], a[76:79], a[28:31], v[68:71]
    v_mfma_f32_16x16x32_bf16 v[72:75], a[76:79], a[44:47], v[72:75]
    v_mfma_f32_16x16x32_bf16 v[76:79], a[76:79], a[60:63], v[76:79]
    v_mfma_f32_16x16x32_bf16 v[80:83], a[80:83], a[0:3], 0
    v_mfma_f32_16x16x32_bf16 v[84:87], a[80:83], a[16:19], 0
    v_mfma_f32_16x16x32_bf16 v[88:91], a[80:83], a[32:35], 0
    v_mfma_f32_16x16x32_bf16 v[92:95], a[80:83], a[48:51], 0
    v_mfma_f32_16x16x32_bf16 v[80:83], a[84:87], a[4:7], v[80:83]
    v_mfma_f32_16x16x32_bf16 v[84:87], a[84:87], a[20:23], v[84:87]
    v_mfma_f32_16x16x32_bf16 v[88:91], a[84:87], a[36:39], v[88:91]
    v_mfma_f32_16x16x32_bf16 v[92:95], a[84:87], a[52:55], v[92:95]
    v_mfma_f32_16x16x32_bf16 v[80:83], a[88:91], a[8:11], v[80:83]
    v_mfma_f32_16x16x32_bf16 v[84:87], a[88:91], a[24:27], v[84:87]
    v_mfma_f32_16x16x32_bf16 v[88:91], a[88:91], a[40:43], v[88:91]
    v_mfma_f32_16x16x32_bf16 v[92:95], a[88:91], a[56:59], v[92:95]
    v_mfma_f32_16x16x32_bf16 v[80:83], a[92:95], a[12:15], v[80:83]
    v_mfma_f32_16x16x32_bf16 v[84:87], a[92:95], a[28:31], v[84:87]
    v_mfma_f32_16x16x32_bf16 v[88:91], a[92:95], a[44:47], v[88:91]
    v_mfma_f32_16x16x32_bf16 v[92:95], a[92:95], a[60:63], v[92:95]
    v_max3_f32 v16, v64, v65, v66
    s_nop 3
    v_max3_f32 v16, v16, v67, v80
    v_max3_f32 v16, v16, v81, v82
    v_max3_f32 v16, v16, v83, v48
    v_mov_b32 v17, v16
    s_nop 1
    v_permlane16_swap_b32 v17, v16
    v_max_f32 v16, v17, v16
    v_mov_b32 v17, v16
    s_nop 1
    v_permlane32_swap_b32 v17, v16
    v_max_f32 v16, v17, v16
    v_sub_f32 v17, v48, v16
    v_exp_f32 v17, v17
    v_mov_b32 v48, v16
    v_mul_f32 v128, v128, v17
    v_mul_f32 v129, v129, v17
    v_mul_f32 v130, v130, v17
    v_mul_f32 v131, v131, v17
    v_mul_f32 v144, v144, v17
    v_mul_f32 v145, v145, v17
    v_mul_f32 v146, v146, v17
    v_mul_f32 v147, v147, v17
    v_mul_f32 v160, v160, v17
    v_mul_f32 v161, v161, v17
    v_mul_f32 v162, v162, v17
    v_mul_f32 v163, v163, v17
    v_mul_f32 v176, v176, v17
    v_mul_f32 v177, v177, v17
    v_mul_f32 v178, v178, v17
    v_mul_f32 v179, v179, v17
    v_mul_f32 v192, v192, v17
    v_mul_f32 v193, v193, v17
    v_mul_f32 v194, v194, v17
    v_mul_f32 v195, v195, v17
    v_mul_f32 v208, v208, v17
    v_mul_f32 v209, v209, v17
    v_mul_f32 v210, v210, v17
    v_mul_f32 v211, v211, v17
    v_mul_f32 v224, v224, v17
    v_mul_f32 v225, v225, v17
    v_mul_f32 v226, v226, v17
    v_mul_f32 v227, v227, v17
    v_mul_f32 v240, v240, v17
    v_mul_f32 v241, v241, v17
    v_mul_f32 v242, v242, v17
    v_mul_f32 v243, v243, v17
    v_accvgpr_read_b32 v18, a192
    v_mul_f32 v18, v18, v17
    v_accvgpr_write_b32 a192, v18
    v_sub_f32 v64, v64, v16
    v_exp_f32 v64, v64
    v_sub_f32 v65, v65, v16
    v_exp_f32 v65, v65
    v_sub_f32 v66, v66, v16
    v_exp_f32 v66, v66
    v_sub_f32 v67, v67, v16
    v_exp_f32 v67, v67
    v_sub_f32 v80, v80, v16
    v_exp_f32 v80, v80
    v_sub_f32 v81, v81, v16
    v_exp_f32 v81, v81
    v_sub_f32 v82, v82, v16
    v_exp_f32 v82, v82
    v_sub_f32 v83, v83, v16
    v_exp_f32 v83, v83
    v_cvt_pk_bf16_f32 v64, v64, v65
    v_cvt_pk_bf16_f32 v65, v66, v67
    v_cvt_pk_bf16_f32 v66, v80, v81
    v_cvt_pk_bf16_f32 v67, v82, v83
    v_max3_f32 v16, v68, v69, v70
    v_max3_f32 v16, v16, v71, v84
    v_max3_f32 v16, v16, v85, v86
    v_max3_f32 v16, v16, v87, v49
    v_mov_b32 v17, v16
    s_nop 1
    v_permlane16_swap_b32 v17, v16
    v_max_f32 v16, v17, v16
    v_mov_b32 v17, v16
    s_nop 1
    v_permlane32_swap_b32 v17, v16
    v_max_f32 v16, v17, v16
    v_sub_f32 v17, v49, v16
    v_exp_f32 v17, v17
    v_mov_b32 v49, v16
    v_mul_f32 v132, v132, v17
    v_mul_f32 v133, v133, v17
    v_mul_f32 v134, v134, v17
    v_mul_f32 v135, v135, v17
    v_mul_f32 v148, v148, v17
    v_mul_f32 v149, v149, v17
    v_mul_f32 v150, v150, v17
    v_mul_f32 v151, v151, v17
    v_mul_f32 v164, v164, v17
    v_mul_f32 v165, v165, v17
    v_mul_f32 v166, v166, v17
    v_mul_f32 v167, v167, v17
    v_mul_f32 v180, v180, v17
    v_mul_f32 v181, v181, v17
    v_mul_f32 v182, v182, v17
    v_mul_f32 v183, v183, v17
    v_mul_f32 v196, v196, v17
    v_mul_f32 v197, v197, v17
    v_mul_f32 v198, v198, v17
    v_mul_f32 v199, v199, v17
    v_mul_f32 v212, v212, v17
    v_mul_f32 v213, v213, v17
    v_mul_f32 v214, v214, v17
    v_mul_f32 v215, v215, v17
    v_mul_f32 v228, v228, v17
    v_mul_f32 v229, v229, v17
    v_mul_f32 v230, v230, v17
    v_mul_f32 v231, v231, v17
    v_mul_f32 v244, v244, v17
    v_mul_f32 v245, v245, v17
    v_mul_f32 v246, v246, v17
    v_mul_f32 v247, v247, v17
    v_accvgpr_read_b32 v18, a196
    v_mul_f32 v18, v18, v17
    v_accvgpr_write_b32 a196, v18
    v_sub_f32 v68, v68, v16
    v_exp_f32 v68, v68
    v_sub_f32 v69, v69, v16
    v_exp_f32 v69, v69
    v_sub_f32 v70, v70, v16
    v_exp_f32 v70, v70
    v_sub_f32 v71, v71, v16
    v_exp_f32 v71, v71
    v_sub_f32 v84, v84, v16
    v_exp_f32 v84, v84
    v_sub_f32 v85, v85, v16
    v_exp_f32 v85, v85
    v_sub_f32 v86, v86, v16
    v_exp_f32 v86, v86
    v_sub_f32 v87, v87, v16
    v_exp_f32 v87, v87
    v_cvt_pk_bf16_f32 v68, v68, v69
    v_cvt_pk_bf16_f32 v69, v70, v71
    v_cvt_pk_bf16_f32 v70, v84, v85
    v_cvt_pk_bf16_f32 v71, v86, v87
    v_max3_f32 v16, v72, v73, v74
    v_max3_f32 v16, v16, v75, v88
    v_max3_f32 v16, v16, v89, v90
    v_max3_f32 v16, v16, v91, v50
    v_mov_b32 v17, v16
    s_nop 1
    v_permlane16_swap_b32 v17, v16
    v_max_f32 v16, v17, v16
    v_mov_b32 v17, v16
    s_nop 1
    v_permlane32_swap_b32 v17, v16
    v_max_f32 v16, v17, v16
    v_sub_f32 v17, v50, v16
    v_exp_f32 v17, v17
    v_mov_b32 v50, v16
    v_mul_f32 v136, v136, v17
    v_mul_f32 v137, v137, v17
    v_mul_f32 v138, v138, v17
    v_mul_f32 v139, v139, v17
    v_mul_f32 v152, v152, v17
    v_mul_f32 v153, v153, v17
    v_mul_f32 v154, v154, v17
    v_mul_f32 v155, v155, v17
    v_mul_f32 v168, v168, v17
    v_mul_f32 v169, v169, v17
    v_mul_f32 v170, v170, v17
    v_mul_f32 v171, v171, v17
    v_mul_f32 v184, v184, v17
    v_mul_f32 v185, v185, v17
    v_mul_f32 v186, v186, v17
    v_mul_f32 v187, v187, v17
    v_mul_f32 v200, v200, v17
    v_mul_f32 v201, v201, v17
    v_mul_f32 v202, v202, v17
    v_mul_f32 v203, v203, v17
    v_mul_f32 v216, v216, v17
    v_mul_f32 v217, v217, v17
    v_mul_f32 v218, v218, v17
    v_mul_f32 v219, v219, v17
    v_mul_f32 v232, v232, v17
    v_mul_f32 v233, v233, v17
    v_mul_f32 v234, v234, v17
    v_mul_f32 v235, v235, v17
    v_mul_f32 v248, v248, v17
    v_mul_f32 v249, v249, v17
    v_mul_f32 v250, v250, v17
    v_mul_f32 v251, v251, v17
    v_accvgpr_read_b32 v18, a200
    v_mul_f32 v18, v18, v17
    v_accvgpr_write_b32 a200, v18
    v_sub_f32 v72, v72, v16
    v_exp_f32 v72, v72
    v_sub_f32 v73, v73, v16
    v_exp_f32 v73, v73
    v_sub_f32 v74, v74, v16
    v_exp_f32 v74, v74
    v_sub_f32 v75, v75, v16
    v_exp_f32 v75, v75
    v_sub_f32 v88, v88, v16
    v_exp_f32 v88, v88
    v_sub_f32 v89, v89, v16
    v_exp_f32 v89, v89
    v_sub_f32 v90, v90, v16
    v_exp_f32 v90, v90
    v_sub_f32 v91, v91, v16
    v_exp_f32 v91, v91
    v_cvt_pk_bf16_f32 v72, v72, v73
    v_cvt_pk_bf16_f32 v73, v74, v75
    v_cvt_pk_bf16_f32 v74, v88, v89
    v_cvt_pk_bf16_f32 v75, v90, v91
    v_max3_f32 v16, v76, v77, v78
    v_max3_f32 v16, v16, v79, v92
    v_max3_f32 v16, v16, v93, v94
    v_max3_f32 v16, v16, v95, v51
    v_mov_b32 v17, v16
    s_nop 1
    v_permlane16_swap_b32 v17, v16
    v_max_f32 v16, v17, v16
    v_mov_b32 v17, v16
    s_nop 1
    v_permlane32_swap_b32 v17, v16
    v_max_f32 v16, v17, v16
    v_sub_f32 v17, v51, v16
    v_exp_f32 v17, v17
    v_mov_b32 v51, v16
    v_mul_f32 v140, v140, v17
    v_mul_f32 v141, v141, v17
    v_mul_f32 v142, v142, v17
    v_mul_f32 v143, v143, v17
    v_mul_f32 v156, v156, v17
    v_mul_f32 v157, v157, v17
    v_mul_f32 v158, v158, v17
    v_mul_f32 v159, v159, v17
    v_mul_f32 v172, v172, v17
    v_mul_f32 v173, v173, v17
    v_mul_f32 v174, v174, v17
    v_mul_f32 v175, v175, v17
    v_mul_f32 v188, v188, v17
    v_mul_f32 v189, v189, v17
    v_mul_f32 v190, v190, v17
    v_mul_f32 v191, v191, v17
    v_mul_f32 v204, v204, v17
    v_mul_f32 v205, v205, v17
    v_mul_f32 v206, v206, v17
    v_mul_f32 v207, v207, v17
    v_mul_f32 v220, v220, v17
    v_mul_f32 v221, v221, v17
    v_mul_f32 v222, v222, v17
    v_mul_f32 v223, v223, v17
    v_mul_f32 v236, v236, v17
    v_mul_f32 v237, v237, v17
    v_mul_f32 v238, v238, v17
    v_mul_f32 v239, v239, v17
    v_mul_f32 v252, v252, v17
    v_mul_f32 v253, v253, v17
    v_mul_f32 v254, v254, v17
    v_mul_f32 v255, v255, v17
    v_accvgpr_read_b32 v18, a204
    v_mul_f32 v18, v18, v17
    v_accvgpr_write_b32 a204, v18
    v_sub_f32 v76, v76, v16
    v_exp_f32 v76, v76
    v_sub_f32 v77, v77, v16
    v_exp_f32 v77, v77
    v_sub_f32 v78, v78, v16
    v_exp_f32 v78, v78
    v_sub_f32 v79, v79, v16
    v_exp_f32 v79, v79
    v_sub_f32 v92, v92, v16
    v_exp_f32 v92, v92
    v_sub_f32 v93, v93, v16
    v_exp_f32 v93, v93
    v_sub_f32 v94, v94, v16
    v_exp_f32 v94, v94
    v_sub_f32 v95, v95, v16
    v_exp_f32 v95, v95
    v_cvt_pk_bf16_f32 v76, v76, v77
    v_cvt_pk_bf16_f32 v77, v78, v79
    v_cvt_pk_bf16_f32 v78, v92, v93
    v_cvt_pk_bf16_f32 v79, v94, v95
    s_waitcnt lgkmcnt(14)
    v_mfma_f32_16x16x32_bf16 v[128:131], a[128:131], v[64:67], v[128:131]
    v_mfma_f32_16x16x32_bf16 v[132:135], a[128:131], v[68:71], v[132:135]
    v_mfma_f32_16x16x32_bf16 v[136:139], a[128:131], v[72:75], v[136:139]
    v_mfma_f32_16x16x32_bf16 v[140:143], a[128:131], v[76:79], v[140:143]
    s_waitcnt lgkmcnt(12)
    v_mfma_f32_16x16x32_bf16 v[144:147], a[132:135], v[64:67], v[144:147]
    v_mfma_f32_16x16x32_bf16 v[148:151], a[132:135], v[68:71], v[148:151]
    v_mfma_f32_16x16x32_bf16 v[152:155], a[132:135], v[72:75], v[152:155]
    v_mfma_f32_16x16x32_bf16 v[156:159], a[132:135], v[76:79], v[156:159]
    v_mfma_f32_16x16x32_bf16 a[192:195], a[208:211], v[64:67], a[192:195]
    s_waitcnt lgkmcnt(10)
    v_mfma_f32_16x16x32_bf16 v[160:163], a[136:139], v[64:67], v[160:163]
    v_mfma_f32_16x16x32_bf16 v[164:167], a[136:139], v[68:71], v[164:167]
    v_mfma_f32_16x16x32_bf16 v[168:171], a[136:139], v[72:75], v[168:171]
    v_mfma_f32_16x16x32_bf16 v[172:175], a[136:139], v[76:79], v[172:175]
    s_waitcnt lgkmcnt(8)
    v_mfma_f32_16x16x32_bf16 v[176:179], a[140:143], v[64:67], v[176:179]
    v_mfma_f32_16x16x32_bf16 v[180:183], a[140:143], v[68:71], v[180:183]
    v_mfma_f32_16x16x32_bf16 v[184:187], a[140:143], v[72:75], v[184:187]
    v_mfma_f32_16x16x32_bf16 v[188:191], a[140:143], v[76:79], v[188:191]
    v_mfma_f32_16x16x32_bf16 a[196:199], a[208:211], v[68:71], a[196:199]
    s_waitcnt lgkmcnt(6)
    v_mfma_f32_16x16x32_bf16 v[192:195], a[144:147], v[64:67], v[192:195]
    v_mfma_f32_16x16x32_bf16 v[196:199], a[144:147], v[68:71], v[196:199]
    v_mfma_f32_16x16x32_bf16 v[200:203], a[144:147], v[72:75], v[200:203]
    v_mfma_f32_16x16x32_bf16 v[204:207], a[144:147], v[76:79], v[204:207]
    s_waitcnt lgkmcnt(4)
    v_mfma_f32_16x16x32_bf16 v[208:211], a[148:151], v[64:67], v[208:211]
    v_mfma_f32_16x16x32_bf16 v[212:215], a[148:151], v[68:71], v[212:215]
    v_mfma_f32_16x16x32_bf16 v[216:219], a[148:151], v[72:75], v[216:219]
    v_mfma_f32_16x16x32_bf16 v[220:223], a[148:151], v[76:79], v[220:223]
    v_mfma_f32_16x16x32_bf16 a[200:203], a[208:211], v[72:75], a[200:203]
    s_waitcnt lgkmcnt(2)
    v_mfma_f32_16x16x32_bf16 v[224:227], a[152:155], v[64:67], v[224:227]
    v_mfma_f32_16x16x32_bf16 v[228:231], a[152:155], v[68:71], v[228:231]
    v_mfma_f32_16x16x32_bf16 v[232:235], a[152:155], v[72:75], v[232:235]
    v_mfma_f32_16x16x32_bf16 v[236:239], a[152:155], v[76:79], v[236:239]
    s_waitcnt lgkmcnt(0)
    v_mfma_f32_16x16x32_bf16 v[240:243], a[156:159], v[64:67], v[240:243]
    v_mfma_f32_16x16x32_bf16 v[244:247], a[156:159], v[68:71], v[244:247]
    v_mfma_f32_16x16x32_bf16 v[248:251], a[156:159], v[72:75], v[248:251]
    v_mfma_f32_16x16x32_bf16 v[252:255], a[156:159], v[76:79], v[252:255]
    v_mfma_f32_16x16x32_bf16 a[204:207], a[208:211], v[76:79], a[204:207]
    s_add_u32 s44, s44, 8192
    s_cmp_lt_u32 s44, 524288
    s_cbranch_scc1 L2_sloop
    v_accvgpr_read_b32 v16, a192
    v_accvgpr_read_b32 v17, a196
    v_accvgpr_read_b32 v18, a200
    s_nop 1
    v_accvgpr_read_b32 v19, a204
    s_mov_b32 s12, s8
    s_mov_b32 s13, s9
    s_mov_b32 s14, 0x100000
    s_add_u32 m0, s37, 0
    s_add_u32 s40, s37, 524288
    buffer_load_dwordx4 v44, s[12:15], s40 offen offset:0 sc1 lds
    buffer_load_dwordx4 v45, s[12:15], s40 offen offset:1024 sc1 lds
    buffer_load_dwordx4 v44, s[12:15], s40 offen offset:2048 sc1 lds
    buffer_load_dwordx4 v45, s[12:15], s40 offen offset:3072 sc1 lds
    s_add_u32 m0, s37, 16384
    s_add_u32 s40, s37, 540672
    buffer_load_dwordx4 v44, s[12:15], s40 offen offset:0 sc1 lds
    buffer_load_dwordx4 v45, s[12:15], s40 offen offset:1024 sc1 lds
    buffer_load_dwordx4 v44, s[12:15], s40 offen offset:2048 sc1 lds
    buffer_load_dwordx4 v45, s[12:15], s40 offen offset:3072 sc1 lds
    s_add_u32 m0, s37, 32768
    s_add_u32 s40, s37, 557056
    buffer_load_dwordx4 v44, s[12:15], s40 offen offset:0 sc1 lds
    buffer_load_dwordx4 v45, s[12:15], s40 offen offset:1024 sc1 lds
    buffer_load_dwordx4 v44, s[12:15], s40 offen offset:2048 sc1 lds
    buffer_load_dwordx4 v45, s[12:15], s40 offen offset:3072 sc1 lds
    s_add_u32 m0, s37, 65536
    s_add_u32 s40, s37, 528384
    buffer_load_dwordx4 v44, s[12:15], s40 offen offset:0 sc1 lds
    buffer_load_dwordx4 v45, s[12:15], s40 offen offset:1024 sc1 lds
    buffer_load_dwordx4 v44, s[12:15], s40 offen offset:2048 sc1 lds
    buffer_load_dwordx4 v45, s[12:15], s40 offen offset:3072 sc1 lds
    s_add_u32 m0, s37, 81920
    s_add_u32 s40, s37, 544768
    buffer_load_dwordx4 v44, s[12:15], s40 offen offset:0 sc1 lds
    buffer_load_dwordx4 v45, s[12:15], s40 offen offset:1024 sc1 lds
    buffer_load_dwordx4 v44, s[12:15], s40 offen offset:2048 sc1 lds
    buffer_load_dwordx4 v45, s[12:15], s40 offen offset:3072 sc1 lds
    s_add_u32 m0, s37, 98304
    s_add_u32 s40, s37, 561152
    buffer_load_dwordx4 v44, s[12:15], s40 offen offset:0 sc1 lds
    buffer_load_dwordx4 v45, s[12:15], s40 offen offset:1024 sc1 lds
    buffer_load_dwordx4 v44, s[12:15], s40 offen offset:2048 sc1 lds
    buffer_load_dwordx4 v45, s[12:15], s40 offen offset:3072 sc1 lds
    v_mov_b32 v20, 0
    v_mov_b32 v21, 0
    v_rcp_f32 v16, v16
    v_rcp_f32 v17, v17
    v_rcp_f32 v18, v18
    v_rcp_f32 v19, v19
    s_mov_b32 s43, 0
    v_mul_f32 v128, v128, v16
    v_mul_f32 v129, v129, v16
    v_mul_f32 v130, v130, v16
    v_mul_f32 v131, v131, v16
    v_mul_f32 v144, v144, v16
    v_mul_f32 v145, v145, v16
    v_mul_f32 v146, v146, v16
    v_mul_f32 v147, v147, v16
    v_cvt_pk_bf16_f32 v64, v128, v129
    v_cvt_pk_bf16_f32 v65, v130, v131
    v_cvt_pk_bf16_f32 v66, v144, v145
    v_cvt_pk_bf16_f32 v67, v146, v147
    buffer_store_dwordx4 v[64:67], v47, s[28:31], s43 offen offset:0 sc1
    v_mul_f32 v160, v160, v16
    v_mul_f32 v161, v161, v16
    v_mul_f32 v162, v162, v16
    v_mul_f32 v163, v163, v16
    v_mul_f32 v176, v176, v16
    v_mul_f32 v177, v177, v16
    v_mul_f32 v178, v178, v16
    v_mul_f32 v179, v179, v16
    v_cvt_pk_bf16_f32 v68, v160, v161
    v_cvt_pk_bf16_f32 v69, v162, v163
    v_cvt_pk_bf16_f32 v70, v176, v177
    v_cvt_pk_bf16_f32 v71, v178, v179
    buffer_store_dwordx4 v[68:71], v47, s[28:31], s43 offen offset:1024 sc1
    v_mul_f32 v192, v192, v16
    v_mul_f32 v193, v193, v16
    v_mul_f32 v194, v194, v16
    v_mul_f32 v195, v195, v16
    v_mul_f32 v208, v208, v16
    v_mul_f32 v209, v209, v16
    v_mul_f32 v210, v210, v16
    v_mul_f32 v211, v211, v16
    v_cvt_pk_bf16_f32 v72, v192, v193
    v_cvt_pk_bf16_f32 v73, v194, v195
    v_cvt_pk_bf16_f32 v74, v208, v209
    v_cvt_pk_bf16_f32 v75, v210, v211
    buffer_store_dwordx4 v[72:75], v47, s[28:31], s43 offen offset:2048 sc1
    v_mul_f32 v224, v224, v16
    v_mul_f32 v225, v225, v16
    v_mul_f32 v226, v226, v16
    v_mul_f32 v227, v227, v16
    v_mul_f32 v240, v240, v16
    v_mul_f32 v241, v241, v16
    v_mul_f32 v242, v242, v16
    v_mul_f32 v243, v243, v16
    v_cvt_pk_bf16_f32 v76, v224, v225
    v_cvt_pk_bf16_f32 v77, v226, v227
    v_cvt_pk_bf16_f32 v78, v240, v241
    v_cvt_pk_bf16_f32 v79, v242, v243
    buffer_store_dwordx4 v[76:79], v47, s[28:31], s43 offen offset:3072 sc1
    s_mov_b32 s43, 131072
    v_mul_f32 v132, v132, v17
    v_mul_f32 v133, v133, v17
    v_mul_f32 v134, v134, v17
    v_mul_f32 v135, v135, v17
    v_mul_f32 v148, v148, v17
    v_mul_f32 v149, v149, v17
    v_mul_f32 v150, v150, v17
    v_mul_f32 v151, v151, v17
    v_cvt_pk_bf16_f32 v80, v132, v133
    v_cvt_pk_bf16_f32 v81, v134, v135
    v_cvt_pk_bf16_f32 v82, v148, v149
    v_cvt_pk_bf16_f32 v83, v150, v151
    buffer_store_dwordx4 v[80:83], v47, s[28:31], s43 offen offset:0 sc1
    v_mul_f32 v164, v164, v17
    v_mul_f32 v165, v165, v17
    v_mul_f32 v166, v166, v17
    v_mul_f32 v167, v167, v17
    v_mul_f32 v180, v180, v17
    v_mul_f32 v181, v181, v17
    v_mul_f32 v182, v182, v17
    v_mul_f32 v183, v183, v17
    v_cvt_pk_bf16_f32 v84, v164, v165
    v_cvt_pk_bf16_f32 v85, v166, v167
    v_cvt_pk_bf16_f32 v86, v180, v181
    v_cvt_pk_bf16_f32 v87, v182, v183
    buffer_store_dwordx4 v[84:87], v47, s[28:31], s43 offen offset:1024 sc1
    v_mul_f32 v196, v196, v17
    v_mul_f32 v197, v197, v17
    v_mul_f32 v198, v198, v17
    v_mul_f32 v199, v199, v17
    v_mul_f32 v212, v212, v17
    v_mul_f32 v213, v213, v17
    v_mul_f32 v214, v214, v17
    v_mul_f32 v215, v215, v17
    v_cvt_pk_bf16_f32 v88, v196, v197
    v_cvt_pk_bf16_f32 v89, v198, v199
    v_cvt_pk_bf16_f32 v90, v212, v213
    v_cvt_pk_bf16_f32 v91, v214, v215
    buffer_store_dwordx4 v[88:91], v47, s[28:31], s43 offen offset:2048 sc1
    v_mul_f32 v228, v228, v17
    v_mul_f32 v229, v229, v17
    v_mul_f32 v230, v230, v17
    v_mul_f32 v231, v231, v17
    v_mul_f32 v244, v244, v17
    v_mul_f32 v245, v245, v17
    v_mul_f32 v246, v246, v17
    v_mul_f32 v247, v247, v17
    v_cvt_pk_bf16_f32 v92, v228, v229
    v_cvt_pk_bf16_f32 v93, v230, v231
    v_cvt_pk_bf16_f32 v94, v244, v245
    v_cvt_pk_bf16_f32 v95, v246, v247
    buffer_store_dwordx4 v[92:95], v47, s[28:31], s43 offen offset:3072 sc1
    s_mov_b32 s43, 262144
    v_mul_f32 v136, v136, v18
    v_mul_f32 v137, v137, v18
    v_mul_f32 v138, v138, v18
    v_mul_f32 v139, v139, v18
    v_mul_f32 v152, v152, v18
    v_mul_f32 v153, v153, v18
    v_mul_f32 v154, v154, v18
    v_mul_f32 v155, v155, v18
    v_cvt_pk_bf16_f32 v64, v136, v137
    v_cvt_pk_bf16_f32 v65, v138, v139
    v_cvt_pk_bf16_f32 v66, v152, v153
    v_cvt_pk_bf16_f32 v67, v154, v155
    buffer_store_dwordx4 v[64:67], v47, s[28:31], s43 offen offset:0 sc1
    v_mul_f32 v168, v168, v18
    v_mul_f32 v169, v169, v18
    v_mul_f32 v170, v170, v18
    v_mul_f32 v171, v171, v18
    v_mul_f32 v184, v184, v18
    v_mul_f32 v185, v185, v18
    v_mul_f32 v186, v186, v18
    v_mul_f32 v187, v187, v18
    v_cvt_pk_bf16_f32 v68, v168, v169
    v_cvt_pk_bf16_f32 v69, v170, v171
    v_cvt_pk_bf16_f32 v70, v184, v185
    v_cvt_pk_bf16_f32 v71, v186, v187
    buffer_store_dwordx4 v[68:71], v47, s[28:31], s43 offen offset:1024 sc1
    v_mul_f32 v200, v200, v18
    v_mul_f32 v201, v201, v18
    v_mul_f32 v202, v202, v18
    v_mul_f32 v203, v203, v18
    v_mul_f32 v216, v216, v18
    v_mul_f32 v217, v217, v18
    v_mul_f32 v218, v218, v18
    v_mul_f32 v219, v219, v18
    v_cvt_pk_bf16_f32 v72, v200, v201
    v_cvt_pk_bf16_f32 v73, v202, v203
    v_cvt_pk_bf16_f32 v74, v216, v217
    v_cvt_pk_bf16_f32 v75, v218, v219
    buffer_store_dwordx4 v[72:75], v47, s[28:31], s43 offen offset:2048 sc1
    v_mul_f32 v232, v232, v18
    v_mul_f32 v233, v233, v18
    v_mul_f32 v234, v234, v18
    v_mul_f32 v235, v235, v18
    v_mul_f32 v248, v248, v18
    v_mul_f32 v249, v249, v18
    v_mul_f32 v250, v250, v18
    v_mul_f32 v251, v251, v18
    v_cvt_pk_bf16_f32 v76, v232, v233
    v_cvt_pk_bf16_f32 v77, v234, v235
    v_cvt_pk_bf16_f32 v78, v248, v249
    v_cvt_pk_bf16_f32 v79, v250, v251
    buffer_store_dwordx4 v[76:79], v47, s[28:31], s43 offen offset:3072 sc1
    s_mov_b32 s43, 393216
    v_mul_f32 v140, v140, v19
    v_mul_f32 v141, v141, v19
    v_mul_f32 v142, v142, v19
    v_mul_f32 v143, v143, v19
    v_mul_f32 v156, v156, v19
    v_mul_f32 v157, v157, v19
    v_mul_f32 v158, v158, v19
    v_mul_f32 v159, v159, v19
    v_cvt_pk_bf16_f32 v80, v140, v141
    v_cvt_pk_bf16_f32 v81, v142, v143
    v_cvt_pk_bf16_f32 v82, v156, v157
    v_cvt_pk_bf16_f32 v83, v158, v159
    buffer_store_dwordx4 v[80:83], v47, s[28:31], s43 offen offset:0 sc1
    v_mul_f32 v172, v172, v19
    v_mul_f32 v173, v173, v19
    v_mul_f32 v174, v174, v19
    v_mul_f32 v175, v175, v19
    v_mul_f32 v188, v188, v19
    v_mul_f32 v189, v189, v19
    v_mul_f32 v190, v190, v19
    v_mul_f32 v191, v191, v19
    v_cvt_pk_bf16_f32 v84, v172, v173
    v_cvt_pk_bf16_f32 v85, v174, v175
    v_cvt_pk_bf16_f32 v86, v188, v189
    v_cvt_pk_bf16_f32 v87, v190, v191
    buffer_store_dwordx4 v[84:87], v47, s[28:31], s43 offen offset:1024 sc1
    v_mul_f32 v204, v204, v19
    v_mul_f32 v205, v205, v19
    v_mul_f32 v206, v206, v19
    v_mul_f32 v207, v207, v19
    v_mul_f32 v220, v220, v19
    v_mul_f32 v221, v221, v19
    v_mul_f32 v222, v222, v19
    v_mul_f32 v223, v223, v19
    v_cvt_pk_bf16_f32 v88, v204, v205
    v_cvt_pk_bf16_f32 v89, v206, v207
    v_cvt_pk_bf16_f32 v90, v220, v221
    v_cvt_pk_bf16_f32 v91, v222, v223
    buffer_store_dwordx4 v[88:91], v47, s[28:31], s43 offen offset:2048 sc1
    v_mul_f32 v236, v236, v19
    v_mul_f32 v237, v237, v19
    v_mul_f32 v238, v238, v19
    v_mul_f32 v239, v239, v19
    v_mul_f32 v252, v252, v19
    v_mul_f32 v253, v253, v19
    v_mul_f32 v254, v254, v19
    v_mul_f32 v255, v255, v19
    v_cvt_pk_bf16_f32 v92, v236, v237
    v_cvt_pk_bf16_f32 v93, v238, v239
    v_cvt_pk_bf16_f32 v94, v252, v253
    v_cvt_pk_bf16_f32 v95, v254, v255
    buffer_store_dwordx4 v[92:95], v47, s[28:31], s43 offen offset:3072 sc1
    s_branch L2_done
L2_bg:
    s_cmp_eq_u32 s41, 7
    s_cbranch_scc1 L2_bg7
    s_cmp_eq_u32 s41, 6
    s_cbranch_scc1 L2_bg6
    s_cmp_eq_u32 s41, 5
    s_cbranch_scc1 L2_bg5
    s_cmp_eq_u32 s41, 2
    s_cbranch_scc1 L2_bg2
    s_cmp_eq_u32 s41, 1
    s_cbranch_scc1 L2_bg1
    s_mov_b32 s4, s56
    s_mov_b32 s5, s57
    s_mov_b32 s6, 4194304
    s_mov_b32 s7, 0x20000
    s_lshl_b32 s42, s2, 14
    s_add_u32 s42, s42, s37
    buffer_load_dwordx4 a[216:219], v47, s[4:7], s42 offen offset:0
    buffer_load_dwordx4 a[220:223], v47, s[4:7], s42 offen offset:1024
    buffer_load_dwordx4 a[224:227], v47, s[4:7], s42 offen offset:2048
    buffer_load_dwordx4 a[228:231], v47, s[4:7], s42 offen offset:3072
    s_branch L2_bgb
L2_bg5:
    s_mov_b32 s20, s64
    s_mov_b32 s21, s65
    s_mov_b32 s22, 1835008
    s_mov_b32 s23, 0x20000
    s_mov_b32 s24, s66
    s_mov_b32 s25, s67
    s_mov_b32 s26, 1835008
    s_mov_b32 s27, 0x20000
    s_mul_i32 s42, s2, 7168
    s_lshl_b32 s43, s36, 10
    s_add_u32 s42, s42, s43
    s_add_u32 s43, s42, 4096
    buffer_load_dwordx4 a[232:235], v47, s[20:23], s42 offen
    buffer_load_dwordx4 a[236:239], v47, s[20:23], s43 offen
    buffer_load_dwordx4 a[240:243], v47, s[24:27], s42 offen
    buffer_load_dwordx4 a[244:247], v47, s[24:27], s43 offen
    s_branch L2_bgb
L2_bg7:
    s_add_u32 s4, s10, 25165824
    s_addc_u32 s5, s11, 0
    s_mov_b32 s6, 4718592
    s_mov_b32 s7, 0x20000
    s_bfe_u32 s42, s2, 0x50001
    s_sub_u32 s43, s42, 26
    s_lshl_b32 s43, s43, 2
    s_add_u32 s43, s43, 26
    s_sub_u32 s44, s43, 11
    s_cmp_ge_u32 s42, 29
    s_cselect_b32 s43, s44, s43
    s_cmp_ge_u32 s42, 26
    s_cselect_b32 s42, s43, s42
    s_lshl_b32 s42, s42, 12
    s_lshr_b32 s43, s2, 6
    s_mul_i32 s43, s43, 147456
    s_add_u32 s42, s42, s43
    s_and_b32 s43, s2, 1
    s_lshl_b32 s43, s43, 11
    s_add_u32 s42, s42, s43
    s_lshl_b32 s43, s36, 9
    s_add_u32 s42, s42, s43
    v_and_b32 v6, 7, v0
    v_lshrrev_b32 v7, 3, v0
    v_mul_u32_u24 v7, 589824, v7
    v_lshl_add_u32 v6, v6, 4, v7
    buffer_store_dwordx4 a[216:219], v6, s[4:7], s42 offen offset:0 sc1
    buffer_store_dwordx4 a[220:223], v6, s[4:7], s42 offen offset:128 sc1
    buffer_store_dwordx4 a[224:227], v6, s[4:7], s42 offen offset:256 sc1
    buffer_store_dwordx4 a[228:231], v6, s[4:7], s42 offen offset:384 sc1
    s_branch L2_bgb
L2_bg6:
    s_mov_b32 s28, s68
    s_mov_b32 s29, s69
    s_mov_b32 s30, 1835008
    s_mov_b32 s31, 0x20000
    s_lshl_b32 s42, s3, 9
    s_lshl_b32 s43, s36, 11
    s_add_u32 s42, s42, s43
    s_add_u32 m0, s43, 147456
    s_nop 0
    buffer_load_dwordx4 v47, s[28:31], s42 offen offset:0 lds
    buffer_load_dwordx4 v47, s[28:31], s42 offen offset:1024 lds
    s_cmp_lg_u32 s36, 0
    s_cbranch_scc1 L2_bgb
    s_and_b32 s42, s2, 15
    s_lshl_b32 s42, s42, 7
    s_add_u32 s42, s42, 48128
    v_mov_b32 v6, 1
    v_mov_b32 v7, 0
    s_mov_b64 exec, 1
    buffer_atomic_add v6, v7, s[32:35], s42 offen
    s_mov_b64 exec, -1
    s_branch L2_bgb
L2_bg2:
    buffer_load_dword v4, v5, s[32:35], 0 offen sc1
    s_branch L2_bgb
L2_bg1:
    s_mov_b32 s4, s58
    s_mov_b32 s5, s59
    s_mov_b32 s6, 2097152
    s_mov_b32 s7, 0x20000
    s_mov_b32 s20, s60
    s_mov_b32 s21, s61
    s_mov_b32 s22, 1024
    s_mov_b32 s23, 0x20000
    s_and_b32 s42, s2, 7
    s_lshl_b32 s42, s42, 2
    s_lshr_b32 s43, s2, 6
    s_add_u32 s42, s42, s43
    s_lshl_b32 s42, s42, 16
    s_bfe_u32 s43, s2, 0x30003
    s_lshl_b32 s43, s43, 7
    s_add_u32 s42, s42, s43
    s_lshl_b32 s43, s36, 14
    s_add_u32 s42, s42, s43
    v_lshrrev_b32 v6, 3, v0
    v_and_b32 v7, 7, v0
    v_lshlrev_b32 v7, 4, v7
    v_lshl_add_u32 v6, v6, 10, v7
    v_add_u32 v7, 7168, v6
    s_lshl_b32 s43, s36, 11
    s_add_u32 m0, s43, 131072
    s_nop 0
    buffer_load_dwordx4 v6, s[4:7], s42 offen lds
    buffer_load_dwordx4 v7, s[4:7], s42 offen offset:1024 lds
    s_add_u32 m0, s43, 139264
    s_add_u32 s42, s43, 4096
    buffer_load_dwordx4 v47, s[32:35], s42 offen sc1 lds
    buffer_load_dwordx4 v47, s[32:35], s42 offen offset:1024 sc1 lds
    s_cmp_gt_u32 s36, 1
    s_cbranch_scc1 L2_bgb
    s_cmp_eq_u32 s36, 1
    s_cbranch_scc1 L2_bg1b
    s_mov_b32 m0, 155648
    s_mov_b32 s42, 12288
    buffer_load_dwordx4 v47, s[32:35], s42 offen sc1 lds
    s_branch L2_bgb
L2_bg1b:
    s_mov_b32 m0, 156672
    s_nop 0
    buffer_load_dwordx4 v47, s[20:23], 0 offen lds
    s_branch L2_bgb
L2_wspin:
    s_cmp_lg_u32 s41, 1
    s_cbranch_scc1 L2_wback
    s_mov_b32 s42, 0
L2_wspin2:
    s_sleep 2
    buffer_load_dword v4, v5, s[32:35], 0 offen sc1
    s_waitcnt vmcnt(0)
    v_cmp_ne_u32 vcc, 16, v4
    s_add_u32 s42, s42, 1
    s_cmp_gt_u32 s42, 0x8000
    s_cbranch_scc1 L2_wback
    s_cbranch_vccnz L2_wspin2
    s_branch L2_wback
L2_last:
    s_endpgm
.section .rodata,"a"
.p2align 6
.amdhsa_kernel adaLN_cond__mha_block_cached__moe_arch_mod__prompt_kernel
  .amdhsa_next_free_vgpr 512
  .amdhsa_next_free_sgpr 72
  .amdhsa_accum_offset 256
  .amdhsa_group_segment_fixed_size 0
  .amdhsa_kernarg_size 120
  .amdhsa_user_sgpr_count 2
  .amdhsa_user_sgpr_kernarg_segment_ptr 1
  .amdhsa_system_sgpr_workgroup_id_x 1
.end_amdhsa_kernel
```
